```python
import torch

def _softmax(x, axis=-1):
    return torch.softmax(x, dim=axis)

def _gelu(x):
    return torch.nn.functional.gelu(x, approximate='tanh')

def _silu(x):
    return torch.nn.functional.silu(x)

def _sigmoid(x):
    return torch.sigmoid(x)

def _layernorm(x, axis=-1, eps=1e-05):
    m = x.mean(dim=axis, keepdim=True)
    v = x.var(dim=axis, keepdim=True, unbiased=False)
    return (x - m) / torch.sqrt(v + eps)

def _scatter_add(tgt, idx, src, axis=0):
    return tgt.clone().index_add_(axis, idx, src)

def _segment_sum(src, seg, n):
    out = torch.zeros((n,) + src.shape[1:], dtype=src.dtype)
    return out.index_add_(0, seg, src)

def _pad(x, pw):
    flat = tuple((v for pair in reversed(pw) for v in pair))
    return torch.nn.functional.pad(x, flat)
kernel_name = 'adaLN_cond__mha_block__glu_gated_glu__prompt'

def setup_inputs():

    _w = lambda a: (lambda t: t.to(torch.bfloat16) if t.is_floating_point() else t)(torch.as_tensor(a))

    def _A_setup():
        B, S, D, H = (1, 2048, 640, 32)
        return {'x': _w((lambda *s: torch.randn(*s, dtype=torch.bfloat16) * 0.05)(B, S, D)), 'wqkv': _w((lambda *s: torch.randn(*s, dtype=torch.bfloat16) * 0.05)(D, 3 * D)), 'wo': _w((lambda *s: torch.randn(*s, dtype=torch.bfloat16) * 0.05)(D, D))}
    _A_in = _A_setup()

    def _B_setup():
        B, S, D, F = (1, 2048, 640, 1536)
        return {'x': _w((lambda *s: torch.randn(*s, dtype=torch.bfloat16) * 0.05)(B, S, D)), 'w_gate': _w((lambda *s: torch.randn(*s, dtype=torch.bfloat16) * 0.05)(D, F)), 'w_up': _w((lambda *s: torch.randn(*s, dtype=torch.bfloat16) * 0.05)(D, F)), 'w_down': _w((lambda *s: torch.randn(*s, dtype=torch.bfloat16) * 0.05)(F, D))}
    _B_in = _B_setup()
    return {'A_x': _A_in['x'], 'A_wqkv': _A_in['wqkv'], 'A_wo': _A_in['wo'], 'B_x': _B_in['x'], 'B_w_gate': _B_in['w_gate'], 'B_w_up': _B_in['w_up'], 'B_w_down': _B_in['w_down'], 'c': _w((lambda *s: torch.randn(*s, dtype=torch.bfloat16) * 0.1)(1, 640) * 8.0), 'w_mod': _w((lambda *s: torch.randn(*s, dtype=torch.bfloat16) * 0.1)(640, 6 * 640) * 640 ** (-0.5) * 8.0)}

def reference(A_x, A_wqkv, A_wo, B_x, B_w_gate, B_w_up, B_w_down, c, w_mod):

    def _A_ref(x, wqkv, wo):
        B, S, D = x.shape
        H = 32
        Dh = D // H
        qkv = (lambda x, *d: x.permute(*d))((x @ wqkv).reshape(B, S, 3, H, Dh), 2, 0, 3, 1, 4)
        q, k, v = (qkv[0], qkv[1], qkv[2])
        scores = torch.einsum('bhqd,bhkd->bhqk', q, k) * Dh ** (-0.5)
        p = _softmax(scores, axis=-1)
        o = torch.einsum('bhqk,bhkd->bhqd', p, v)
        return (lambda x, *d: x.permute(*d))(o, 0, 2, 1, 3).reshape(B, S, D) @ wo

    def _B_ref(x, w_gate, w_up, w_down):
        g = torch.einsum('bsd,df->bsf', x, w_gate)
        u = torch.einsum('bsd,df->bsf', x, w_up)
        h = _sigmoid(g) * u
        return torch.einsum('bsf,fd->bsd', h, w_down)
    x = A_x
    mod = (_silu(c) @ w_mod).reshape(c.shape[0], 6, 1, -1)
    sa, ca, ga, sb, cb, gb = (mod[:, 0].clone(), mod[:, 1].clone(), mod[:, 2].clone(), mod[:, 3].clone(), mod[:, 4].clone(), mod[:, 5].clone())
    h = _layernorm(x, axis=-1) * (1 + ca) + sa
    x = x + ga * _A_ref(h, A_wqkv, A_wo)
    h = _layernorm(x, axis=-1) * (1 + cb) + sb
    x = x + gb * _B_ref(h, B_w_gate, B_w_up, B_w_down)
    return x
```

```asm
; @launch grid=(256,1,1) block=(512,1,1) lds=163840
.amdgcn_target "amdgcn-amd-amdhsa--gfx950"
.text
.globl adaLN_cond__mha_block__glu_gated_glu__prompt_kernel
.p2align 8
.type adaLN_cond__mha_block__glu_gated_glu__prompt_kernel,@function
adaLN_cond__mha_block__glu_gated_glu__prompt_kernel:
    s_cmp_ge_u32 s2, 256
    s_cbranch_scc1 L_fin
    s_load_dwordx16 s[16:31], s[0:1], 0
    s_load_dwordx8 s[32:39], s[0:1], 64
    v_lshrrev_b32 v1, 6, v0
    s_nop 0
    v_and_b32 v0, 63, v0
    v_readfirstlane_b32 s40, v1
    s_waitcnt lgkmcnt(0)
    s_cmp_lg_u32 s40, 7
    s_cbranch_scc1 cp_5
    s_getpc_b64 s[92:93]
cp_here_6:
    s_sub_u32 s92, s92, cp_here_6-adaLN_cond__mha_block__glu_gated_glu__prompt_kernel
    s_subb_u32 s93, s93, 0
    s_lshr_b32 s94, s2, 3
    s_and_b32 s94, s94, 31
    s_mul_i32 s94, s94, (L_fin-adaLN_cond__mha_block__glu_gated_glu__prompt_kernel+4095)/4096*128
    v_min_u32 v252, (L_fin-adaLN_cond__mha_block__glu_gated_glu__prompt_kernel+4095)/4096-1, v0
    v_lshlrev_b32 v252, 7, v252
    v_add_u32 v252, s94, v252
    v_min_u32 v252, L_fin-adaLN_cond__mha_block__glu_gated_glu__prompt_kernel, v252
    v_mov_b32 v253, s93
    v_add_co_u32 v252, vcc, s92, v252
    s_nop 1
    v_addc_co_u32 v253, vcc, 0, v253, vcc
    global_load_dword v254, v[252:253], off
cp_5:
    s_mov_b32 s96, s38
    s_mov_b32 s97, s39
    s_mov_b32 s98, 0x20000
    s_mov_b32 s99, 0x20000
    v_mov_b32 v250, 0
    buffer_load_dword v251, v250, s[96:99], 0 offen sc1
    s_mov_b32 s42, 0
    s_and_b32 s71, s2, 7
    s_lshr_b32 s72, s2, 3
    s_lshr_b32 s73, s71, 1
    s_lshl_b32 s73, s73, 2
    s_and_b32 s74, s72, 3
    s_add_u32 s68, s73, s74
    s_and_b32 s73, s71, 1
    s_lshl_b32 s73, s73, 3
    s_lshr_b32 s74, s72, 2
    s_add_u32 s69, s73, s74
    s_mov_b32 s44, s18
    s_mov_b32 s45, s19
    s_mov_b32 s46, 0x258000
    s_mov_b32 s47, 0x20000
    s_cmp_ge_u32 s40, 4
    s_cbranch_scc1 P0_ld_1
    s_mov_b32 s56, s16
    s_mov_b32 s57, s17
    s_mov_b32 s58, 0x280000
    s_mov_b32 s59, 0x20000
    s_add_u32 s60, s38, 0x100000
    s_addc_u32 s61, s39, 0
    s_mov_b32 s62, 0x280000
    s_mov_b32 s63, 0x20000
    s_lshl_b32 s85, s2, 3
    s_lshl_b32 s86, s40, 1
    s_add_u32 s85, s85, s86
    v_lshrrev_b32 v2, 5, v0
    v_and_b32 v3, 31, v0
    v_add_u32 v4, s85, v2
    s_movk_i32 s87, 1280
    v_mul_lo_u32 v5, v4, s87
    v_lshl_add_u32 v5, v3, 3, v5
    buffer_load_dwordx2 v[8:9], v5, s[56:59], 0 offen offset:0
    buffer_load_dwordx2 v[10:11], v5, s[56:59], 0 offen offset:256
    buffer_load_dwordx2 v[12:13], v5, s[56:59], 0 offen offset:512
    buffer_load_dwordx2 v[14:15], v5, s[56:59], 0 offen offset:768
    buffer_load_dwordx2 v[16:17], v5, s[56:59], 0 offen offset:1024
    s_barrier
    s_waitcnt vmcnt(0)
    s_mov_b32 s41, 0x9e3779b1
    v_mul_lo_u32 v251, v251, s41
    v_add_u32 v251, 0x85ebca6b, v251
    s_nop 0
    v_readfirstlane_b32 s41, v251
    v_lshlrev_b32 v20, 16, v8
    v_and_b32 v21, 0xffff0000, v8
    v_lshlrev_b32 v22, 16, v9
    v_and_b32 v23, 0xffff0000, v9
    v_lshlrev_b32 v24, 16, v10
    v_and_b32 v25, 0xffff0000, v10
    v_lshlrev_b32 v26, 16, v11
    v_and_b32 v27, 0xffff0000, v11
    v_lshlrev_b32 v28, 16, v12
    v_and_b32 v29, 0xffff0000, v12
    v_lshlrev_b32 v30, 16, v13
    v_and_b32 v31, 0xffff0000, v13
    v_lshlrev_b32 v32, 16, v14
    v_and_b32 v33, 0xffff0000, v14
    v_lshlrev_b32 v34, 16, v15
    v_and_b32 v35, 0xffff0000, v15
    v_lshlrev_b32 v36, 16, v16
    v_and_b32 v37, 0xffff0000, v16
    v_lshlrev_b32 v38, 16, v17
    v_and_b32 v39, 0xffff0000, v17
    v_add_f32 v42, v20, v21
    v_add_f32 v43, v22, v23
    v_add_f32 v42, v42, v24
    v_add_f32 v43, v43, v25
    v_add_f32 v42, v42, v26
    v_add_f32 v43, v43, v27
    v_add_f32 v42, v42, v28
    v_add_f32 v43, v43, v29
    v_add_f32 v42, v42, v30
    v_add_f32 v43, v43, v31
    v_add_f32 v42, v42, v32
    v_add_f32 v43, v43, v33
    v_add_f32 v42, v42, v34
    v_add_f32 v43, v43, v35
    v_add_f32 v42, v42, v36
    v_add_f32 v43, v43, v37
    v_add_f32 v42, v42, v38
    v_add_f32 v43, v43, v39
    v_add_f32 v40, v42, v43
    s_nop 1
    v_add_f32_dpp v40, v40, v40 row_ror:8 row_mask:0xf bank_mask:0xf
    s_nop 1
    v_add_f32_dpp v40, v40, v40 row_ror:4 row_mask:0xf bank_mask:0xf
    s_nop 1
    v_add_f32_dpp v40, v40, v40 row_ror:2 row_mask:0xf bank_mask:0xf
    s_nop 1
    v_add_f32_dpp v40, v40, v40 row_ror:1 row_mask:0xf bank_mask:0xf
    v_mov_b32 v41, v40
    s_nop 1
    v_permlane16_swap_b32 v40, v41
    s_nop 1
    v_add_f32 v40, v40, v41
    v_mul_f32 v40, 0x3acccccd, v40
    v_sub_f32 v20, v20, v40
    v_sub_f32 v21, v21, v40
    v_sub_f32 v22, v22, v40
    v_sub_f32 v23, v23, v40
    v_sub_f32 v24, v24, v40
    v_sub_f32 v25, v25, v40
    v_sub_f32 v26, v26, v40
    v_sub_f32 v27, v27, v40
    v_sub_f32 v28, v28, v40
    v_sub_f32 v29, v29, v40
    v_sub_f32 v30, v30, v40
    v_sub_f32 v31, v31, v40
    v_sub_f32 v32, v32, v40
    v_sub_f32 v33, v33, v40
    v_sub_f32 v34, v34, v40
    v_sub_f32 v35, v35, v40
    v_sub_f32 v36, v36, v40
    v_sub_f32 v37, v37, v40
    v_sub_f32 v38, v38, v40
    v_sub_f32 v39, v39, v40
    v_mul_f32 v42, v20, v20
    v_mul_f32 v43, v21, v21
    v_fmac_f32 v42, v22, v22
    v_fmac_f32 v43, v23, v23
    v_fmac_f32 v42, v24, v24
    v_fmac_f32 v43, v25, v25
    v_fmac_f32 v42, v26, v26
    v_fmac_f32 v43, v27, v27
    v_fmac_f32 v42, v28, v28
    v_fmac_f32 v43, v29, v29
    v_fmac_f32 v42, v30, v30
    v_fmac_f32 v43, v31, v31
    v_fmac_f32 v42, v32, v32
    v_fmac_f32 v43, v33, v33
    v_fmac_f32 v42, v34, v34
    v_fmac_f32 v43, v35, v35
    v_fmac_f32 v42, v36, v36
    v_fmac_f32 v43, v37, v37
    v_fmac_f32 v42, v38, v38
    v_fmac_f32 v43, v39, v39
    v_add_f32 v41, v42, v43
    s_nop 1
    v_add_f32_dpp v41, v41, v41 row_ror:8 row_mask:0xf bank_mask:0xf
    s_nop 1
    v_add_f32_dpp v41, v41, v41 row_ror:4 row_mask:0xf bank_mask:0xf
    s_nop 1
    v_add_f32_dpp v41, v41, v41 row_ror:2 row_mask:0xf bank_mask:0xf
    s_nop 1
    v_add_f32_dpp v41, v41, v41 row_ror:1 row_mask:0xf bank_mask:0xf
    v_mov_b32 v42, v41
    s_nop 1
    v_permlane16_swap_b32 v41, v42
    s_nop 1
    v_add_f32 v41, v41, v42
    v_mov_b32 v42, 0x3727c5ac
    v_fmac_f32 v42, 0x3acccccd, v41
    v_rsq_f32 v42, v42
    s_nop 0
    v_mul_f32 v20, v20, v42
    v_mul_f32 v21, v21, v42
    v_mul_f32 v22, v22, v42
    v_mul_f32 v23, v23, v42
    v_mul_f32 v24, v24, v42
    v_mul_f32 v25, v25, v42
    v_mul_f32 v26, v26, v42
    v_mul_f32 v27, v27, v42
    v_mul_f32 v28, v28, v42
    v_mul_f32 v29, v29, v42
    v_mul_f32 v30, v30, v42
    v_mul_f32 v31, v31, v42
    v_mul_f32 v32, v32, v42
    v_mul_f32 v33, v33, v42
    v_mul_f32 v34, v34, v42
    v_mul_f32 v35, v35, v42
    v_mul_f32 v36, v36, v42
    v_mul_f32 v37, v37, v42
    v_mul_f32 v38, v38, v42
    v_mul_f32 v39, v39, v42
    v_lshlrev_b32 v6, 4, v3
    v_add_u32 v6, 139264, v6
    s_barrier
    ds_read_b128 v[60:63], v6 offset:0
    ds_read_b128 v[64:67], v6 offset:2560
    ds_read_b128 v[68:71], v6 offset:512
    ds_read_b128 v[72:75], v6 offset:3072
    ds_read_b128 v[76:79], v6 offset:1024
    ds_read_b128 v[80:83], v6 offset:3584
    ds_read_b128 v[84:87], v6 offset:1536
    ds_read_b128 v[88:91], v6 offset:4096
    ds_read_b128 v[92:95], v6 offset:2048
    ds_read_b128 v[96:99], v6 offset:4608
    s_waitcnt lgkmcnt(8)
    v_fma_f32 v20, v20, v60, v64
    v_fma_f32 v21, v21, v61, v65
    v_fma_f32 v22, v22, v62, v66
    v_fma_f32 v23, v23, v63, v67
    v_cvt_pk_bf16_f32 v8, v20, v21
    v_cvt_pk_bf16_f32 v9, v22, v23
    buffer_store_dwordx2 v[8:9], v5, s[60:63], 0 offen offset:0 sc1
    s_waitcnt lgkmcnt(6)
    v_fma_f32 v24, v24, v68, v72
    v_fma_f32 v25, v25, v69, v73
    v_fma_f32 v26, v26, v70, v74
    v_fma_f32 v27, v27, v71, v75
    v_cvt_pk_bf16_f32 v10, v24, v25
    v_cvt_pk_bf16_f32 v11, v26, v27
    buffer_store_dwordx2 v[10:11], v5, s[60:63], 0 offen offset:256 sc1
    s_waitcnt lgkmcnt(4)
    v_fma_f32 v28, v28, v76, v80
    v_fma_f32 v29, v29, v77, v81
    v_fma_f32 v30, v30, v78, v82
    v_fma_f32 v31, v31, v79, v83
    v_cvt_pk_bf16_f32 v12, v28, v29
    v_cvt_pk_bf16_f32 v13, v30, v31
    buffer_store_dwordx2 v[12:13], v5, s[60:63], 0 offen offset:512 sc1
    s_waitcnt lgkmcnt(2)
    v_fma_f32 v32, v32, v84, v88
    v_fma_f32 v33, v33, v85, v89
    v_fma_f32 v34, v34, v86, v90
    v_fma_f32 v35, v35, v87, v91
    v_cvt_pk_bf16_f32 v14, v32, v33
    v_cvt_pk_bf16_f32 v15, v34, v35
    buffer_store_dwordx2 v[14:15], v5, s[60:63], 0 offen offset:768 sc1
    s_waitcnt lgkmcnt(0)
    v_fma_f32 v36, v36, v92, v96
    v_fma_f32 v37, v37, v93, v97
    v_fma_f32 v38, v38, v94, v98
    v_fma_f32 v39, v39, v95, v99
    v_cvt_pk_bf16_f32 v16, v36, v37
    v_cvt_pk_bf16_f32 v17, v38, v39
    buffer_store_dwordx2 v[16:17], v5, s[60:63], 0 offen offset:1024 sc1
    s_waitcnt vmcnt(0)
    s_branch P0_D_4
P0_ld_1:
    s_sub_u32 s70, s40, 4
    s_cmp_ge_u32 s2, 240
    s_cbranch_scc1 P0_nomod_7
    s_mov_b32 s56, s32
    s_mov_b32 s57, s33
    s_mov_b32 s58, 0x4b0000
    s_mov_b32 s59, 0x20000
    s_mov_b32 s60, s30
    s_mov_b32 s61, s31
    s_mov_b32 s62, 0x500
    s_mov_b32 s63, 0x20000
    s_and_b32 s84, s2, 7
    s_lshr_b32 s85, s2, 3
    s_mul_i32 s86, s84, 10
    s_add_u32 s86, s86, s85
    s_mul_i32 s87, s84, 20
    s_add_u32 s87, s87, s85
    s_add_u32 s87, s87, 70
    s_cmp_lt_u32 s85, 10
    s_cselect_b32 s86, s86, s87
    v_lshrrev_b32 v2, 1, v0
    v_and_b32 v3, 1, v0
    s_mul_i32 s87, s70, 160
    v_add_u32 v4, s87, v2
    v_lshlrev_b32 v5, 1, v4
    s_movk_i32 s87, 7680
    v_mul_lo_u32 v6, v4, s87
    s_lshl_b32 s88, s86, 5
    v_lshl_add_u32 v6, v3, 4, v6
    v_add_u32 v6, s88, v6
    buffer_load_ushort v8, v5, s[60:63], 0 offen offset:0
    buffer_load_ushort v9, v5, s[60:63], 0 offen offset:64
    buffer_load_ushort v10, v5, s[60:63], 0 offen offset:128
    buffer_load_ushort v11, v5, s[60:63], 0 offen offset:192
    buffer_load_ushort v12, v5, s[60:63], 0 offen offset:256
    s_mov_b32 s87, 0
    buffer_load_dwordx4 v[16:19], v6, s[56:59], s87 offen
    s_mov_b32 s87, 245760
    buffer_load_dwordx4 v[20:23], v6, s[56:59], s87 offen
    s_mov_b32 s87, 491520
    buffer_load_dwordx4 v[24:27], v6, s[56:59], s87 offen
    s_mov_b32 s87, 737280
    buffer_load_dwordx4 v[28:31], v6, s[56:59], s87 offen
    s_mov_b32 s87, 983040
    buffer_load_dwordx4 v[32:35], v6, s[56:59], s87 offen
    s_waitcnt vmcnt(5)
    s_mov_b32 s41, 0x9e3779b1
    v_mul_lo_u32 v251, v251, s41
    v_add_u32 v251, 0x85ebca6b, v251
    s_nop 0
    v_readfirstlane_b32 s41, v251
    v_lshlrev_b32 v8, 16, v8
    v_lshlrev_b32 v9, 16, v9
    v_lshlrev_b32 v10, 16, v10
    v_lshlrev_b32 v11, 16, v11
    v_lshlrev_b32 v12, 16, v12
    v_mul_f32 v40, 0xbfb8aa3b, v8
    v_mul_f32 v41, 0xbfb8aa3b, v9
    v_mul_f32 v42, 0xbfb8aa3b, v10
    v_mul_f32 v43, 0xbfb8aa3b, v11
    v_mul_f32 v44, 0xbfb8aa3b, v12
    v_exp_f32 v40, v40
    v_exp_f32 v41, v41
    v_exp_f32 v42, v42
    v_exp_f32 v43, v43
    v_exp_f32 v44, v44
    s_nop 0
    v_add_f32 v40, 1.0, v40
    v_add_f32 v41, 1.0, v41
    v_add_f32 v42, 1.0, v42
    v_add_f32 v43, 1.0, v43
    v_add_f32 v44, 1.0, v44
    v_rcp_f32 v40, v40
    v_rcp_f32 v41, v41
    v_rcp_f32 v42, v42
    v_rcp_f32 v43, v43
    v_rcp_f32 v44, v44
    s_nop 0
    v_mul_f32 v8, v8, v40
    v_mul_f32 v9, v9, v41
    v_mul_f32 v10, v10, v42
    v_mul_f32 v11, v11, v43
    v_mul_f32 v12, v12, v44
    v_cvt_pk_bf16_f32 v8, v8, v8
    v_cvt_pk_bf16_f32 v9, v9, v9
    v_cvt_pk_bf16_f32 v10, v10, v10
    v_cvt_pk_bf16_f32 v11, v11, v11
    v_cvt_pk_bf16_f32 v12, v12, v12
    v_and_b32 v8, 0xffff0000, v8
    v_and_b32 v9, 0xffff0000, v9
    v_and_b32 v10, 0xffff0000, v10
    v_and_b32 v11, 0xffff0000, v11
    v_and_b32 v12, 0xffff0000, v12
    s_waitcnt vmcnt(4)
    v_lshlrev_b32 v46, 16, v16
    v_and_b32 v47, 0xffff0000, v16
    v_mul_f32 v48, v8, v46
    v_mul_f32 v49, v8, v47
    v_lshlrev_b32 v46, 16, v17
    v_and_b32 v47, 0xffff0000, v17
    v_mul_f32 v50, v8, v46
    v_mul_f32 v51, v8, v47
    v_lshlrev_b32 v46, 16, v18
    v_and_b32 v47, 0xffff0000, v18
    v_mul_f32 v52, v8, v46
    v_mul_f32 v53, v8, v47
    v_lshlrev_b32 v46, 16, v19
    v_and_b32 v47, 0xffff0000, v19
    v_mul_f32 v54, v8, v46
    v_mul_f32 v55, v8, v47
    s_waitcnt vmcnt(3)
    v_lshlrev_b32 v46, 16, v20
    v_and_b32 v47, 0xffff0000, v20
    v_fmac_f32 v48, v9, v46
    v_fmac_f32 v49, v9, v47
    v_lshlrev_b32 v46, 16, v21
    v_and_b32 v47, 0xffff0000, v21
    v_fmac_f32 v50, v9, v46
    v_fmac_f32 v51, v9, v47
    v_lshlrev_b32 v46, 16, v22
    v_and_b32 v47, 0xffff0000, v22
    v_fmac_f32 v52, v9, v46
    v_fmac_f32 v53, v9, v47
    v_lshlrev_b32 v46, 16, v23
    v_and_b32 v47, 0xffff0000, v23
    v_fmac_f32 v54, v9, v46
    v_fmac_f32 v55, v9, v47
    s_waitcnt vmcnt(2)
    v_lshlrev_b32 v46, 16, v24
    v_and_b32 v47, 0xffff0000, v24
    v_fmac_f32 v48, v10, v46
    v_fmac_f32 v49, v10, v47
    v_lshlrev_b32 v46, 16, v25
    v_and_b32 v47, 0xffff0000, v25
    v_fmac_f32 v50, v10, v46
    v_fmac_f32 v51, v10, v47
    v_lshlrev_b32 v46, 16, v26
    v_and_b32 v47, 0xffff0000, v26
    v_fmac_f32 v52, v10, v46
    v_fmac_f32 v53, v10, v47
    v_lshlrev_b32 v46, 16, v27
    v_and_b32 v47, 0xffff0000, v27
    v_fmac_f32 v54, v10, v46
    v_fmac_f32 v55, v10, v47
    s_waitcnt vmcnt(1)
    v_lshlrev_b32 v46, 16, v28
    v_and_b32 v47, 0xffff0000, v28
    v_fmac_f32 v48, v11, v46
    v_fmac_f32 v49, v11, v47
    v_lshlrev_b32 v46, 16, v29
    v_and_b32 v47, 0xffff0000, v29
    v_fmac_f32 v50, v11, v46
    v_fmac_f32 v51, v11, v47
    v_lshlrev_b32 v46, 16, v30
    v_and_b32 v47, 0xffff0000, v30
    v_fmac_f32 v52, v11, v46
    v_fmac_f32 v53, v11, v47
    v_lshlrev_b32 v46, 16, v31
    v_and_b32 v47, 0xffff0000, v31
    v_fmac_f32 v54, v11, v46
    v_fmac_f32 v55, v11, v47
    s_waitcnt vmcnt(0)
    v_lshlrev_b32 v46, 16, v32
    v_and_b32 v47, 0xffff0000, v32
    v_fmac_f32 v48, v12, v46
    v_fmac_f32 v49, v12, v47
    v_lshlrev_b32 v46, 16, v33
    v_and_b32 v47, 0xffff0000, v33
    v_fmac_f32 v50, v12, v46
    v_fmac_f32 v51, v12, v47
    v_lshlrev_b32 v46, 16, v34
    v_and_b32 v47, 0xffff0000, v34
    v_fmac_f32 v52, v12, v46
    v_fmac_f32 v53, v12, v47
    v_lshlrev_b32 v46, 16, v35
    v_and_b32 v47, 0xffff0000, v35
    v_fmac_f32 v54, v12, v46
    v_fmac_f32 v55, v12, v47
    s_lshl_b32 s87, s70, 11
    s_add_u32 s87, s87, 131072
    v_lshlrev_b32 v7, 5, v0
    v_add_u32 v7, s87, v7
    ds_write_b128 v7, v[48:51]
    ds_write_b128 v7, v[52:55] offset:16
    s_waitcnt lgkmcnt(0)
    s_branch P0_A_2
P0_nomod_7:
    s_waitcnt vmcnt(0)
    s_mov_b32 s41, 0x9e3779b1
    v_mul_lo_u32 v251, v251, s41
    v_add_u32 v251, 0x85ebca6b, v251
    s_nop 0
    v_readfirstlane_b32 s41, v251
P0_A_2:
    s_barrier
    s_cmp_eq_u32 s70, 0
    s_cbranch_scc1 P0_w0_8
    s_cmp_eq_u32 s70, 3
    s_cbranch_scc1 P0_pre_10
    s_branch P0_w1_9
P0_w0_8:
    s_cmp_ge_u32 s2, 240
    s_cbranch_scc1 P0_pre_10
    s_add_u32 s56, s38, 0x80000
    s_addc_u32 s57, s39, 0
    s_mov_b32 s58, 0x20000
    s_mov_b32 s59, 0x20000
    v_and_b32 v3, 3, v0
    v_lshrrev_b32 v2, 2, v0
    v_lshlrev_b32 v7, 9, v2
    v_lshl_add_u32 v7, v3, 4, v7
    v_add_u32 v7, 131072, v7
    ds_read_b128 v[64:67], v7 offset:0
    ds_read_b128 v[68:71], v7 offset:64
    ds_read_b128 v[72:75], v7 offset:128
    ds_read_b128 v[76:79], v7 offset:192
    ds_read_b128 v[80:83], v7 offset:256
    ds_read_b128 v[84:87], v7 offset:320
    ds_read_b128 v[88:91], v7 offset:384
    ds_read_b128 v[92:95], v7 offset:448
    s_waitcnt lgkmcnt(6)
    v_add_f32 v64, v64, v68
    v_add_f32 v65, v65, v69
    v_add_f32 v66, v66, v70
    v_add_f32 v67, v67, v71
    s_waitcnt lgkmcnt(5)
    v_add_f32 v64, v64, v72
    v_add_f32 v65, v65, v73
    v_add_f32 v66, v66, v74
    v_add_f32 v67, v67, v75
    s_waitcnt lgkmcnt(4)
    v_add_f32 v64, v64, v76
    v_add_f32 v65, v65, v77
    v_add_f32 v66, v66, v78
    v_add_f32 v67, v67, v79
    s_waitcnt lgkmcnt(3)
    v_add_f32 v64, v64, v80
    v_add_f32 v65, v65, v81
    v_add_f32 v66, v66, v82
    v_add_f32 v67, v67, v83
    s_waitcnt lgkmcnt(2)
    v_add_f32 v64, v64, v84
    v_add_f32 v65, v65, v85
    v_add_f32 v66, v66, v86
    v_add_f32 v67, v67, v87
    s_waitcnt lgkmcnt(1)
    v_add_f32 v64, v64, v88
    v_add_f32 v65, v65, v89
    v_add_f32 v66, v66, v90
    v_add_f32 v67, v67, v91
    s_waitcnt lgkmcnt(0)
    v_add_f32 v64, v64, v92
    v_add_f32 v65, v65, v93
    v_add_f32 v66, v66, v94
    v_add_f32 v67, v67, v95
    s_nop 1
    v_add_f32_dpp v64, v64, v64 row_ror:4 row_mask:0xf bank_mask:0xf
    v_add_f32_dpp v65, v65, v65 row_ror:4 row_mask:0xf bank_mask:0xf
    v_add_f32_dpp v66, v66, v66 row_ror:4 row_mask:0xf bank_mask:0xf
    v_add_f32_dpp v67, v67, v67 row_ror:4 row_mask:0xf bank_mask:0xf
    s_nop 1
    v_add_f32_dpp v64, v64, v64 row_ror:8 row_mask:0xf bank_mask:0xf
    v_add_f32_dpp v65, v65, v65 row_ror:8 row_mask:0xf bank_mask:0xf
    v_add_f32_dpp v66, v66, v66 row_ror:8 row_mask:0xf bank_mask:0xf
    v_add_f32_dpp v67, v67, v67 row_ror:8 row_mask:0xf bank_mask:0xf
    v_mov_b32 v68, v64
    v_mov_b32 v69, v65
    v_mov_b32 v70, v66
    v_mov_b32 v71, v67
    s_nop 1
    v_permlane16_swap_b32 v64, v68
    v_permlane16_swap_b32 v65, v69
    v_permlane16_swap_b32 v66, v70
    v_permlane16_swap_b32 v67, v71
    s_nop 1
    v_add_f32 v64, v64, v68
    v_add_f32 v65, v65, v69
    v_add_f32 v66, v66, v70
    v_add_f32 v67, v67, v71
    v_mov_b32 v68, v64
    v_mov_b32 v69, v65
    v_mov_b32 v70, v66
    v_mov_b32 v71, v67
    s_nop 1
    v_permlane32_swap_b32 v64, v68
    v_permlane32_swap_b32 v65, v69
    v_permlane32_swap_b32 v66, v70
    v_permlane32_swap_b32 v67, v71
    s_nop 1
    v_add_f32 v64, v64, v68
    v_add_f32 v65, v65, v69
    v_add_f32 v66, v66, v70
    v_add_f32 v67, v67, v71
    v_cvt_pk_bf16_f32 v72, v64, v65
    v_cvt_pk_bf16_f32 v73, v66, v67
    v_mov_b32 v74, s41
    v_mov_b32 v75, 0
    v_lshlrev_b32 v7, 4, v3
    v_mul_u32_u24 v76, 16384, v2
    v_add_u32 v7, v7, v76
    s_lshl_b32 s87, s86, 6
    s_mov_b32 exec_lo, -1
    s_mov_b32 exec_hi, 0
    buffer_store_dwordx4 v[72:75], v7, s[56:59], s87 offen sc1
    s_mov_b64 exec, -1
    s_branch P0_pre_10
P0_w1_9:
    s_add_u32 s56, s38, 0x80000
    s_addc_u32 s57, s39, 0
    s_mov_b32 s58, 0x20000
    s_mov_b32 s59, 0x20000
    s_and_b32 s84, s2, 7
    s_mul_i32 s84, s84, 16384
    s_sub_u32 s85, s70, 1
    s_mul_i32 s86, s85, 2560
    s_add_u32 s84, s84, s86
    v_lshlrev_b32 v7, 4, v0
    v_add_u32 v8, 128, v0
    v_min_u32 v8, 159, v8
    v_lshlrev_b32 v8, 4, v8
    s_mov_b32 s94, 30000
    s_cmp_lg_u32 s42, 0
    s_cselect_b32 s94, 1, s94
P0_mod_poll_11:
    buffer_load_dwordx4 v[16:19], v7, s[56:59], s84 offen sc1
    buffer_load_dwordx4 v[20:23], v7, s[56:59], s84 offen offset:1024 sc1
    buffer_load_dwordx4 v[24:27], v8, s[56:59], s84 offen sc1
    s_waitcnt vmcnt(0)
    v_cmp_ne_u32 vcc, s41, v18
    v_cmp_ne_u32 s[92:93], s41, v22
    s_nop 1
    s_or_b64 vcc, vcc, s[92:93]
    v_cmp_ne_u32 s[92:93], s41, v26
    s_nop 1
    s_or_b64 vcc, vcc, s[92:93]
    s_nop 1
    s_cbranch_vccz P0_mod_ok_13
    s_sleep 2
    s_sub_u32 s94, s94, 1
    s_cmp_lg_u32 s94, 0
    s_cbranch_scc1 P0_mod_poll_11
    s_mov_b32 s42, 1
P0_mod_ok_13:
    s_cmp_eq_u32 s85, 0
    s_mov_b32 s86, 139264
    s_cselect_b32 s86, 141824, s86
    v_add_u32 v7, s86, v7
    v_add_u32 v8, s86, v8
    v_lshlrev_b32 v40, 16, v16
    v_and_b32 v41, 0xffff0000, v16
    v_lshlrev_b32 v42, 16, v17
    v_and_b32 v43, 0xffff0000, v17
    v_lshlrev_b32 v44, 16, v20
    v_and_b32 v45, 0xffff0000, v20
    v_lshlrev_b32 v46, 16, v21
    v_and_b32 v47, 0xffff0000, v21
    v_lshlrev_b32 v48, 16, v24
    v_and_b32 v49, 0xffff0000, v24
    v_lshlrev_b32 v50, 16, v25
    v_and_b32 v51, 0xffff0000, v25
    s_cmp_eq_u32 s85, 0
    s_cbranch_scc1 P0_plain_14
    v_add_f32 v40, 1.0, v40
    v_add_f32 v41, 1.0, v41
    v_add_f32 v42, 1.0, v42
    v_add_f32 v43, 1.0, v43
    v_cvt_pk_bf16_f32 v40, v40, v41
    v_cvt_pk_bf16_f32 v42, v42, v43
    v_and_b32 v41, 0xffff0000, v40
    v_and_b32 v43, 0xffff0000, v42
    v_lshlrev_b32 v40, 16, v40
    v_lshlrev_b32 v42, 16, v42
    v_add_f32 v44, 1.0, v44
    v_add_f32 v45, 1.0, v45
    v_add_f32 v46, 1.0, v46
    v_add_f32 v47, 1.0, v47
    v_cvt_pk_bf16_f32 v44, v44, v45
    v_cvt_pk_bf16_f32 v46, v46, v47
    v_and_b32 v45, 0xffff0000, v44
    v_and_b32 v47, 0xffff0000, v46
    v_lshlrev_b32 v44, 16, v44
    v_lshlrev_b32 v46, 16, v46
    v_add_f32 v48, 1.0, v48
    v_add_f32 v49, 1.0, v49
    v_add_f32 v50, 1.0, v50
    v_add_f32 v51, 1.0, v51
    v_cvt_pk_bf16_f32 v48, v48, v49
    v_cvt_pk_bf16_f32 v50, v50, v51
    v_and_b32 v49, 0xffff0000, v48
    v_and_b32 v51, 0xffff0000, v50
    v_lshlrev_b32 v48, 16, v48
    v_lshlrev_b32 v50, 16, v50
P0_plain_14:
    ds_write_b128 v7, v[40:43]
    ds_write_b128 v7, v[44:47] offset:1024
    ds_write_b128 v8, v[48:51]
    s_waitcnt lgkmcnt(0)
    s_barrier
    s_cmp_ge_u32 s69, 15
    s_cbranch_scc1 P1_nopre_15
    s_sub_u32 s70, s40, 4
    v_lshrrev_b32 v8, 4, v0
    v_bfe_u32 v9, v0, 2, 2
    v_xor_b32 v9, v9, v8
    v_and_b32 v10, 3, v0
    v_mul_u32_u24 v56, 3840, v8
    v_lshl_add_u32 v56, v9, 6, v56
    v_lshl_add_u32 v56, v10, 4, v56
    s_mul_i32 s73, s70, 61440
    s_lshl_b32 s77, s69, 8
    s_add_u32 s73, s73, s77
    s_lshl_b32 s77, s70, 12
    s_add_u32 m0, s77, 0
    s_add_u32 s75, s73, 0
    buffer_load_dwordx4 v56, s[44:47], s75 offen lds
    s_add_u32 m0, s77, 1024
    s_add_u32 s75, s73, 15360
    buffer_load_dwordx4 v56, s[44:47], s75 offen lds
    s_add_u32 m0, s77, 2048
    s_add_u32 s75, s73, 30720
    buffer_load_dwordx4 v56, s[44:47], s75 offen lds
    s_add_u32 m0, s77, 3072
    s_add_u32 s75, s73, 46080
    buffer_load_dwordx4 v56, s[44:47], s75 offen lds
    s_add_u32 m0, s77, 16384
    s_add_u32 s75, s73, 245760
    buffer_load_dwordx4 v56, s[44:47], s75 offen lds
    s_add_u32 m0, s77, 17408
    s_add_u32 s75, s73, 261120
    buffer_load_dwordx4 v56, s[44:47], s75 offen lds
    s_add_u32 m0, s77, 18432
    s_add_u32 s75, s73, 276480
    buffer_load_dwordx4 v56, s[44:47], s75 offen lds
    s_add_u32 m0, s77, 19456
    s_add_u32 s75, s73, 291840
    buffer_load_dwordx4 v56, s[44:47], s75 offen lds
    s_add_u32 m0, s77, 32768
    s_add_u32 s75, s73, 491520
    buffer_load_dwordx4 v56, s[44:47], s75 offen lds
    s_add_u32 m0, s77, 33792
    s_add_u32 s75, s73, 506880
    buffer_load_dwordx4 v56, s[44:47], s75 offen lds
    s_add_u32 m0, s77, 34816
    s_add_u32 s75, s73, 522240
    buffer_load_dwordx4 v56, s[44:47], s75 offen lds
    s_add_u32 m0, s77, 35840
    s_add_u32 s75, s73, 537600
    buffer_load_dwordx4 v56, s[44:47], s75 offen lds
    s_and_b32 s84, s68, 3
    s_mul_i32 s84, s84, 112
    s_mul_i32 s85, s70, 28
    s_add_u32 s84, s84, s85
    s_add_u32 s84, s84, 192
    s_mul_i32 s84, s84, 3840
    s_lshl_b32 s85, s69, 8
    s_add_u32 s84, s84, s85
    v_lshrrev_b32 v100, 1, v0
    v_min_u32 v100, 27, v100
    v_mul_u32_u24 v100, 3840, v100
    v_and_b32 v101, 1, v0
    v_lshl_add_u32 v100, v101, 7, v100
    buffer_load_dword v102, v100, s[44:47], s84 offen
P1_nopre_15:
    s_branch P0_D_4
P0_pre_10:
    s_cmp_ge_u32 s69, 15
    s_cbranch_scc1 P1_nopre_16
    s_sub_u32 s70, s40, 4
    v_lshrrev_b32 v8, 4, v0
    v_bfe_u32 v9, v0, 2, 2
    v_xor_b32 v9, v9, v8
    v_and_b32 v10, 3, v0
    v_mul_u32_u24 v56, 3840, v8
    v_lshl_add_u32 v56, v9, 6, v56
    v_lshl_add_u32 v56, v10, 4, v56
    s_mul_i32 s73, s70, 61440
    s_lshl_b32 s77, s69, 8
    s_add_u32 s73, s73, s77
    s_lshl_b32 s77, s70, 12
    s_add_u32 m0, s77, 0
    s_add_u32 s75, s73, 0
    buffer_load_dwordx4 v56, s[44:47], s75 offen lds
    s_add_u32 m0, s77, 1024
    s_add_u32 s75, s73, 15360
    buffer_load_dwordx4 v56, s[44:47], s75 offen lds
    s_add_u32 m0, s77, 2048
    s_add_u32 s75, s73, 30720
    buffer_load_dwordx4 v56, s[44:47], s75 offen lds
    s_add_u32 m0, s77, 3072
    s_add_u32 s75, s73, 46080
    buffer_load_dwordx4 v56, s[44:47], s75 offen lds
    s_add_u32 m0, s77, 16384
    s_add_u32 s75, s73, 245760
    buffer_load_dwordx4 v56, s[44:47], s75 offen lds
    s_add_u32 m0, s77, 17408
    s_add_u32 s75, s73, 261120
    buffer_load_dwordx4 v56, s[44:47], s75 offen lds
    s_add_u32 m0, s77, 18432
    s_add_u32 s75, s73, 276480
    buffer_load_dwordx4 v56, s[44:47], s75 offen lds
    s_add_u32 m0, s77, 19456
    s_add_u32 s75, s73, 291840
    buffer_load_dwordx4 v56, s[44:47], s75 offen lds
    s_add_u32 m0, s77, 32768
    s_add_u32 s75, s73, 491520
    buffer_load_dwordx4 v56, s[44:47], s75 offen lds
    s_add_u32 m0, s77, 33792
    s_add_u32 s75, s73, 506880
    buffer_load_dwordx4 v56, s[44:47], s75 offen lds
    s_add_u32 m0, s77, 34816
    s_add_u32 s75, s73, 522240
    buffer_load_dwordx4 v56, s[44:47], s75 offen lds
    s_add_u32 m0, s77, 35840
    s_add_u32 s75, s73, 537600
    buffer_load_dwordx4 v56, s[44:47], s75 offen lds
    s_and_b32 s84, s68, 3
    s_mul_i32 s84, s84, 112
    s_mul_i32 s85, s70, 28
    s_add_u32 s84, s84, s85
    s_add_u32 s84, s84, 192
    s_mul_i32 s84, s84, 3840
    s_lshl_b32 s85, s69, 8
    s_add_u32 s84, s84, s85
    v_lshrrev_b32 v100, 1, v0
    v_min_u32 v100, 27, v100
    v_mul_u32_u24 v100, 3840, v100
    v_and_b32 v101, 1, v0
    v_lshl_add_u32 v100, v101, 7, v100
    buffer_load_dword v102, v100, s[44:47], s84 offen
P1_nopre_16:
    s_barrier
P0_D_4:
    s_barrier
    s_cmp_lg_u32 s40, 0
    s_cbranch_scc1 sig_17
    s_lshl_b32 s94, s2, 6
    s_add_u32 s94, s94, 64
    v_mov_b32 v250, s41
    v_mov_b32 v251, 0
    s_mov_b64 exec, 1
    buffer_store_dword v250, v251, s[96:99], s94 offen sc1
    s_mov_b64 exec, -1
sig_17:
    s_cmp_ge_u32 s69, 15
    s_cbranch_scc1 P1_spare_19
    v_lshlrev_b32 v1, 4, v0
    v_and_b32 v2, 31, v0
    v_lshrrev_b32 v3, 5, v0
    s_cmp_lt_u32 s40, 4
    s_cbranch_scc1 P1_comp_20
    s_sub_u32 s70, s40, 4
    v_lshrrev_b32 v8, 4, v0
    v_bfe_u32 v9, v0, 2, 2
    v_xor_b32 v9, v9, v8
    v_and_b32 v10, 3, v0
    v_mul_u32_u24 v56, 3840, v8
    v_lshl_add_u32 v56, v9, 6, v56
    v_lshl_add_u32 v56, v10, 4, v56
    s_mul_i32 s73, s70, 61440
    s_lshl_b32 s77, s69, 8
    s_add_u32 s73, s73, s77
    s_lshl_b32 s77, s70, 12
    s_add_u32 s48, s38, 0x100000
    s_addc_u32 s49, s39, 0
    s_mov_b32 s50, 0x280000
    s_mov_b32 s51, 0x20000
    v_lshrrev_b32 v8, 3, v0
    v_mul_u32_u24 v8, 1280, v8
    v_and_b32 v9, 7, v0
    v_lshrrev_b32 v10, 4, v0
    v_xor_b32 v11, v9, v10
    v_lshl_add_u32 v57, v11, 4, v8
    v_xor_b32 v11, 4, v11
    v_lshl_add_u32 v58, v11, 4, v8
    s_lshl_b32 s72, s70, 12
    s_lshl_b32 s74, s68, 7
    s_lshl_b32 s76, s70, 5
    s_add_u32 s74, s74, s76
    s_mul_i32 s74, s74, 1280
    s_barrier
    s_add_u32 m0, s72, 65536
    s_add_u32 s75, s74, 0
    buffer_load_dwordx4 v57, s[48:51], s75 offen sc1 lds
    s_add_u32 m0, s72, 66560
    s_add_u32 s75, s74, 10240
    buffer_load_dwordx4 v58, s[48:51], s75 offen sc1 lds
    s_add_u32 m0, s72, 67584
    s_add_u32 s75, s74, 20480
    buffer_load_dwordx4 v57, s[48:51], s75 offen sc1 lds
    s_add_u32 m0, s72, 68608
    s_add_u32 s75, s74, 30720
    buffer_load_dwordx4 v58, s[48:51], s75 offen sc1 lds
    s_add_u32 m0, s72, 81920
    s_add_u32 s75, s74, 128
    buffer_load_dwordx4 v57, s[48:51], s75 offen sc1 lds
    s_add_u32 m0, s72, 82944
    s_add_u32 s75, s74, 10368
    buffer_load_dwordx4 v58, s[48:51], s75 offen sc1 lds
    s_add_u32 m0, s72, 83968
    s_add_u32 s75, s74, 20608
    buffer_load_dwordx4 v57, s[48:51], s75 offen sc1 lds
    s_add_u32 m0, s72, 84992
    s_add_u32 s75, s74, 30848
    buffer_load_dwordx4 v58, s[48:51], s75 offen sc1 lds
    s_waitcnt vmcnt(4)
    s_barrier
    s_add_u32 m0, s72, 98304
    s_add_u32 s75, s74, 256
    buffer_load_dwordx4 v57, s[48:51], s75 offen sc1 lds
    s_add_u32 m0, s72, 99328
    s_add_u32 s75, s74, 10496
    buffer_load_dwordx4 v58, s[48:51], s75 offen sc1 lds
    s_add_u32 m0, s72, 100352
    s_add_u32 s75, s74, 20736
    buffer_load_dwordx4 v57, s[48:51], s75 offen sc1 lds
    s_add_u32 m0, s72, 101376
    s_add_u32 s75, s74, 30976
    buffer_load_dwordx4 v58, s[48:51], s75 offen sc1 lds
    s_add_u32 m0, s77, 49152
    s_add_u32 s75, s73, 737280
    buffer_load_dwordx4 v56, s[44:47], s75 offen lds
    s_add_u32 m0, s77, 50176
    s_add_u32 s75, s73, 752640
    buffer_load_dwordx4 v56, s[44:47], s75 offen lds
    s_add_u32 m0, s77, 51200
    s_add_u32 s75, s73, 768000
    buffer_load_dwordx4 v56, s[44:47], s75 offen lds
    s_add_u32 m0, s77, 52224
    s_add_u32 s75, s73, 783360
    buffer_load_dwordx4 v56, s[44:47], s75 offen lds
    s_waitcnt vmcnt(8)
    s_barrier
    s_add_u32 m0, s72, 65536
    s_add_u32 s75, s74, 384
    buffer_load_dwordx4 v57, s[48:51], s75 offen sc1 lds
    s_add_u32 m0, s72, 66560
    s_add_u32 s75, s74, 10624
    buffer_load_dwordx4 v58, s[48:51], s75 offen sc1 lds
    s_add_u32 m0, s72, 67584
    s_add_u32 s75, s74, 20864
    buffer_load_dwordx4 v57, s[48:51], s75 offen sc1 lds
    s_add_u32 m0, s72, 68608
    s_add_u32 s75, s74, 31104
    buffer_load_dwordx4 v58, s[48:51], s75 offen sc1 lds
    s_add_u32 m0, s77, 0
    s_add_u32 s75, s73, 983040
    buffer_load_dwordx4 v56, s[44:47], s75 offen lds
    s_add_u32 m0, s77, 1024
    s_add_u32 s75, s73, 998400
    buffer_load_dwordx4 v56, s[44:47], s75 offen lds
    s_add_u32 m0, s77, 2048
    s_add_u32 s75, s73, 1013760
    buffer_load_dwordx4 v56, s[44:47], s75 offen lds
    s_add_u32 m0, s77, 3072
    s_add_u32 s75, s73, 1029120
    buffer_load_dwordx4 v56, s[44:47], s75 offen lds
    s_waitcnt vmcnt(12)
    s_barrier
    s_add_u32 m0, s72, 81920
    s_add_u32 s75, s74, 512
    buffer_load_dwordx4 v57, s[48:51], s75 offen sc1 lds
    s_add_u32 m0, s72, 82944
    s_add_u32 s75, s74, 10752
    buffer_load_dwordx4 v58, s[48:51], s75 offen sc1 lds
    s_add_u32 m0, s72, 83968
    s_add_u32 s75, s74, 20992
    buffer_load_dwordx4 v57, s[48:51], s75 offen sc1 lds
    s_add_u32 m0, s72, 84992
    s_add_u32 s75, s74, 31232
    buffer_load_dwordx4 v58, s[48:51], s75 offen sc1 lds
    s_add_u32 m0, s77, 16384
    s_add_u32 s75, s73, 1228800
    buffer_load_dwordx4 v56, s[44:47], s75 offen lds
    s_add_u32 m0, s77, 17408
    s_add_u32 s75, s73, 1244160
    buffer_load_dwordx4 v56, s[44:47], s75 offen lds
    s_add_u32 m0, s77, 18432
    s_add_u32 s75, s73, 1259520
    buffer_load_dwordx4 v56, s[44:47], s75 offen lds
    s_add_u32 m0, s77, 19456
    s_add_u32 s75, s73, 1274880
    buffer_load_dwordx4 v56, s[44:47], s75 offen lds
    s_waitcnt vmcnt(12)
    s_barrier
    s_add_u32 m0, s72, 98304
    s_add_u32 s75, s74, 640
    buffer_load_dwordx4 v57, s[48:51], s75 offen sc1 lds
    s_add_u32 m0, s72, 99328
    s_add_u32 s75, s74, 10880
    buffer_load_dwordx4 v58, s[48:51], s75 offen sc1 lds
    s_add_u32 m0, s72, 100352
    s_add_u32 s75, s74, 21120
    buffer_load_dwordx4 v57, s[48:51], s75 offen sc1 lds
    s_add_u32 m0, s72, 101376
    s_add_u32 s75, s74, 31360
    buffer_load_dwordx4 v58, s[48:51], s75 offen sc1 lds
    s_add_u32 m0, s77, 32768
    s_add_u32 s75, s73, 1474560
    buffer_load_dwordx4 v56, s[44:47], s75 offen lds
    s_add_u32 m0, s77, 33792
    s_add_u32 s75, s73, 1489920
    buffer_load_dwordx4 v56, s[44:47], s75 offen lds
    s_add_u32 m0, s77, 34816
    s_add_u32 s75, s73, 1505280
    buffer_load_dwordx4 v56, s[44:47], s75 offen lds
    s_add_u32 m0, s77, 35840
    s_add_u32 s75, s73, 1520640
    buffer_load_dwordx4 v56, s[44:47], s75 offen lds
    s_waitcnt vmcnt(12)
    s_barrier
    s_add_u32 m0, s72, 65536
    s_add_u32 s75, s74, 768
    buffer_load_dwordx4 v57, s[48:51], s75 offen sc1 lds
    s_add_u32 m0, s72, 66560
    s_add_u32 s75, s74, 11008
    buffer_load_dwordx4 v58, s[48:51], s75 offen sc1 lds
    s_add_u32 m0, s72, 67584
    s_add_u32 s75, s74, 21248
    buffer_load_dwordx4 v57, s[48:51], s75 offen sc1 lds
    s_add_u32 m0, s72, 68608
    s_add_u32 s75, s74, 31488
    buffer_load_dwordx4 v58, s[48:51], s75 offen sc1 lds
    s_add_u32 m0, s77, 49152
    s_add_u32 s75, s73, 1720320
    buffer_load_dwordx4 v56, s[44:47], s75 offen lds
    s_add_u32 m0, s77, 50176
    s_add_u32 s75, s73, 1735680
    buffer_load_dwordx4 v56, s[44:47], s75 offen lds
    s_add_u32 m0, s77, 51200
    s_add_u32 s75, s73, 1751040
    buffer_load_dwordx4 v56, s[44:47], s75 offen lds
    s_add_u32 m0, s77, 52224
    s_add_u32 s75, s73, 1766400
    buffer_load_dwordx4 v56, s[44:47], s75 offen lds
    s_waitcnt vmcnt(12)
    s_barrier
    s_add_u32 m0, s72, 81920
    s_add_u32 s75, s74, 896
    buffer_load_dwordx4 v57, s[48:51], s75 offen sc1 lds
    s_add_u32 m0, s72, 82944
    s_add_u32 s75, s74, 11136
    buffer_load_dwordx4 v58, s[48:51], s75 offen sc1 lds
    s_add_u32 m0, s72, 83968
    s_add_u32 s75, s74, 21376
    buffer_load_dwordx4 v57, s[48:51], s75 offen sc1 lds
    s_add_u32 m0, s72, 84992
    s_add_u32 s75, s74, 31616
    buffer_load_dwordx4 v58, s[48:51], s75 offen sc1 lds
    s_add_u32 m0, s77, 0
    s_add_u32 s75, s73, 1966080
    buffer_load_dwordx4 v56, s[44:47], s75 offen lds
    s_add_u32 m0, s77, 1024
    s_add_u32 s75, s73, 1981440
    buffer_load_dwordx4 v56, s[44:47], s75 offen lds
    s_add_u32 m0, s77, 2048
    s_add_u32 s75, s73, 1996800
    buffer_load_dwordx4 v56, s[44:47], s75 offen lds
    s_add_u32 m0, s77, 3072
    s_add_u32 s75, s73, 2012160
    buffer_load_dwordx4 v56, s[44:47], s75 offen lds
    s_waitcnt vmcnt(12)
    s_barrier
    s_add_u32 m0, s72, 98304
    s_add_u32 s75, s74, 1024
    buffer_load_dwordx4 v57, s[48:51], s75 offen sc1 lds
    s_add_u32 m0, s72, 99328
    s_add_u32 s75, s74, 11264
    buffer_load_dwordx4 v58, s[48:51], s75 offen sc1 lds
    s_add_u32 m0, s72, 100352
    s_add_u32 s75, s74, 21504
    buffer_load_dwordx4 v57, s[48:51], s75 offen sc1 lds
    s_add_u32 m0, s72, 101376
    s_add_u32 s75, s74, 31744
    buffer_load_dwordx4 v58, s[48:51], s75 offen sc1 lds
    s_add_u32 m0, s77, 16384
    s_add_u32 s75, s73, 2211840
    buffer_load_dwordx4 v56, s[44:47], s75 offen lds
    s_add_u32 m0, s77, 17408
    s_add_u32 s75, s73, 2227200
    buffer_load_dwordx4 v56, s[44:47], s75 offen lds
    s_add_u32 m0, s77, 18432
    s_add_u32 s75, s73, 2242560
    buffer_load_dwordx4 v56, s[44:47], s75 offen lds
    s_add_u32 m0, s77, 19456
    s_add_u32 s75, s73, 2257920
    buffer_load_dwordx4 v56, s[44:47], s75 offen lds
    s_waitcnt vmcnt(12)
    s_barrier
    s_add_u32 m0, s72, 65536
    s_add_u32 s75, s74, 1152
    buffer_load_dwordx4 v57, s[48:51], s75 offen sc1 lds
    s_add_u32 m0, s72, 66560
    s_add_u32 s75, s74, 11392
    buffer_load_dwordx4 v58, s[48:51], s75 offen sc1 lds
    s_add_u32 m0, s72, 67584
    s_add_u32 s75, s74, 21632
    buffer_load_dwordx4 v57, s[48:51], s75 offen sc1 lds
    s_add_u32 m0, s72, 68608
    s_add_u32 s75, s74, 31872
    buffer_load_dwordx4 v58, s[48:51], s75 offen sc1 lds
    s_waitcnt vmcnt(8)
    s_barrier
    s_waitcnt vmcnt(0)
    s_barrier
    s_branch P1_fin_21
P1_comp_20:
    s_lshl_b32 s71, s40, 12
    s_add_u32 s71, s71, 65536
    v_lshlrev_b32 v8, 7, v2
    v_add_u32 v8, s71, v8
    v_bfe_u32 v9, v2, 1, 3
    v_add_u32 v10, 0, v3
    v_xor_b32 v10, v10, v9
    v_lshl_add_u32 v44, v10, 4, v8
    v_add_u32 v10, 2, v3
    v_xor_b32 v10, v10, v9
    v_lshl_add_u32 v45, v10, 4, v8
    v_add_u32 v10, 4, v3
    v_xor_b32 v10, v10, v9
    v_lshl_add_u32 v46, v10, 4, v8
    v_add_u32 v10, 6, v3
    v_xor_b32 v10, v10, v9
    v_lshl_add_u32 v47, v10, 4, v8
    v_bfe_u32 v8, v0, 2, 2
    v_bfe_u32 v9, v0, 4, 1
    v_and_b32 v10, 3, v0
    v_lshl_add_u32 v11, v3, 3, v8
    v_lshlrev_b32 v11, 8, v11
    v_lshl_add_u32 v11, v9, 5, v11
    v_lshl_add_u32 v11, v10, 3, v11
    v_xor_b32 v12, 0, v8
    v_lshl_add_u32 v40, v12, 6, v11
    v_xor_b32 v12, 1, v8
    v_lshl_add_u32 v41, v12, 6, v11
    v_xor_b32 v12, 2, v8
    v_lshl_add_u32 v42, v12, 6, v11
    v_xor_b32 v12, 3, v8
    v_lshl_add_u32 v43, v12, 6, v11
    s_lshl_b32 s72, s68, 2
    s_add_u32 s72, s72, s40
    s_cmp_ge_u32 s69, 10
    s_cbranch_scc1 P1_v_22
    s_mov_b32 s73, 2560
    s_mov_b32 s74, 12582912
    s_cmp_lt_u32 s69, 5
    s_cselect_b32 s73, 1280, s73
    s_cselect_b32 s74, 8388608, s74
    s_cselect_b32 s76, 0x3ea52b5c, 1.0
    s_cselect_b32 s75, 0, 5
    s_sub_u32 s75, s69, s75
    s_add_u32 s56, s38, s74
    s_addc_u32 s57, s39, 0
    s_mov_b32 s58, 0x500000
    s_mov_b32 s59, 0x20000
    s_mul_i32 s78, s72, s73
    s_lshl_b32 s79, s73, 6
    s_lshl_b32 s80, s75, 5
    v_add_u32 v5, s80, v3
    v_lshlrev_b32 v6, 3, v2
    v_add_u32 v8, 0, v5
    v_mul_u32_u24 v9, 0xcccd, v8
    v_lshrrev_b32 v9, 18, v9
    v_mul_u32_u24 v10, 5, v9
    v_sub_u32 v10, v8, v10
    v_mul_lo_u32 v128, v9, s79
    v_lshl_add_u32 v10, v10, 8, v6
    v_add_u32 v128, v128, v10
    v_add_u32 v8, 2, v5
    v_mul_u32_u24 v9, 0xcccd, v8
    v_lshrrev_b32 v9, 18, v9
    v_mul_u32_u24 v10, 5, v9
    v_sub_u32 v10, v8, v10
    v_mul_lo_u32 v129, v9, s79
    v_lshl_add_u32 v10, v10, 8, v6
    v_add_u32 v129, v129, v10
    v_add_u32 v8, 4, v5
    v_mul_u32_u24 v9, 0xcccd, v8
    v_lshrrev_b32 v9, 18, v9
    v_mul_u32_u24 v10, 5, v9
    v_sub_u32 v10, v8, v10
    v_mul_lo_u32 v130, v9, s79
    v_lshl_add_u32 v10, v10, 8, v6
    v_add_u32 v130, v130, v10
    v_add_u32 v8, 6, v5
    v_mul_u32_u24 v9, 0xcccd, v8
    v_lshrrev_b32 v9, 18, v9
    v_mul_u32_u24 v10, 5, v9
    v_sub_u32 v10, v8, v10
    v_mul_lo_u32 v131, v9, s79
    v_lshl_add_u32 v10, v10, 8, v6
    v_add_u32 v131, v131, v10
    v_add_u32 v8, 8, v5
    v_mul_u32_u24 v9, 0xcccd, v8
    v_lshrrev_b32 v9, 18, v9
    v_mul_u32_u24 v10, 5, v9
    v_sub_u32 v10, v8, v10
    v_mul_lo_u32 v132, v9, s79
    v_lshl_add_u32 v10, v10, 8, v6
    v_add_u32 v132, v132, v10
    v_add_u32 v8, 10, v5
    v_mul_u32_u24 v9, 0xcccd, v8
    v_lshrrev_b32 v9, 18, v9
    v_mul_u32_u24 v10, 5, v9
    v_sub_u32 v10, v8, v10
    v_mul_lo_u32 v133, v9, s79
    v_lshl_add_u32 v10, v10, 8, v6
    v_add_u32 v133, v133, v10
    v_add_u32 v8, 12, v5
    v_mul_u32_u24 v9, 0xcccd, v8
    v_lshrrev_b32 v9, 18, v9
    v_mul_u32_u24 v10, 5, v9
    v_sub_u32 v10, v8, v10
    v_mul_lo_u32 v134, v9, s79
    v_lshl_add_u32 v10, v10, 8, v6
    v_add_u32 v134, v134, v10
    v_add_u32 v8, 14, v5
    v_mul_u32_u24 v9, 0xcccd, v8
    v_lshrrev_b32 v9, 18, v9
    v_mul_u32_u24 v10, 5, v9
    v_sub_u32 v10, v8, v10
    v_mul_lo_u32 v135, v9, s79
    v_lshl_add_u32 v10, v10, 8, v6
    v_add_u32 v135, v135, v10
    v_add_u32 v8, 16, v5
    v_mul_u32_u24 v9, 0xcccd, v8
    v_lshrrev_b32 v9, 18, v9
    v_mul_u32_u24 v10, 5, v9
    v_sub_u32 v10, v8, v10
    v_mul_lo_u32 v136, v9, s79
    v_lshl_add_u32 v10, v10, 8, v6
    v_add_u32 v136, v136, v10
    v_add_u32 v8, 18, v5
    v_mul_u32_u24 v9, 0xcccd, v8
    v_lshrrev_b32 v9, 18, v9
    v_mul_u32_u24 v10, 5, v9
    v_sub_u32 v10, v8, v10
    v_mul_lo_u32 v137, v9, s79
    v_lshl_add_u32 v10, v10, 8, v6
    v_add_u32 v137, v137, v10
    v_add_u32 v8, 20, v5
    v_mul_u32_u24 v9, 0xcccd, v8
    v_lshrrev_b32 v9, 18, v9
    v_mul_u32_u24 v10, 5, v9
    v_sub_u32 v10, v8, v10
    v_mul_lo_u32 v138, v9, s79
    v_lshl_add_u32 v10, v10, 8, v6
    v_add_u32 v138, v138, v10
    v_add_u32 v8, 22, v5
    v_mul_u32_u24 v9, 0xcccd, v8
    v_lshrrev_b32 v9, 18, v9
    v_mul_u32_u24 v10, 5, v9
    v_sub_u32 v10, v8, v10
    v_mul_lo_u32 v139, v9, s79
    v_lshl_add_u32 v10, v10, 8, v6
    v_add_u32 v139, v139, v10
    v_add_u32 v8, 24, v5
    v_mul_u32_u24 v9, 0xcccd, v8
    v_lshrrev_b32 v9, 18, v9
    v_mul_u32_u24 v10, 5, v9
    v_sub_u32 v10, v8, v10
    v_mul_lo_u32 v140, v9, s79
    v_lshl_add_u32 v10, v10, 8, v6
    v_add_u32 v140, v140, v10
    v_add_u32 v8, 26, v5
    v_mul_u32_u24 v9, 0xcccd, v8
    v_lshrrev_b32 v9, 18, v9
    v_mul_u32_u24 v10, 5, v9
    v_sub_u32 v10, v8, v10
    v_mul_lo_u32 v141, v9, s79
    v_lshl_add_u32 v10, v10, 8, v6
    v_add_u32 v141, v141, v10
    v_add_u32 v8, 28, v5
    v_mul_u32_u24 v9, 0xcccd, v8
    v_lshrrev_b32 v9, 18, v9
    v_mul_u32_u24 v10, 5, v9
    v_sub_u32 v10, v8, v10
    v_mul_lo_u32 v142, v9, s79
    v_lshl_add_u32 v10, v10, 8, v6
    v_add_u32 v142, v142, v10
    v_add_u32 v8, 30, v5
    v_mul_u32_u24 v9, 0xcccd, v8
    v_lshrrev_b32 v9, 18, v9
    v_mul_u32_u24 v10, 5, v9
    v_sub_u32 v10, v8, v10
    v_mul_lo_u32 v143, v9, s79
    v_lshl_add_u32 v10, v10, 8, v6
    v_add_u32 v143, v143, v10
    s_lshl_b32 s71, s68, 4
    v_and_b32 v240, 15, v0
    v_add_u32 v240, s71, v240
    s_cmp_lg_u32 s40, 0
    s_cbranch_scc1 wf_23
    s_cmp_lg_u32 s42, 0
    s_cbranch_scc1 wf_23
    v_lshlrev_b32 v240, 6, v240
    v_add_u32 v240, 64, v240
    s_mov_b32 s94, 30000
wf_poll_24:
    buffer_load_dword v250, v240, s[96:99], 0 offen sc1
    s_waitcnt vmcnt(0)
    v_cmp_ne_u32 vcc, s41, v250
    s_nop 1
    s_cbranch_vccz wf_23
    s_sleep 1
    s_sub_u32 s94, s94, 1
    s_cmp_lg_u32 s94, 0
    s_cbranch_scc1 wf_poll_24
wf_done_25:
    s_mov_b32 s42, 1
wf_23:
    s_barrier
    s_barrier
    ds_read_b128 v[32:35], v44 offset:0
    ds_read_b64_tr_b16 v[16:17], v40 offset:0
    ds_read_b64_tr_b16 v[18:19], v40 offset:1024
    ds_read_b64_tr_b16 v[20:21], v41 offset:0
    ds_read_b64_tr_b16 v[22:23], v41 offset:1024
    ds_read_b64_tr_b16 v[24:25], v42 offset:0
    ds_read_b64_tr_b16 v[26:27], v42 offset:1024
    ds_read_b64_tr_b16 v[28:29], v43 offset:0
    ds_read_b64_tr_b16 v[30:31], v43 offset:1024
    s_waitcnt lgkmcnt(6)
    v_mfma_f32_32x32x16_bf16 v[64:79], v[16:19], v[32:35], 0
    ds_read_b128 v[36:39], v45 offset:0
    ds_read_b64_tr_b16 v[16:17], v40 offset:4096
    ds_read_b64_tr_b16 v[18:19], v40 offset:5120
    s_waitcnt lgkmcnt(7)
    v_mfma_f32_32x32x16_bf16 v[80:95], v[20:23], v[32:35], 0
    ds_read_b64_tr_b16 v[20:21], v41 offset:4096
    ds_read_b64_tr_b16 v[22:23], v41 offset:5120
    s_waitcnt lgkmcnt(7)
    v_mfma_f32_32x32x16_bf16 v[96:111], v[24:27], v[32:35], 0
    ds_read_b64_tr_b16 v[24:25], v42 offset:4096
    ds_read_b64_tr_b16 v[26:27], v42 offset:5120
    s_waitcnt lgkmcnt(7)
    v_mfma_f32_32x32x16_bf16 v[112:127], v[28:31], v[32:35], 0
    ds_read_b64_tr_b16 v[28:29], v43 offset:4096
    ds_read_b64_tr_b16 v[30:31], v43 offset:5120
    s_waitcnt lgkmcnt(6)
    v_mfma_f32_32x32x16_bf16 v[64:79], v[16:19], v[36:39], v[64:79]
    ds_read_b128 v[32:35], v46 offset:0
    ds_read_b64_tr_b16 v[16:17], v40 offset:8192
    ds_read_b64_tr_b16 v[18:19], v40 offset:9216
    s_waitcnt lgkmcnt(7)
    v_mfma_f32_32x32x16_bf16 v[80:95], v[20:23], v[36:39], v[80:95]
    ds_read_b64_tr_b16 v[20:21], v41 offset:8192
    ds_read_b64_tr_b16 v[22:23], v41 offset:9216
    s_waitcnt lgkmcnt(7)
    v_mfma_f32_32x32x16_bf16 v[96:111], v[24:27], v[36:39], v[96:111]
    ds_read_b64_tr_b16 v[24:25], v42 offset:8192
    ds_read_b64_tr_b16 v[26:27], v42 offset:9216
    s_waitcnt lgkmcnt(7)
    v_mfma_f32_32x32x16_bf16 v[112:127], v[28:31], v[36:39], v[112:127]
    ds_read_b64_tr_b16 v[28:29], v43 offset:8192
    ds_read_b64_tr_b16 v[30:31], v43 offset:9216
    s_waitcnt lgkmcnt(6)
    v_mfma_f32_32x32x16_bf16 v[64:79], v[16:19], v[32:35], v[64:79]
    ds_read_b128 v[36:39], v47 offset:0
    ds_read_b64_tr_b16 v[16:17], v40 offset:12288
    ds_read_b64_tr_b16 v[18:19], v40 offset:13312
    s_waitcnt lgkmcnt(7)
    v_mfma_f32_32x32x16_bf16 v[80:95], v[20:23], v[32:35], v[80:95]
    ds_read_b64_tr_b16 v[20:21], v41 offset:12288
    ds_read_b64_tr_b16 v[22:23], v41 offset:13312
    s_waitcnt lgkmcnt(7)
    v_mfma_f32_32x32x16_bf16 v[96:111], v[24:27], v[32:35], v[96:111]
    ds_read_b64_tr_b16 v[24:25], v42 offset:12288
    ds_read_b64_tr_b16 v[26:27], v42 offset:13312
    s_waitcnt lgkmcnt(7)
    v_mfma_f32_32x32x16_bf16 v[112:127], v[28:31], v[32:35], v[112:127]
    ds_read_b64_tr_b16 v[28:29], v43 offset:12288
    ds_read_b64_tr_b16 v[30:31], v43 offset:13312
    s_waitcnt lgkmcnt(6)
    v_mfma_f32_32x32x16_bf16 v[64:79], v[16:19], v[36:39], v[64:79]
    s_waitcnt lgkmcnt(4)
    v_mfma_f32_32x32x16_bf16 v[80:95], v[20:23], v[36:39], v[80:95]
    s_waitcnt lgkmcnt(0)
    s_barrier
    ds_read_b128 v[32:35], v44 offset:16384
    ds_read_b64_tr_b16 v[16:17], v40 offset:16384
    ds_read_b64_tr_b16 v[18:19], v40 offset:17408
    ds_read_b64_tr_b16 v[20:21], v41 offset:16384
    ds_read_b64_tr_b16 v[22:23], v41 offset:17408
    v_mfma_f32_32x32x16_bf16 v[96:111], v[24:27], v[36:39], v[96:111]
    ds_read_b64_tr_b16 v[24:25], v42 offset:16384
    ds_read_b64_tr_b16 v[26:27], v42 offset:17408
    v_mfma_f32_32x32x16_bf16 v[112:127], v[28:31], v[36:39], v[112:127]
    ds_read_b64_tr_b16 v[28:29], v43 offset:16384
    ds_read_b64_tr_b16 v[30:31], v43 offset:17408
    s_waitcnt lgkmcnt(6)
    v_mfma_f32_32x32x16_bf16 v[64:79], v[16:19], v[32:35], v[64:79]
    ds_read_b128 v[36:39], v45 offset:16384
    ds_read_b64_tr_b16 v[16:17], v40 offset:20480
    ds_read_b64_tr_b16 v[18:19], v40 offset:21504
    s_waitcnt lgkmcnt(7)
    v_mfma_f32_32x32x16_bf16 v[80:95], v[20:23], v[32:35], v[80:95]
    ds_read_b64_tr_b16 v[20:21], v41 offset:20480
    ds_read_b64_tr_b16 v[22:23], v41 offset:21504
    s_waitcnt lgkmcnt(7)
    v_mfma_f32_32x32x16_bf16 v[96:111], v[24:27], v[32:35], v[96:111]
    ds_read_b64_tr_b16 v[24:25], v42 offset:20480
    ds_read_b64_tr_b16 v[26:27], v42 offset:21504
    s_waitcnt lgkmcnt(7)
    v_mfma_f32_32x32x16_bf16 v[112:127], v[28:31], v[32:35], v[112:127]
    ds_read_b64_tr_b16 v[28:29], v43 offset:20480
    ds_read_b64_tr_b16 v[30:31], v43 offset:21504
    s_waitcnt lgkmcnt(6)
    v_mfma_f32_32x32x16_bf16 v[64:79], v[16:19], v[36:39], v[64:79]
    ds_read_b128 v[32:35], v46 offset:16384
    ds_read_b64_tr_b16 v[16:17], v40 offset:24576
    ds_read_b64_tr_b16 v[18:19], v40 offset:25600
    s_waitcnt lgkmcnt(7)
    v_mfma_f32_32x32x16_bf16 v[80:95], v[20:23], v[36:39], v[80:95]
    ds_read_b64_tr_b16 v[20:21], v41 offset:24576
    ds_read_b64_tr_b16 v[22:23], v41 offset:25600
    s_waitcnt lgkmcnt(7)
    v_mfma_f32_32x32x16_bf16 v[96:111], v[24:27], v[36:39], v[96:111]
    ds_read_b64_tr_b16 v[24:25], v42 offset:24576
    ds_read_b64_tr_b16 v[26:27], v42 offset:25600
    s_waitcnt lgkmcnt(7)
    v_mfma_f32_32x32x16_bf16 v[112:127], v[28:31], v[36:39], v[112:127]
    ds_read_b64_tr_b16 v[28:29], v43 offset:24576
    ds_read_b64_tr_b16 v[30:31], v43 offset:25600
    s_waitcnt lgkmcnt(6)
    v_mfma_f32_32x32x16_bf16 v[64:79], v[16:19], v[32:35], v[64:79]
    ds_read_b128 v[36:39], v47 offset:16384
    ds_read_b64_tr_b16 v[16:17], v40 offset:28672
    ds_read_b64_tr_b16 v[18:19], v40 offset:29696
    s_waitcnt lgkmcnt(7)
    v_mfma_f32_32x32x16_bf16 v[80:95], v[20:23], v[32:35], v[80:95]
    ds_read_b64_tr_b16 v[20:21], v41 offset:28672
    ds_read_b64_tr_b16 v[22:23], v41 offset:29696
    s_waitcnt lgkmcnt(7)
    v_mfma_f32_32x32x16_bf16 v[96:111], v[24:27], v[32:35], v[96:111]
    ds_read_b64_tr_b16 v[24:25], v42 offset:28672
    ds_read_b64_tr_b16 v[26:27], v42 offset:29696
    s_waitcnt lgkmcnt(7)
    v_mfma_f32_32x32x16_bf16 v[112:127], v[28:31], v[32:35], v[112:127]
    ds_read_b64_tr_b16 v[28:29], v43 offset:28672
    ds_read_b64_tr_b16 v[30:31], v43 offset:29696
    s_waitcnt lgkmcnt(6)
    v_mfma_f32_32x32x16_bf16 v[64:79], v[16:19], v[36:39], v[64:79]
    s_waitcnt lgkmcnt(4)
    v_mfma_f32_32x32x16_bf16 v[80:95], v[20:23], v[36:39], v[80:95]
    s_waitcnt lgkmcnt(0)
    s_barrier
    ds_read_b128 v[32:35], v44 offset:32768
    ds_read_b64_tr_b16 v[16:17], v40 offset:32768
    ds_read_b64_tr_b16 v[18:19], v40 offset:33792
    ds_read_b64_tr_b16 v[20:21], v41 offset:32768
    ds_read_b64_tr_b16 v[22:23], v41 offset:33792
    v_mfma_f32_32x32x16_bf16 v[96:111], v[24:27], v[36:39], v[96:111]
    ds_read_b64_tr_b16 v[24:25], v42 offset:32768
    ds_read_b64_tr_b16 v[26:27], v42 offset:33792
    v_mfma_f32_32x32x16_bf16 v[112:127], v[28:31], v[36:39], v[112:127]
    ds_read_b64_tr_b16 v[28:29], v43 offset:32768
    ds_read_b64_tr_b16 v[30:31], v43 offset:33792
    s_waitcnt lgkmcnt(6)
    v_mfma_f32_32x32x16_bf16 v[64:79], v[16:19], v[32:35], v[64:79]
    ds_read_b128 v[36:39], v45 offset:32768
    ds_read_b64_tr_b16 v[16:17], v40 offset:36864
    ds_read_b64_tr_b16 v[18:19], v40 offset:37888
    s_waitcnt lgkmcnt(7)
    v_mfma_f32_32x32x16_bf16 v[80:95], v[20:23], v[32:35], v[80:95]
    ds_read_b64_tr_b16 v[20:21], v41 offset:36864
    ds_read_b64_tr_b16 v[22:23], v41 offset:37888
    s_waitcnt lgkmcnt(7)
    v_mfma_f32_32x32x16_bf16 v[96:111], v[24:27], v[32:35], v[96:111]
    ds_read_b64_tr_b16 v[24:25], v42 offset:36864
    ds_read_b64_tr_b16 v[26:27], v42 offset:37888
    s_waitcnt lgkmcnt(7)
    v_mfma_f32_32x32x16_bf16 v[112:127], v[28:31], v[32:35], v[112:127]
    ds_read_b64_tr_b16 v[28:29], v43 offset:36864
    ds_read_b64_tr_b16 v[30:31], v43 offset:37888
    s_waitcnt lgkmcnt(6)
    v_mfma_f32_32x32x16_bf16 v[64:79], v[16:19], v[36:39], v[64:79]
    ds_read_b128 v[32:35], v46 offset:32768
    ds_read_b64_tr_b16 v[16:17], v40 offset:40960
    ds_read_b64_tr_b16 v[18:19], v40 offset:41984
    s_waitcnt lgkmcnt(7)
    v_mfma_f32_32x32x16_bf16 v[80:95], v[20:23], v[36:39], v[80:95]
    ds_read_b64_tr_b16 v[20:21], v41 offset:40960
    ds_read_b64_tr_b16 v[22:23], v41 offset:41984
    s_waitcnt lgkmcnt(7)
    v_mfma_f32_32x32x16_bf16 v[96:111], v[24:27], v[36:39], v[96:111]
    ds_read_b64_tr_b16 v[24:25], v42 offset:40960
    ds_read_b64_tr_b16 v[26:27], v42 offset:41984
    s_waitcnt lgkmcnt(7)
    v_mfma_f32_32x32x16_bf16 v[112:127], v[28:31], v[36:39], v[112:127]
    ds_read_b64_tr_b16 v[28:29], v43 offset:40960
    ds_read_b64_tr_b16 v[30:31], v43 offset:41984
    s_waitcnt lgkmcnt(6)
    v_mfma_f32_32x32x16_bf16 v[64:79], v[16:19], v[32:35], v[64:79]
    ds_read_b128 v[36:39], v47 offset:32768
    ds_read_b64_tr_b16 v[16:17], v40 offset:45056
    ds_read_b64_tr_b16 v[18:19], v40 offset:46080
    s_waitcnt lgkmcnt(7)
    v_mfma_f32_32x32x16_bf16 v[80:95], v[20:23], v[32:35], v[80:95]
    ds_read_b64_tr_b16 v[20:21], v41 offset:45056
    ds_read_b64_tr_b16 v[22:23], v41 offset:46080
    s_waitcnt lgkmcnt(7)
    v_mfma_f32_32x32x16_bf16 v[96:111], v[24:27], v[32:35], v[96:111]
    ds_read_b64_tr_b16 v[24:25], v42 offset:45056
    ds_read_b64_tr_b16 v[26:27], v42 offset:46080
    s_waitcnt lgkmcnt(7)
    v_mfma_f32_32x32x16_bf16 v[112:127], v[28:31], v[32:35], v[112:127]
    ds_read_b64_tr_b16 v[28:29], v43 offset:45056
    ds_read_b64_tr_b16 v[30:31], v43 offset:46080
    s_waitcnt lgkmcnt(6)
    v_mfma_f32_32x32x16_bf16 v[64:79], v[16:19], v[36:39], v[64:79]
    s_waitcnt lgkmcnt(4)
    v_mfma_f32_32x32x16_bf16 v[80:95], v[20:23], v[36:39], v[80:95]
    s_waitcnt lgkmcnt(0)
    s_barrier
    ds_read_b128 v[32:35], v44 offset:0
    ds_read_b64_tr_b16 v[16:17], v40 offset:49152
    ds_read_b64_tr_b16 v[18:19], v40 offset:50176
    ds_read_b64_tr_b16 v[20:21], v41 offset:49152
    ds_read_b64_tr_b16 v[22:23], v41 offset:50176
    v_mfma_f32_32x32x16_bf16 v[96:111], v[24:27], v[36:39], v[96:111]
    ds_read_b64_tr_b16 v[24:25], v42 offset:49152
    ds_read_b64_tr_b16 v[26:27], v42 offset:50176
    v_mfma_f32_32x32x16_bf16 v[112:127], v[28:31], v[36:39], v[112:127]
    ds_read_b64_tr_b16 v[28:29], v43 offset:49152
    ds_read_b64_tr_b16 v[30:31], v43 offset:50176
    s_waitcnt lgkmcnt(6)
    v_mfma_f32_32x32x16_bf16 v[64:79], v[16:19], v[32:35], v[64:79]
    ds_read_b128 v[36:39], v45 offset:0
    ds_read_b64_tr_b16 v[16:17], v40 offset:53248
    ds_read_b64_tr_b16 v[18:19], v40 offset:54272
    s_waitcnt lgkmcnt(7)
    v_mfma_f32_32x32x16_bf16 v[80:95], v[20:23], v[32:35], v[80:95]
    ds_read_b64_tr_b16 v[20:21], v41 offset:53248
    ds_read_b64_tr_b16 v[22:23], v41 offset:54272
    s_waitcnt lgkmcnt(7)
    v_mfma_f32_32x32x16_bf16 v[96:111], v[24:27], v[32:35], v[96:111]
    ds_read_b64_tr_b16 v[24:25], v42 offset:53248
    ds_read_b64_tr_b16 v[26:27], v42 offset:54272
    s_waitcnt lgkmcnt(7)
    v_mfma_f32_32x32x16_bf16 v[112:127], v[28:31], v[32:35], v[112:127]
    ds_read_b64_tr_b16 v[28:29], v43 offset:53248
    ds_read_b64_tr_b16 v[30:31], v43 offset:54272
    s_waitcnt lgkmcnt(6)
    v_mfma_f32_32x32x16_bf16 v[64:79], v[16:19], v[36:39], v[64:79]
    ds_read_b128 v[32:35], v46 offset:0
    ds_read_b64_tr_b16 v[16:17], v40 offset:57344
    ds_read_b64_tr_b16 v[18:19], v40 offset:58368
    s_waitcnt lgkmcnt(7)
    v_mfma_f32_32x32x16_bf16 v[80:95], v[20:23], v[36:39], v[80:95]
    ds_read_b64_tr_b16 v[20:21], v41 offset:57344
    ds_read_b64_tr_b16 v[22:23], v41 offset:58368
    s_waitcnt lgkmcnt(7)
    v_mfma_f32_32x32x16_bf16 v[96:111], v[24:27], v[36:39], v[96:111]
    ds_read_b64_tr_b16 v[24:25], v42 offset:57344
    ds_read_b64_tr_b16 v[26:27], v42 offset:58368
    s_waitcnt lgkmcnt(7)
    v_mfma_f32_32x32x16_bf16 v[112:127], v[28:31], v[36:39], v[112:127]
    ds_read_b64_tr_b16 v[28:29], v43 offset:57344
    ds_read_b64_tr_b16 v[30:31], v43 offset:58368
    s_waitcnt lgkmcnt(6)
    v_mfma_f32_32x32x16_bf16 v[64:79], v[16:19], v[32:35], v[64:79]
    ds_read_b128 v[36:39], v47 offset:0
    ds_read_b64_tr_b16 v[16:17], v40 offset:61440
    ds_read_b64_tr_b16 v[18:19], v40 offset:62464
    s_waitcnt lgkmcnt(7)
    v_mfma_f32_32x32x16_bf16 v[80:95], v[20:23], v[32:35], v[80:95]
    ds_read_b64_tr_b16 v[20:21], v41 offset:61440
    ds_read_b64_tr_b16 v[22:23], v41 offset:62464
    s_waitcnt lgkmcnt(7)
    v_mfma_f32_32x32x16_bf16 v[96:111], v[24:27], v[32:35], v[96:111]
    ds_read_b64_tr_b16 v[24:25], v42 offset:61440
    ds_read_b64_tr_b16 v[26:27], v42 offset:62464
    s_waitcnt lgkmcnt(7)
    v_mfma_f32_32x32x16_bf16 v[112:127], v[28:31], v[32:35], v[112:127]
    ds_read_b64_tr_b16 v[28:29], v43 offset:61440
    ds_read_b64_tr_b16 v[30:31], v43 offset:62464
    s_waitcnt lgkmcnt(6)
    v_mfma_f32_32x32x16_bf16 v[64:79], v[16:19], v[36:39], v[64:79]
    s_waitcnt lgkmcnt(4)
    v_mfma_f32_32x32x16_bf16 v[80:95], v[20:23], v[36:39], v[80:95]
    s_waitcnt lgkmcnt(0)
    s_barrier
    ds_read_b128 v[32:35], v44 offset:16384
    ds_read_b64_tr_b16 v[16:17], v40 offset:0
    ds_read_b64_tr_b16 v[18:19], v40 offset:1024
    ds_read_b64_tr_b16 v[20:21], v41 offset:0
    ds_read_b64_tr_b16 v[22:23], v41 offset:1024
    v_mfma_f32_32x32x16_bf16 v[96:111], v[24:27], v[36:39], v[96:111]
    ds_read_b64_tr_b16 v[24:25], v42 offset:0
    ds_read_b64_tr_b16 v[26:27], v42 offset:1024
    v_mfma_f32_32x32x16_bf16 v[112:127], v[28:31], v[36:39], v[112:127]
    ds_read_b64_tr_b16 v[28:29], v43 offset:0
    ds_read_b64_tr_b16 v[30:31], v43 offset:1024
    s_waitcnt lgkmcnt(6)
    v_mfma_f32_32x32x16_bf16 v[64:79], v[16:19], v[32:35], v[64:79]
    ds_read_b128 v[36:39], v45 offset:16384
    ds_read_b64_tr_b16 v[16:17], v40 offset:4096
    ds_read_b64_tr_b16 v[18:19], v40 offset:5120
    s_waitcnt lgkmcnt(7)
    v_mfma_f32_32x32x16_bf16 v[80:95], v[20:23], v[32:35], v[80:95]
    ds_read_b64_tr_b16 v[20:21], v41 offset:4096
    ds_read_b64_tr_b16 v[22:23], v41 offset:5120
    s_waitcnt lgkmcnt(7)
    v_mfma_f32_32x32x16_bf16 v[96:111], v[24:27], v[32:35], v[96:111]
    ds_read_b64_tr_b16 v[24:25], v42 offset:4096
    ds_read_b64_tr_b16 v[26:27], v42 offset:5120
    s_waitcnt lgkmcnt(7)
    v_mfma_f32_32x32x16_bf16 v[112:127], v[28:31], v[32:35], v[112:127]
    ds_read_b64_tr_b16 v[28:29], v43 offset:4096
    ds_read_b64_tr_b16 v[30:31], v43 offset:5120
    s_waitcnt lgkmcnt(6)
    v_mfma_f32_32x32x16_bf16 v[64:79], v[16:19], v[36:39], v[64:79]
    ds_read_b128 v[32:35], v46 offset:16384
    ds_read_b64_tr_b16 v[16:17], v40 offset:8192
    ds_read_b64_tr_b16 v[18:19], v40 offset:9216
    s_waitcnt lgkmcnt(7)
    v_mfma_f32_32x32x16_bf16 v[80:95], v[20:23], v[36:39], v[80:95]
    ds_read_b64_tr_b16 v[20:21], v41 offset:8192
    ds_read_b64_tr_b16 v[22:23], v41 offset:9216
    s_waitcnt lgkmcnt(7)
    v_mfma_f32_32x32x16_bf16 v[96:111], v[24:27], v[36:39], v[96:111]
    ds_read_b64_tr_b16 v[24:25], v42 offset:8192
    ds_read_b64_tr_b16 v[26:27], v42 offset:9216
    s_waitcnt lgkmcnt(7)
    v_mfma_f32_32x32x16_bf16 v[112:127], v[28:31], v[36:39], v[112:127]
    ds_read_b64_tr_b16 v[28:29], v43 offset:8192
    ds_read_b64_tr_b16 v[30:31], v43 offset:9216
    s_waitcnt lgkmcnt(6)
    v_mfma_f32_32x32x16_bf16 v[64:79], v[16:19], v[32:35], v[64:79]
    ds_read_b128 v[36:39], v47 offset:16384
    ds_read_b64_tr_b16 v[16:17], v40 offset:12288
    ds_read_b64_tr_b16 v[18:19], v40 offset:13312
    s_waitcnt lgkmcnt(7)
    v_mfma_f32_32x32x16_bf16 v[80:95], v[20:23], v[32:35], v[80:95]
    ds_read_b64_tr_b16 v[20:21], v41 offset:12288
    ds_read_b64_tr_b16 v[22:23], v41 offset:13312
    s_waitcnt lgkmcnt(7)
    v_mfma_f32_32x32x16_bf16 v[96:111], v[24:27], v[32:35], v[96:111]
    ds_read_b64_tr_b16 v[24:25], v42 offset:12288
    ds_read_b64_tr_b16 v[26:27], v42 offset:13312
    s_waitcnt lgkmcnt(7)
    v_mfma_f32_32x32x16_bf16 v[112:127], v[28:31], v[32:35], v[112:127]
    ds_read_b64_tr_b16 v[28:29], v43 offset:12288
    ds_read_b64_tr_b16 v[30:31], v43 offset:13312
    s_waitcnt lgkmcnt(6)
    v_mfma_f32_32x32x16_bf16 v[64:79], v[16:19], v[36:39], v[64:79]
    s_waitcnt lgkmcnt(4)
    v_mfma_f32_32x32x16_bf16 v[80:95], v[20:23], v[36:39], v[80:95]
    s_waitcnt lgkmcnt(0)
    s_barrier
    ds_read_b128 v[32:35], v44 offset:32768
    ds_read_b64_tr_b16 v[16:17], v40 offset:16384
    ds_read_b64_tr_b16 v[18:19], v40 offset:17408
    ds_read_b64_tr_b16 v[20:21], v41 offset:16384
    ds_read_b64_tr_b16 v[22:23], v41 offset:17408
    v_mfma_f32_32x32x16_bf16 v[96:111], v[24:27], v[36:39], v[96:111]
    ds_read_b64_tr_b16 v[24:25], v42 offset:16384
    ds_read_b64_tr_b16 v[26:27], v42 offset:17408
    v_mfma_f32_32x32x16_bf16 v[112:127], v[28:31], v[36:39], v[112:127]
    ds_read_b64_tr_b16 v[28:29], v43 offset:16384
    ds_read_b64_tr_b16 v[30:31], v43 offset:17408
    s_waitcnt lgkmcnt(6)
    v_mfma_f32_32x32x16_bf16 v[64:79], v[16:19], v[32:35], v[64:79]
    ds_read_b128 v[36:39], v45 offset:32768
    ds_read_b64_tr_b16 v[16:17], v40 offset:20480
    ds_read_b64_tr_b16 v[18:19], v40 offset:21504
    s_waitcnt lgkmcnt(7)
    v_mfma_f32_32x32x16_bf16 v[80:95], v[20:23], v[32:35], v[80:95]
    ds_read_b64_tr_b16 v[20:21], v41 offset:20480
    ds_read_b64_tr_b16 v[22:23], v41 offset:21504
    s_waitcnt lgkmcnt(7)
    v_mfma_f32_32x32x16_bf16 v[96:111], v[24:27], v[32:35], v[96:111]
    ds_read_b64_tr_b16 v[24:25], v42 offset:20480
    ds_read_b64_tr_b16 v[26:27], v42 offset:21504
    s_waitcnt lgkmcnt(7)
    v_mfma_f32_32x32x16_bf16 v[112:127], v[28:31], v[32:35], v[112:127]
    ds_read_b64_tr_b16 v[28:29], v43 offset:20480
    ds_read_b64_tr_b16 v[30:31], v43 offset:21504
    s_waitcnt lgkmcnt(6)
    v_mfma_f32_32x32x16_bf16 v[64:79], v[16:19], v[36:39], v[64:79]
    ds_read_b128 v[32:35], v46 offset:32768
    ds_read_b64_tr_b16 v[16:17], v40 offset:24576
    ds_read_b64_tr_b16 v[18:19], v40 offset:25600
    s_waitcnt lgkmcnt(7)
    v_mfma_f32_32x32x16_bf16 v[80:95], v[20:23], v[36:39], v[80:95]
    ds_read_b64_tr_b16 v[20:21], v41 offset:24576
    ds_read_b64_tr_b16 v[22:23], v41 offset:25600
    s_waitcnt lgkmcnt(7)
    v_mfma_f32_32x32x16_bf16 v[96:111], v[24:27], v[36:39], v[96:111]
    ds_read_b64_tr_b16 v[24:25], v42 offset:24576
    ds_read_b64_tr_b16 v[26:27], v42 offset:25600
    s_waitcnt lgkmcnt(7)
    v_mfma_f32_32x32x16_bf16 v[112:127], v[28:31], v[36:39], v[112:127]
    ds_read_b64_tr_b16 v[28:29], v43 offset:24576
    ds_read_b64_tr_b16 v[30:31], v43 offset:25600
    s_waitcnt lgkmcnt(6)
    v_mfma_f32_32x32x16_bf16 v[64:79], v[16:19], v[32:35], v[64:79]
    ds_read_b128 v[36:39], v47 offset:32768
    ds_read_b64_tr_b16 v[16:17], v40 offset:28672
    ds_read_b64_tr_b16 v[18:19], v40 offset:29696
    s_waitcnt lgkmcnt(7)
    v_mfma_f32_32x32x16_bf16 v[80:95], v[20:23], v[32:35], v[80:95]
    ds_read_b64_tr_b16 v[20:21], v41 offset:28672
    ds_read_b64_tr_b16 v[22:23], v41 offset:29696
    s_waitcnt lgkmcnt(7)
    v_mfma_f32_32x32x16_bf16 v[96:111], v[24:27], v[32:35], v[96:111]
    ds_read_b64_tr_b16 v[24:25], v42 offset:28672
    ds_read_b64_tr_b16 v[26:27], v42 offset:29696
    s_waitcnt lgkmcnt(7)
    v_mfma_f32_32x32x16_bf16 v[112:127], v[28:31], v[32:35], v[112:127]
    ds_read_b64_tr_b16 v[28:29], v43 offset:28672
    ds_read_b64_tr_b16 v[30:31], v43 offset:29696
    s_waitcnt lgkmcnt(6)
    v_mfma_f32_32x32x16_bf16 v[64:79], v[16:19], v[36:39], v[64:79]
    s_waitcnt lgkmcnt(4)
    v_mfma_f32_32x32x16_bf16 v[80:95], v[20:23], v[36:39], v[80:95]
    s_waitcnt lgkmcnt(0)
    s_barrier
    ds_read_b128 v[32:35], v44 offset:0
    ds_read_b64_tr_b16 v[16:17], v40 offset:32768
    ds_read_b64_tr_b16 v[18:19], v40 offset:33792
    ds_read_b64_tr_b16 v[20:21], v41 offset:32768
    ds_read_b64_tr_b16 v[22:23], v41 offset:33792
    v_mfma_f32_32x32x16_bf16 v[96:111], v[24:27], v[36:39], v[96:111]
    ds_read_b64_tr_b16 v[24:25], v42 offset:32768
    ds_read_b64_tr_b16 v[26:27], v42 offset:33792
    v_mfma_f32_32x32x16_bf16 v[112:127], v[28:31], v[36:39], v[112:127]
    ds_read_b64_tr_b16 v[28:29], v43 offset:32768
    ds_read_b64_tr_b16 v[30:31], v43 offset:33792
    s_waitcnt lgkmcnt(6)
    v_mfma_f32_32x32x16_bf16 v[64:79], v[16:19], v[32:35], v[64:79]
    ds_read_b128 v[36:39], v45 offset:0
    ds_read_b64_tr_b16 v[16:17], v40 offset:36864
    ds_read_b64_tr_b16 v[18:19], v40 offset:37888
    s_waitcnt lgkmcnt(7)
    v_mfma_f32_32x32x16_bf16 v[80:95], v[20:23], v[32:35], v[80:95]
    ds_read_b64_tr_b16 v[20:21], v41 offset:36864
    ds_read_b64_tr_b16 v[22:23], v41 offset:37888
    s_waitcnt lgkmcnt(7)
    v_mfma_f32_32x32x16_bf16 v[96:111], v[24:27], v[32:35], v[96:111]
    ds_read_b64_tr_b16 v[24:25], v42 offset:36864
    ds_read_b64_tr_b16 v[26:27], v42 offset:37888
    s_waitcnt lgkmcnt(7)
    v_mfma_f32_32x32x16_bf16 v[112:127], v[28:31], v[32:35], v[112:127]
    ds_read_b64_tr_b16 v[28:29], v43 offset:36864
    ds_read_b64_tr_b16 v[30:31], v43 offset:37888
    s_waitcnt lgkmcnt(6)
    v_mfma_f32_32x32x16_bf16 v[64:79], v[16:19], v[36:39], v[64:79]
    ds_read_b128 v[32:35], v46 offset:0
    ds_read_b64_tr_b16 v[16:17], v40 offset:40960
    ds_read_b64_tr_b16 v[18:19], v40 offset:41984
    s_waitcnt lgkmcnt(7)
    v_mfma_f32_32x32x16_bf16 v[80:95], v[20:23], v[36:39], v[80:95]
    ds_read_b64_tr_b16 v[20:21], v41 offset:40960
    ds_read_b64_tr_b16 v[22:23], v41 offset:41984
    s_waitcnt lgkmcnt(7)
    v_mfma_f32_32x32x16_bf16 v[96:111], v[24:27], v[36:39], v[96:111]
    ds_read_b64_tr_b16 v[24:25], v42 offset:40960
    ds_read_b64_tr_b16 v[26:27], v42 offset:41984
    s_waitcnt lgkmcnt(7)
    v_mfma_f32_32x32x16_bf16 v[112:127], v[28:31], v[36:39], v[112:127]
    ds_read_b64_tr_b16 v[28:29], v43 offset:40960
    ds_read_b64_tr_b16 v[30:31], v43 offset:41984
    s_waitcnt lgkmcnt(6)
    v_mfma_f32_32x32x16_bf16 v[64:79], v[16:19], v[32:35], v[64:79]
    ds_read_b128 v[36:39], v47 offset:0
    ds_read_b64_tr_b16 v[16:17], v40 offset:45056
    ds_read_b64_tr_b16 v[18:19], v40 offset:46080
    s_waitcnt lgkmcnt(7)
    v_mfma_f32_32x32x16_bf16 v[80:95], v[20:23], v[32:35], v[80:95]
    ds_read_b64_tr_b16 v[20:21], v41 offset:45056
    ds_read_b64_tr_b16 v[22:23], v41 offset:46080
    s_waitcnt lgkmcnt(7)
    v_mfma_f32_32x32x16_bf16 v[96:111], v[24:27], v[32:35], v[96:111]
    ds_read_b64_tr_b16 v[24:25], v42 offset:45056
    ds_read_b64_tr_b16 v[26:27], v42 offset:46080
    s_waitcnt lgkmcnt(7)
    v_mfma_f32_32x32x16_bf16 v[112:127], v[28:31], v[32:35], v[112:127]
    ds_read_b64_tr_b16 v[28:29], v43 offset:45056
    ds_read_b64_tr_b16 v[30:31], v43 offset:46080
    s_waitcnt lgkmcnt(6)
    v_mfma_f32_32x32x16_bf16 v[64:79], v[16:19], v[36:39], v[64:79]
    s_waitcnt lgkmcnt(4)
    v_mfma_f32_32x32x16_bf16 v[80:95], v[20:23], v[36:39], v[80:95]
    s_waitcnt lgkmcnt(0)
    s_barrier
    ds_read_b128 v[32:35], v44 offset:16384
    ds_read_b64_tr_b16 v[16:17], v40 offset:49152
    ds_read_b64_tr_b16 v[18:19], v40 offset:50176
    ds_read_b64_tr_b16 v[20:21], v41 offset:49152
    ds_read_b64_tr_b16 v[22:23], v41 offset:50176
    v_mfma_f32_32x32x16_bf16 v[96:111], v[24:27], v[36:39], v[96:111]
    ds_read_b64_tr_b16 v[24:25], v42 offset:49152
    ds_read_b64_tr_b16 v[26:27], v42 offset:50176
    v_mfma_f32_32x32x16_bf16 v[112:127], v[28:31], v[36:39], v[112:127]
    ds_read_b64_tr_b16 v[28:29], v43 offset:49152
    ds_read_b64_tr_b16 v[30:31], v43 offset:50176
    s_waitcnt lgkmcnt(6)
    v_mfma_f32_32x32x16_bf16 v[64:79], v[16:19], v[32:35], v[64:79]
    ds_read_b128 v[36:39], v45 offset:16384
    ds_read_b64_tr_b16 v[16:17], v40 offset:53248
    ds_read_b64_tr_b16 v[18:19], v40 offset:54272
    s_waitcnt lgkmcnt(7)
    v_mfma_f32_32x32x16_bf16 v[80:95], v[20:23], v[32:35], v[80:95]
    ds_read_b64_tr_b16 v[20:21], v41 offset:53248
    ds_read_b64_tr_b16 v[22:23], v41 offset:54272
    s_waitcnt lgkmcnt(7)
    v_mfma_f32_32x32x16_bf16 v[96:111], v[24:27], v[32:35], v[96:111]
    ds_read_b64_tr_b16 v[24:25], v42 offset:53248
    ds_read_b64_tr_b16 v[26:27], v42 offset:54272
    s_waitcnt lgkmcnt(7)
    v_mfma_f32_32x32x16_bf16 v[112:127], v[28:31], v[32:35], v[112:127]
    ds_read_b64_tr_b16 v[28:29], v43 offset:53248
    ds_read_b64_tr_b16 v[30:31], v43 offset:54272
    s_waitcnt lgkmcnt(6)
    v_mfma_f32_32x32x16_bf16 v[64:79], v[16:19], v[36:39], v[64:79]
    ds_read_b128 v[32:35], v46 offset:16384
    ds_read_b64_tr_b16 v[16:17], v40 offset:57344
    ds_read_b64_tr_b16 v[18:19], v40 offset:58368
    s_waitcnt lgkmcnt(7)
    v_mfma_f32_32x32x16_bf16 v[80:95], v[20:23], v[36:39], v[80:95]
    ds_read_b64_tr_b16 v[20:21], v41 offset:57344
    ds_read_b64_tr_b16 v[22:23], v41 offset:58368
    s_waitcnt lgkmcnt(7)
    v_mfma_f32_32x32x16_bf16 v[96:111], v[24:27], v[36:39], v[96:111]
    ds_read_b64_tr_b16 v[24:25], v42 offset:57344
    ds_read_b64_tr_b16 v[26:27], v42 offset:58368
    s_waitcnt lgkmcnt(7)
    v_mfma_f32_32x32x16_bf16 v[112:127], v[28:31], v[36:39], v[112:127]
    ds_read_b64_tr_b16 v[28:29], v43 offset:57344
    ds_read_b64_tr_b16 v[30:31], v43 offset:58368
    s_waitcnt lgkmcnt(6)
    v_mfma_f32_32x32x16_bf16 v[64:79], v[16:19], v[32:35], v[64:79]
    ds_read_b128 v[36:39], v47 offset:16384
    ds_read_b64_tr_b16 v[16:17], v40 offset:61440
    ds_read_b64_tr_b16 v[18:19], v40 offset:62464
    s_waitcnt lgkmcnt(7)
    v_mfma_f32_32x32x16_bf16 v[80:95], v[20:23], v[32:35], v[80:95]
    ds_read_b64_tr_b16 v[20:21], v41 offset:61440
    ds_read_b64_tr_b16 v[22:23], v41 offset:62464
    s_waitcnt lgkmcnt(7)
    v_mfma_f32_32x32x16_bf16 v[96:111], v[24:27], v[32:35], v[96:111]
    ds_read_b64_tr_b16 v[24:25], v42 offset:61440
    ds_read_b64_tr_b16 v[26:27], v42 offset:62464
    s_waitcnt lgkmcnt(7)
    v_mfma_f32_32x32x16_bf16 v[112:127], v[28:31], v[32:35], v[112:127]
    ds_read_b64_tr_b16 v[28:29], v43 offset:61440
    ds_read_b64_tr_b16 v[30:31], v43 offset:62464
    s_waitcnt lgkmcnt(6)
    v_mfma_f32_32x32x16_bf16 v[64:79], v[16:19], v[36:39], v[64:79]
    s_waitcnt lgkmcnt(4)
    v_mfma_f32_32x32x16_bf16 v[80:95], v[20:23], v[36:39], v[80:95]
    s_waitcnt lgkmcnt(0)
    s_barrier
    ds_read_b128 v[32:35], v44 offset:32768
    ds_read_b64_tr_b16 v[16:17], v40 offset:0
    ds_read_b64_tr_b16 v[18:19], v40 offset:1024
    ds_read_b64_tr_b16 v[20:21], v41 offset:0
    ds_read_b64_tr_b16 v[22:23], v41 offset:1024
    v_mfma_f32_32x32x16_bf16 v[96:111], v[24:27], v[36:39], v[96:111]
    ds_read_b64_tr_b16 v[24:25], v42 offset:0
    ds_read_b64_tr_b16 v[26:27], v42 offset:1024
    v_mfma_f32_32x32x16_bf16 v[112:127], v[28:31], v[36:39], v[112:127]
    ds_read_b64_tr_b16 v[28:29], v43 offset:0
    ds_read_b64_tr_b16 v[30:31], v43 offset:1024
    s_waitcnt lgkmcnt(6)
    v_mfma_f32_32x32x16_bf16 v[64:79], v[16:19], v[32:35], v[64:79]
    ds_read_b128 v[36:39], v45 offset:32768
    ds_read_b64_tr_b16 v[16:17], v40 offset:4096
    ds_read_b64_tr_b16 v[18:19], v40 offset:5120
    s_waitcnt lgkmcnt(7)
    v_mfma_f32_32x32x16_bf16 v[80:95], v[20:23], v[32:35], v[80:95]
    ds_read_b64_tr_b16 v[20:21], v41 offset:4096
    ds_read_b64_tr_b16 v[22:23], v41 offset:5120
    s_waitcnt lgkmcnt(7)
    v_mfma_f32_32x32x16_bf16 v[96:111], v[24:27], v[32:35], v[96:111]
    ds_read_b64_tr_b16 v[24:25], v42 offset:4096
    ds_read_b64_tr_b16 v[26:27], v42 offset:5120
    s_waitcnt lgkmcnt(7)
    v_mfma_f32_32x32x16_bf16 v[112:127], v[28:31], v[32:35], v[112:127]
    ds_read_b64_tr_b16 v[28:29], v43 offset:4096
    ds_read_b64_tr_b16 v[30:31], v43 offset:5120
    s_waitcnt lgkmcnt(6)
    v_mfma_f32_32x32x16_bf16 v[64:79], v[16:19], v[36:39], v[64:79]
    ds_read_b128 v[32:35], v46 offset:32768
    ds_read_b64_tr_b16 v[16:17], v40 offset:8192
    ds_read_b64_tr_b16 v[18:19], v40 offset:9216
    s_waitcnt lgkmcnt(7)
    v_mfma_f32_32x32x16_bf16 v[80:95], v[20:23], v[36:39], v[80:95]
    ds_read_b64_tr_b16 v[20:21], v41 offset:8192
    ds_read_b64_tr_b16 v[22:23], v41 offset:9216
    s_waitcnt lgkmcnt(7)
    v_mfma_f32_32x32x16_bf16 v[96:111], v[24:27], v[36:39], v[96:111]
    ds_read_b64_tr_b16 v[24:25], v42 offset:8192
    ds_read_b64_tr_b16 v[26:27], v42 offset:9216
    s_waitcnt lgkmcnt(7)
    v_mfma_f32_32x32x16_bf16 v[112:127], v[28:31], v[36:39], v[112:127]
    ds_read_b64_tr_b16 v[28:29], v43 offset:8192
    ds_read_b64_tr_b16 v[30:31], v43 offset:9216
    s_waitcnt lgkmcnt(6)
    v_mfma_f32_32x32x16_bf16 v[64:79], v[16:19], v[32:35], v[64:79]
    ds_read_b128 v[36:39], v47 offset:32768
    ds_read_b64_tr_b16 v[16:17], v40 offset:12288
    ds_read_b64_tr_b16 v[18:19], v40 offset:13312
    s_waitcnt lgkmcnt(7)
    v_mfma_f32_32x32x16_bf16 v[80:95], v[20:23], v[32:35], v[80:95]
    ds_read_b64_tr_b16 v[20:21], v41 offset:12288
    ds_read_b64_tr_b16 v[22:23], v41 offset:13312
    s_waitcnt lgkmcnt(7)
    v_mfma_f32_32x32x16_bf16 v[96:111], v[24:27], v[32:35], v[96:111]
    ds_read_b64_tr_b16 v[24:25], v42 offset:12288
    ds_read_b64_tr_b16 v[26:27], v42 offset:13312
    s_waitcnt lgkmcnt(7)
    v_mfma_f32_32x32x16_bf16 v[112:127], v[28:31], v[32:35], v[112:127]
    ds_read_b64_tr_b16 v[28:29], v43 offset:12288
    ds_read_b64_tr_b16 v[30:31], v43 offset:13312
    s_waitcnt lgkmcnt(6)
    v_mfma_f32_32x32x16_bf16 v[64:79], v[16:19], v[36:39], v[64:79]
    s_waitcnt lgkmcnt(4)
    v_mfma_f32_32x32x16_bf16 v[80:95], v[20:23], v[36:39], v[80:95]
    s_waitcnt lgkmcnt(0)
    s_barrier
    ds_read_b128 v[32:35], v44 offset:0
    ds_read_b64_tr_b16 v[16:17], v40 offset:16384
    ds_read_b64_tr_b16 v[18:19], v40 offset:17408
    ds_read_b64_tr_b16 v[20:21], v41 offset:16384
    ds_read_b64_tr_b16 v[22:23], v41 offset:17408
    v_mfma_f32_32x32x16_bf16 v[96:111], v[24:27], v[36:39], v[96:111]
    ds_read_b64_tr_b16 v[24:25], v42 offset:16384
    ds_read_b64_tr_b16 v[26:27], v42 offset:17408
    v_mfma_f32_32x32x16_bf16 v[112:127], v[28:31], v[36:39], v[112:127]
    ds_read_b64_tr_b16 v[28:29], v43 offset:16384
    ds_read_b64_tr_b16 v[30:31], v43 offset:17408
    s_waitcnt lgkmcnt(6)
    v_mfma_f32_32x32x16_bf16 v[64:79], v[16:19], v[32:35], v[64:79]
    ds_read_b128 v[36:39], v45 offset:0
    ds_read_b64_tr_b16 v[16:17], v40 offset:20480
    ds_read_b64_tr_b16 v[18:19], v40 offset:21504
    s_waitcnt lgkmcnt(7)
    v_mfma_f32_32x32x16_bf16 v[80:95], v[20:23], v[32:35], v[80:95]
    ds_read_b64_tr_b16 v[20:21], v41 offset:20480
    ds_read_b64_tr_b16 v[22:23], v41 offset:21504
    s_waitcnt lgkmcnt(7)
    v_mfma_f32_32x32x16_bf16 v[96:111], v[24:27], v[32:35], v[96:111]
    ds_read_b64_tr_b16 v[24:25], v42 offset:20480
    ds_read_b64_tr_b16 v[26:27], v42 offset:21504
    s_waitcnt lgkmcnt(7)
    v_mfma_f32_32x32x16_bf16 v[112:127], v[28:31], v[32:35], v[112:127]
    ds_read_b64_tr_b16 v[28:29], v43 offset:20480
    ds_read_b64_tr_b16 v[30:31], v43 offset:21504
    s_waitcnt lgkmcnt(6)
    v_mfma_f32_32x32x16_bf16 v[64:79], v[16:19], v[36:39], v[64:79]
    ds_read_b128 v[32:35], v46 offset:0
    ds_read_b64_tr_b16 v[16:17], v40 offset:24576
    ds_read_b64_tr_b16 v[18:19], v40 offset:25600
    s_waitcnt lgkmcnt(7)
    v_mfma_f32_32x32x16_bf16 v[80:95], v[20:23], v[36:39], v[80:95]
    ds_read_b64_tr_b16 v[20:21], v41 offset:24576
    ds_read_b64_tr_b16 v[22:23], v41 offset:25600
    s_waitcnt lgkmcnt(7)
    v_mfma_f32_32x32x16_bf16 v[96:111], v[24:27], v[36:39], v[96:111]
    ds_read_b64_tr_b16 v[24:25], v42 offset:24576
    ds_read_b64_tr_b16 v[26:27], v42 offset:25600
    s_waitcnt lgkmcnt(7)
    v_mfma_f32_32x32x16_bf16 v[112:127], v[28:31], v[36:39], v[112:127]
    ds_read_b64_tr_b16 v[28:29], v43 offset:24576
    ds_read_b64_tr_b16 v[30:31], v43 offset:25600
    s_waitcnt lgkmcnt(6)
    v_mfma_f32_32x32x16_bf16 v[64:79], v[16:19], v[32:35], v[64:79]
    ds_read_b128 v[36:39], v47 offset:0
    ds_read_b64_tr_b16 v[16:17], v40 offset:28672
    ds_read_b64_tr_b16 v[18:19], v40 offset:29696
    s_waitcnt lgkmcnt(7)
    v_mfma_f32_32x32x16_bf16 v[80:95], v[20:23], v[32:35], v[80:95]
    ds_read_b64_tr_b16 v[20:21], v41 offset:28672
    ds_read_b64_tr_b16 v[22:23], v41 offset:29696
    s_waitcnt lgkmcnt(7)
    v_mfma_f32_32x32x16_bf16 v[96:111], v[24:27], v[32:35], v[96:111]
    ds_read_b64_tr_b16 v[24:25], v42 offset:28672
    ds_read_b64_tr_b16 v[26:27], v42 offset:29696
    s_waitcnt lgkmcnt(7)
    v_mfma_f32_32x32x16_bf16 v[112:127], v[28:31], v[32:35], v[112:127]
    ds_read_b64_tr_b16 v[28:29], v43 offset:28672
    ds_read_b64_tr_b16 v[30:31], v43 offset:29696
    s_waitcnt lgkmcnt(6)
    v_mfma_f32_32x32x16_bf16 v[64:79], v[16:19], v[36:39], v[64:79]
    s_waitcnt lgkmcnt(4)
    v_mfma_f32_32x32x16_bf16 v[80:95], v[20:23], v[36:39], v[80:95]
    s_waitcnt lgkmcnt(2)
    v_mfma_f32_32x32x16_bf16 v[96:111], v[24:27], v[36:39], v[96:111]
    s_waitcnt lgkmcnt(0)
    v_mfma_f32_32x32x16_bf16 v[112:127], v[28:31], v[36:39], v[112:127]
    s_nop 11
    s_cmp_ge_u32 s69, 5
    s_cbranch_scc1 P1_noscale_26
    v_mul_f32 v64, s76, v64
    v_mul_f32 v65, s76, v65
    v_mul_f32 v66, s76, v66
    v_mul_f32 v67, s76, v67
    v_mul_f32 v68, s76, v68
    v_mul_f32 v69, s76, v69
    v_mul_f32 v70, s76, v70
    v_mul_f32 v71, s76, v71
    v_mul_f32 v72, s76, v72
    v_mul_f32 v73, s76, v73
    v_mul_f32 v74, s76, v74
    v_mul_f32 v75, s76, v75
    v_mul_f32 v76, s76, v76
    v_mul_f32 v77, s76, v77
    v_mul_f32 v78, s76, v78
    v_mul_f32 v79, s76, v79
    v_mul_f32 v80, s76, v80
    v_mul_f32 v81, s76, v81
    v_mul_f32 v82, s76, v82
    v_mul_f32 v83, s76, v83
    v_mul_f32 v84, s76, v84
    v_mul_f32 v85, s76, v85
    v_mul_f32 v86, s76, v86
    v_mul_f32 v87, s76, v87
    v_mul_f32 v88, s76, v88
    v_mul_f32 v89, s76, v89
    v_mul_f32 v90, s76, v90
    v_mul_f32 v91, s76, v91
    v_mul_f32 v92, s76, v92
    v_mul_f32 v93, s76, v93
    v_mul_f32 v94, s76, v94
    v_mul_f32 v95, s76, v95
    v_mul_f32 v96, s76, v96
    v_mul_f32 v97, s76, v97
    v_mul_f32 v98, s76, v98
    v_mul_f32 v99, s76, v99
    v_mul_f32 v100, s76, v100
    v_mul_f32 v101, s76, v101
    v_mul_f32 v102, s76, v102
    v_mul_f32 v103, s76, v103
    v_mul_f32 v104, s76, v104
    v_mul_f32 v105, s76, v105
    v_mul_f32 v106, s76, v106
    v_mul_f32 v107, s76, v107
    v_mul_f32 v108, s76, v108
    v_mul_f32 v109, s76, v109
    v_mul_f32 v110, s76, v110
    v_mul_f32 v111, s76, v111
    v_mul_f32 v112, s76, v112
    v_mul_f32 v113, s76, v113
    v_mul_f32 v114, s76, v114
    v_mul_f32 v115, s76, v115
    v_mul_f32 v116, s76, v116
    v_mul_f32 v117, s76, v117
    v_mul_f32 v118, s76, v118
    v_mul_f32 v119, s76, v119
    v_mul_f32 v120, s76, v120
    v_mul_f32 v121, s76, v121
    v_mul_f32 v122, s76, v122
    v_mul_f32 v123, s76, v123
    v_mul_f32 v124, s76, v124
    v_mul_f32 v125, s76, v125
    v_mul_f32 v126, s76, v126
    v_mul_f32 v127, s76, v127
P1_noscale_26:
    v_cvt_pk_bf16_f32 v16, v64, v65
    v_cvt_pk_bf16_f32 v17, v66, v67
    buffer_store_dwordx2 v[16:17], v128, s[56:59], s78 offen sc1
    v_cvt_pk_bf16_f32 v18, v68, v69
    v_cvt_pk_bf16_f32 v19, v70, v71
    buffer_store_dwordx2 v[18:19], v129, s[56:59], s78 offen sc1
    v_cvt_pk_bf16_f32 v20, v72, v73
    v_cvt_pk_bf16_f32 v21, v74, v75
    buffer_store_dwordx2 v[20:21], v130, s[56:59], s78 offen sc1
    v_cvt_pk_bf16_f32 v22, v76, v77
    v_cvt_pk_bf16_f32 v23, v78, v79
    buffer_store_dwordx2 v[22:23], v131, s[56:59], s78 offen sc1
    v_cvt_pk_bf16_f32 v24, v80, v81
    v_cvt_pk_bf16_f32 v25, v82, v83
    buffer_store_dwordx2 v[24:25], v132, s[56:59], s78 offen sc1
    v_cvt_pk_bf16_f32 v26, v84, v85
    v_cvt_pk_bf16_f32 v27, v86, v87
    buffer_store_dwordx2 v[26:27], v133, s[56:59], s78 offen sc1
    v_cvt_pk_bf16_f32 v28, v88, v89
    v_cvt_pk_bf16_f32 v29, v90, v91
    buffer_store_dwordx2 v[28:29], v134, s[56:59], s78 offen sc1
    v_cvt_pk_bf16_f32 v30, v92, v93
    v_cvt_pk_bf16_f32 v31, v94, v95
    buffer_store_dwordx2 v[30:31], v135, s[56:59], s78 offen sc1
    v_cvt_pk_bf16_f32 v16, v96, v97
    v_cvt_pk_bf16_f32 v17, v98, v99
    buffer_store_dwordx2 v[16:17], v136, s[56:59], s78 offen sc1
    v_cvt_pk_bf16_f32 v18, v100, v101
    v_cvt_pk_bf16_f32 v19, v102, v103
    buffer_store_dwordx2 v[18:19], v137, s[56:59], s78 offen sc1
    v_cvt_pk_bf16_f32 v20, v104, v105
    v_cvt_pk_bf16_f32 v21, v106, v107
    buffer_store_dwordx2 v[20:21], v138, s[56:59], s78 offen sc1
    v_cvt_pk_bf16_f32 v22, v108, v109
    v_cvt_pk_bf16_f32 v23, v110, v111
    buffer_store_dwordx2 v[22:23], v139, s[56:59], s78 offen sc1
    v_cvt_pk_bf16_f32 v24, v112, v113
    v_cvt_pk_bf16_f32 v25, v114, v115
    buffer_store_dwordx2 v[24:25], v140, s[56:59], s78 offen sc1
    v_cvt_pk_bf16_f32 v26, v116, v117
    v_cvt_pk_bf16_f32 v27, v118, v119
    buffer_store_dwordx2 v[26:27], v141, s[56:59], s78 offen sc1
    v_cvt_pk_bf16_f32 v28, v120, v121
    v_cvt_pk_bf16_f32 v29, v122, v123
    buffer_store_dwordx2 v[28:29], v142, s[56:59], s78 offen sc1
    v_cvt_pk_bf16_f32 v30, v124, v125
    v_cvt_pk_bf16_f32 v31, v126, v127
    buffer_store_dwordx2 v[30:31], v143, s[56:59], s78 offen sc1
    s_branch P1_fin_21
P1_v_22:
    s_add_u32 s56, s38, 0xc00000
    s_addc_u32 s57, s39, 0
    s_mov_b32 s58, 0x500000
    s_mov_b32 s59, 0x20000
    s_mul_i32 s78, s72, 2560
    s_sub_u32 s75, s69, 10
    s_lshl_b32 s80, s75, 7
    v_add_u32 v5, s80, v2
    v_mul_u32_u24 v6, 320, v3
    s_mov_b32 s79, 163840
    v_add_u32 v8, 0, v5
    v_mul_u32_u24 v9, 0xcccd, v8
    v_lshrrev_b32 v9, 20, v9
    v_mul_u32_u24 v10, 20, v9
    v_sub_u32 v10, v8, v10
    v_mul_lo_u32 v128, v9, s79
    v_lshl_add_u32 v128, v10, 4, v128
    v_add_u32 v128, v128, v6
    v_add_u32 v8, 32, v5
    v_mul_u32_u24 v9, 0xcccd, v8
    v_lshrrev_b32 v9, 20, v9
    v_mul_u32_u24 v10, 20, v9
    v_sub_u32 v10, v8, v10
    v_mul_lo_u32 v129, v9, s79
    v_lshl_add_u32 v129, v10, 4, v129
    v_add_u32 v129, v129, v6
    v_add_u32 v8, 64, v5
    v_mul_u32_u24 v9, 0xcccd, v8
    v_lshrrev_b32 v9, 20, v9
    v_mul_u32_u24 v10, 20, v9
    v_sub_u32 v10, v8, v10
    v_mul_lo_u32 v130, v9, s79
    v_lshl_add_u32 v130, v10, 4, v130
    v_add_u32 v130, v130, v6
    v_add_u32 v8, 96, v5
    v_mul_u32_u24 v9, 0xcccd, v8
    v_lshrrev_b32 v9, 20, v9
    v_mul_u32_u24 v10, 20, v9
    v_sub_u32 v10, v8, v10
    v_mul_lo_u32 v131, v9, s79
    v_lshl_add_u32 v131, v10, 4, v131
    v_add_u32 v131, v131, v6
    s_lshl_b32 s71, s68, 4
    v_and_b32 v240, 15, v0
    v_add_u32 v240, s71, v240
    s_cmp_lg_u32 s40, 0
    s_cbranch_scc1 wf_27
    s_cmp_lg_u32 s42, 0
    s_cbranch_scc1 wf_27
    v_lshlrev_b32 v240, 6, v240
    v_add_u32 v240, 64, v240
    s_mov_b32 s94, 30000
wf_poll_28:
    buffer_load_dword v250, v240, s[96:99], 0 offen sc1
    s_waitcnt vmcnt(0)
    v_cmp_ne_u32 vcc, s41, v250
    s_nop 1
    s_cbranch_vccz wf_27
    s_sleep 1
    s_sub_u32 s94, s94, 1
    s_cmp_lg_u32 s94, 0
    s_cbranch_scc1 wf_poll_28
wf_done_29:
    s_mov_b32 s42, 1
wf_27:
    s_barrier
    s_barrier
    ds_read_b128 v[32:35], v44 offset:0
    ds_read_b64_tr_b16 v[16:17], v40 offset:0
    ds_read_b64_tr_b16 v[18:19], v40 offset:1024
    ds_read_b64_tr_b16 v[20:21], v41 offset:0
    ds_read_b64_tr_b16 v[22:23], v41 offset:1024
    ds_read_b64_tr_b16 v[24:25], v42 offset:0
    ds_read_b64_tr_b16 v[26:27], v42 offset:1024
    ds_read_b64_tr_b16 v[28:29], v43 offset:0
    ds_read_b64_tr_b16 v[30:31], v43 offset:1024
    s_waitcnt lgkmcnt(6)
    v_mfma_f32_32x32x16_bf16 v[64:79], v[32:35], v[16:19], 0
    ds_read_b128 v[36:39], v45 offset:0
    ds_read_b64_tr_b16 v[16:17], v40 offset:4096
    ds_read_b64_tr_b16 v[18:19], v40 offset:5120
    s_waitcnt lgkmcnt(7)
    v_mfma_f32_32x32x16_bf16 v[80:95], v[32:35], v[20:23], 0
    ds_read_b64_tr_b16 v[20:21], v41 offset:4096
    ds_read_b64_tr_b16 v[22:23], v41 offset:5120
    s_waitcnt lgkmcnt(7)
    v_mfma_f32_32x32x16_bf16 v[96:111], v[32:35], v[24:27], 0
    ds_read_b64_tr_b16 v[24:25], v42 offset:4096
    ds_read_b64_tr_b16 v[26:27], v42 offset:5120
    s_waitcnt lgkmcnt(7)
    v_mfma_f32_32x32x16_bf16 v[112:127], v[32:35], v[28:31], 0
    ds_read_b64_tr_b16 v[28:29], v43 offset:4096
    ds_read_b64_tr_b16 v[30:31], v43 offset:5120
    s_waitcnt lgkmcnt(6)
    v_mfma_f32_32x32x16_bf16 v[64:79], v[36:39], v[16:19], v[64:79]
    ds_read_b128 v[32:35], v46 offset:0
    ds_read_b64_tr_b16 v[16:17], v40 offset:8192
    ds_read_b64_tr_b16 v[18:19], v40 offset:9216
    s_waitcnt lgkmcnt(7)
    v_mfma_f32_32x32x16_bf16 v[80:95], v[36:39], v[20:23], v[80:95]
    ds_read_b64_tr_b16 v[20:21], v41 offset:8192
    ds_read_b64_tr_b16 v[22:23], v41 offset:9216
    s_waitcnt lgkmcnt(7)
    v_mfma_f32_32x32x16_bf16 v[96:111], v[36:39], v[24:27], v[96:111]
    ds_read_b64_tr_b16 v[24:25], v42 offset:8192
    ds_read_b64_tr_b16 v[26:27], v42 offset:9216
    s_waitcnt lgkmcnt(7)
    v_mfma_f32_32x32x16_bf16 v[112:127], v[36:39], v[28:31], v[112:127]
    ds_read_b64_tr_b16 v[28:29], v43 offset:8192
    ds_read_b64_tr_b16 v[30:31], v43 offset:9216
    s_waitcnt lgkmcnt(6)
    v_mfma_f32_32x32x16_bf16 v[64:79], v[32:35], v[16:19], v[64:79]
    ds_read_b128 v[36:39], v47 offset:0
    ds_read_b64_tr_b16 v[16:17], v40 offset:12288
    ds_read_b64_tr_b16 v[18:19], v40 offset:13312
    s_waitcnt lgkmcnt(7)
    v_mfma_f32_32x32x16_bf16 v[80:95], v[32:35], v[20:23], v[80:95]
    ds_read_b64_tr_b16 v[20:21], v41 offset:12288
    ds_read_b64_tr_b16 v[22:23], v41 offset:13312
    s_waitcnt lgkmcnt(7)
    v_mfma_f32_32x32x16_bf16 v[96:111], v[32:35], v[24:27], v[96:111]
    ds_read_b64_tr_b16 v[24:25], v42 offset:12288
    ds_read_b64_tr_b16 v[26:27], v42 offset:13312
    s_waitcnt lgkmcnt(7)
    v_mfma_f32_32x32x16_bf16 v[112:127], v[32:35], v[28:31], v[112:127]
    ds_read_b64_tr_b16 v[28:29], v43 offset:12288
    ds_read_b64_tr_b16 v[30:31], v43 offset:13312
    s_waitcnt lgkmcnt(6)
    v_mfma_f32_32x32x16_bf16 v[64:79], v[36:39], v[16:19], v[64:79]
    s_waitcnt lgkmcnt(4)
    v_mfma_f32_32x32x16_bf16 v[80:95], v[36:39], v[20:23], v[80:95]
    s_waitcnt lgkmcnt(0)
    s_barrier
    ds_read_b128 v[32:35], v44 offset:16384
    ds_read_b64_tr_b16 v[16:17], v40 offset:16384
    ds_read_b64_tr_b16 v[18:19], v40 offset:17408
    ds_read_b64_tr_b16 v[20:21], v41 offset:16384
    ds_read_b64_tr_b16 v[22:23], v41 offset:17408
    v_mfma_f32_32x32x16_bf16 v[96:111], v[36:39], v[24:27], v[96:111]
    ds_read_b64_tr_b16 v[24:25], v42 offset:16384
    ds_read_b64_tr_b16 v[26:27], v42 offset:17408
    v_mfma_f32_32x32x16_bf16 v[112:127], v[36:39], v[28:31], v[112:127]
    ds_read_b64_tr_b16 v[28:29], v43 offset:16384
    ds_read_b64_tr_b16 v[30:31], v43 offset:17408
    s_waitcnt lgkmcnt(6)
    v_mfma_f32_32x32x16_bf16 v[64:79], v[32:35], v[16:19], v[64:79]
    ds_read_b128 v[36:39], v45 offset:16384
    ds_read_b64_tr_b16 v[16:17], v40 offset:20480
    ds_read_b64_tr_b16 v[18:19], v40 offset:21504
    s_waitcnt lgkmcnt(7)
    v_mfma_f32_32x32x16_bf16 v[80:95], v[32:35], v[20:23], v[80:95]
    ds_read_b64_tr_b16 v[20:21], v41 offset:20480
    ds_read_b64_tr_b16 v[22:23], v41 offset:21504
    s_waitcnt lgkmcnt(7)
    v_mfma_f32_32x32x16_bf16 v[96:111], v[32:35], v[24:27], v[96:111]
    ds_read_b64_tr_b16 v[24:25], v42 offset:20480
    ds_read_b64_tr_b16 v[26:27], v42 offset:21504
    s_waitcnt lgkmcnt(7)
    v_mfma_f32_32x32x16_bf16 v[112:127], v[32:35], v[28:31], v[112:127]
    ds_read_b64_tr_b16 v[28:29], v43 offset:20480
    ds_read_b64_tr_b16 v[30:31], v43 offset:21504
    s_waitcnt lgkmcnt(6)
    v_mfma_f32_32x32x16_bf16 v[64:79], v[36:39], v[16:19], v[64:79]
    ds_read_b128 v[32:35], v46 offset:16384
    ds_read_b64_tr_b16 v[16:17], v40 offset:24576
    ds_read_b64_tr_b16 v[18:19], v40 offset:25600
    s_waitcnt lgkmcnt(7)
    v_mfma_f32_32x32x16_bf16 v[80:95], v[36:39], v[20:23], v[80:95]
    ds_read_b64_tr_b16 v[20:21], v41 offset:24576
    ds_read_b64_tr_b16 v[22:23], v41 offset:25600
    s_waitcnt lgkmcnt(7)
    v_mfma_f32_32x32x16_bf16 v[96:111], v[36:39], v[24:27], v[96:111]
    ds_read_b64_tr_b16 v[24:25], v42 offset:24576
    ds_read_b64_tr_b16 v[26:27], v42 offset:25600
    s_waitcnt lgkmcnt(7)
    v_mfma_f32_32x32x16_bf16 v[112:127], v[36:39], v[28:31], v[112:127]
    ds_read_b64_tr_b16 v[28:29], v43 offset:24576
    ds_read_b64_tr_b16 v[30:31], v43 offset:25600
    s_waitcnt lgkmcnt(6)
    v_mfma_f32_32x32x16_bf16 v[64:79], v[32:35], v[16:19], v[64:79]
    ds_read_b128 v[36:39], v47 offset:16384
    ds_read_b64_tr_b16 v[16:17], v40 offset:28672
    ds_read_b64_tr_b16 v[18:19], v40 offset:29696
    s_waitcnt lgkmcnt(7)
    v_mfma_f32_32x32x16_bf16 v[80:95], v[32:35], v[20:23], v[80:95]
    ds_read_b64_tr_b16 v[20:21], v41 offset:28672
    ds_read_b64_tr_b16 v[22:23], v41 offset:29696
    s_waitcnt lgkmcnt(7)
    v_mfma_f32_32x32x16_bf16 v[96:111], v[32:35], v[24:27], v[96:111]
    ds_read_b64_tr_b16 v[24:25], v42 offset:28672
    ds_read_b64_tr_b16 v[26:27], v42 offset:29696
    s_waitcnt lgkmcnt(7)
    v_mfma_f32_32x32x16_bf16 v[112:127], v[32:35], v[28:31], v[112:127]
    ds_read_b64_tr_b16 v[28:29], v43 offset:28672
    ds_read_b64_tr_b16 v[30:31], v43 offset:29696
    s_waitcnt lgkmcnt(6)
    v_mfma_f32_32x32x16_bf16 v[64:79], v[36:39], v[16:19], v[64:79]
    s_waitcnt lgkmcnt(4)
    v_mfma_f32_32x32x16_bf16 v[80:95], v[36:39], v[20:23], v[80:95]
    s_waitcnt lgkmcnt(0)
    s_barrier
    ds_read_b128 v[32:35], v44 offset:32768
    ds_read_b64_tr_b16 v[16:17], v40 offset:32768
    ds_read_b64_tr_b16 v[18:19], v40 offset:33792
    ds_read_b64_tr_b16 v[20:21], v41 offset:32768
    ds_read_b64_tr_b16 v[22:23], v41 offset:33792
    v_mfma_f32_32x32x16_bf16 v[96:111], v[36:39], v[24:27], v[96:111]
    ds_read_b64_tr_b16 v[24:25], v42 offset:32768
    ds_read_b64_tr_b16 v[26:27], v42 offset:33792
    v_mfma_f32_32x32x16_bf16 v[112:127], v[36:39], v[28:31], v[112:127]
    ds_read_b64_tr_b16 v[28:29], v43 offset:32768
    ds_read_b64_tr_b16 v[30:31], v43 offset:33792
    s_waitcnt lgkmcnt(6)
    v_mfma_f32_32x32x16_bf16 v[64:79], v[32:35], v[16:19], v[64:79]
    ds_read_b128 v[36:39], v45 offset:32768
    ds_read_b64_tr_b16 v[16:17], v40 offset:36864
    ds_read_b64_tr_b16 v[18:19], v40 offset:37888
    s_waitcnt lgkmcnt(7)
    v_mfma_f32_32x32x16_bf16 v[80:95], v[32:35], v[20:23], v[80:95]
    ds_read_b64_tr_b16 v[20:21], v41 offset:36864
    ds_read_b64_tr_b16 v[22:23], v41 offset:37888
    s_waitcnt lgkmcnt(7)
    v_mfma_f32_32x32x16_bf16 v[96:111], v[32:35], v[24:27], v[96:111]
    ds_read_b64_tr_b16 v[24:25], v42 offset:36864
    ds_read_b64_tr_b16 v[26:27], v42 offset:37888
    s_waitcnt lgkmcnt(7)
    v_mfma_f32_32x32x16_bf16 v[112:127], v[32:35], v[28:31], v[112:127]
    ds_read_b64_tr_b16 v[28:29], v43 offset:36864
    ds_read_b64_tr_b16 v[30:31], v43 offset:37888
    s_waitcnt lgkmcnt(6)
    v_mfma_f32_32x32x16_bf16 v[64:79], v[36:39], v[16:19], v[64:79]
    ds_read_b128 v[32:35], v46 offset:32768
    ds_read_b64_tr_b16 v[16:17], v40 offset:40960
    ds_read_b64_tr_b16 v[18:19], v40 offset:41984
    s_waitcnt lgkmcnt(7)
    v_mfma_f32_32x32x16_bf16 v[80:95], v[36:39], v[20:23], v[80:95]
    ds_read_b64_tr_b16 v[20:21], v41 offset:40960
    ds_read_b64_tr_b16 v[22:23], v41 offset:41984
    s_waitcnt lgkmcnt(7)
    v_mfma_f32_32x32x16_bf16 v[96:111], v[36:39], v[24:27], v[96:111]
    ds_read_b64_tr_b16 v[24:25], v42 offset:40960
    ds_read_b64_tr_b16 v[26:27], v42 offset:41984
    s_waitcnt lgkmcnt(7)
    v_mfma_f32_32x32x16_bf16 v[112:127], v[36:39], v[28:31], v[112:127]
    ds_read_b64_tr_b16 v[28:29], v43 offset:40960
    ds_read_b64_tr_b16 v[30:31], v43 offset:41984
    s_waitcnt lgkmcnt(6)
    v_mfma_f32_32x32x16_bf16 v[64:79], v[32:35], v[16:19], v[64:79]
    ds_read_b128 v[36:39], v47 offset:32768
    ds_read_b64_tr_b16 v[16:17], v40 offset:45056
    ds_read_b64_tr_b16 v[18:19], v40 offset:46080
    s_waitcnt lgkmcnt(7)
    v_mfma_f32_32x32x16_bf16 v[80:95], v[32:35], v[20:23], v[80:95]
    ds_read_b64_tr_b16 v[20:21], v41 offset:45056
    ds_read_b64_tr_b16 v[22:23], v41 offset:46080
    s_waitcnt lgkmcnt(7)
    v_mfma_f32_32x32x16_bf16 v[96:111], v[32:35], v[24:27], v[96:111]
    ds_read_b64_tr_b16 v[24:25], v42 offset:45056
    ds_read_b64_tr_b16 v[26:27], v42 offset:46080
    s_waitcnt lgkmcnt(7)
    v_mfma_f32_32x32x16_bf16 v[112:127], v[32:35], v[28:31], v[112:127]
    ds_read_b64_tr_b16 v[28:29], v43 offset:45056
    ds_read_b64_tr_b16 v[30:31], v43 offset:46080
    s_waitcnt lgkmcnt(6)
    v_mfma_f32_32x32x16_bf16 v[64:79], v[36:39], v[16:19], v[64:79]
    s_waitcnt lgkmcnt(4)
    v_mfma_f32_32x32x16_bf16 v[80:95], v[36:39], v[20:23], v[80:95]
    s_waitcnt lgkmcnt(0)
    s_barrier
    ds_read_b128 v[32:35], v44 offset:0
    ds_read_b64_tr_b16 v[16:17], v40 offset:49152
    ds_read_b64_tr_b16 v[18:19], v40 offset:50176
    ds_read_b64_tr_b16 v[20:21], v41 offset:49152
    ds_read_b64_tr_b16 v[22:23], v41 offset:50176
    v_mfma_f32_32x32x16_bf16 v[96:111], v[36:39], v[24:27], v[96:111]
    ds_read_b64_tr_b16 v[24:25], v42 offset:49152
    ds_read_b64_tr_b16 v[26:27], v42 offset:50176
    v_mfma_f32_32x32x16_bf16 v[112:127], v[36:39], v[28:31], v[112:127]
    ds_read_b64_tr_b16 v[28:29], v43 offset:49152
    ds_read_b64_tr_b16 v[30:31], v43 offset:50176
    s_waitcnt lgkmcnt(6)
    v_mfma_f32_32x32x16_bf16 v[64:79], v[32:35], v[16:19], v[64:79]
    ds_read_b128 v[36:39], v45 offset:0
    ds_read_b64_tr_b16 v[16:17], v40 offset:53248
    ds_read_b64_tr_b16 v[18:19], v40 offset:54272
    s_waitcnt lgkmcnt(7)
    v_mfma_f32_32x32x16_bf16 v[80:95], v[32:35], v[20:23], v[80:95]
    ds_read_b64_tr_b16 v[20:21], v41 offset:53248
    ds_read_b64_tr_b16 v[22:23], v41 offset:54272
    s_waitcnt lgkmcnt(7)
    v_mfma_f32_32x32x16_bf16 v[96:111], v[32:35], v[24:27], v[96:111]
    ds_read_b64_tr_b16 v[24:25], v42 offset:53248
    ds_read_b64_tr_b16 v[26:27], v42 offset:54272
    s_waitcnt lgkmcnt(7)
    v_mfma_f32_32x32x16_bf16 v[112:127], v[32:35], v[28:31], v[112:127]
    ds_read_b64_tr_b16 v[28:29], v43 offset:53248
    ds_read_b64_tr_b16 v[30:31], v43 offset:54272
    s_waitcnt lgkmcnt(6)
    v_mfma_f32_32x32x16_bf16 v[64:79], v[36:39], v[16:19], v[64:79]
    ds_read_b128 v[32:35], v46 offset:0
    ds_read_b64_tr_b16 v[16:17], v40 offset:57344
    ds_read_b64_tr_b16 v[18:19], v40 offset:58368
    s_waitcnt lgkmcnt(7)
    v_mfma_f32_32x32x16_bf16 v[80:95], v[36:39], v[20:23], v[80:95]
    ds_read_b64_tr_b16 v[20:21], v41 offset:57344
    ds_read_b64_tr_b16 v[22:23], v41 offset:58368
    s_waitcnt lgkmcnt(7)
    v_mfma_f32_32x32x16_bf16 v[96:111], v[36:39], v[24:27], v[96:111]
    ds_read_b64_tr_b16 v[24:25], v42 offset:57344
    ds_read_b64_tr_b16 v[26:27], v42 offset:58368
    s_waitcnt lgkmcnt(7)
    v_mfma_f32_32x32x16_bf16 v[112:127], v[36:39], v[28:31], v[112:127]
    ds_read_b64_tr_b16 v[28:29], v43 offset:57344
    ds_read_b64_tr_b16 v[30:31], v43 offset:58368
    s_waitcnt lgkmcnt(6)
    v_mfma_f32_32x32x16_bf16 v[64:79], v[32:35], v[16:19], v[64:79]
    ds_read_b128 v[36:39], v47 offset:0
    ds_read_b64_tr_b16 v[16:17], v40 offset:61440
    ds_read_b64_tr_b16 v[18:19], v40 offset:62464
    s_waitcnt lgkmcnt(7)
    v_mfma_f32_32x32x16_bf16 v[80:95], v[32:35], v[20:23], v[80:95]
    ds_read_b64_tr_b16 v[20:21], v41 offset:61440
    ds_read_b64_tr_b16 v[22:23], v41 offset:62464
    s_waitcnt lgkmcnt(7)
    v_mfma_f32_32x32x16_bf16 v[96:111], v[32:35], v[24:27], v[96:111]
    ds_read_b64_tr_b16 v[24:25], v42 offset:61440
    ds_read_b64_tr_b16 v[26:27], v42 offset:62464
    s_waitcnt lgkmcnt(7)
    v_mfma_f32_32x32x16_bf16 v[112:127], v[32:35], v[28:31], v[112:127]
    ds_read_b64_tr_b16 v[28:29], v43 offset:61440
    ds_read_b64_tr_b16 v[30:31], v43 offset:62464
    s_waitcnt lgkmcnt(6)
    v_mfma_f32_32x32x16_bf16 v[64:79], v[36:39], v[16:19], v[64:79]
    s_waitcnt lgkmcnt(4)
    v_mfma_f32_32x32x16_bf16 v[80:95], v[36:39], v[20:23], v[80:95]
    s_waitcnt lgkmcnt(0)
    s_barrier
    ds_read_b128 v[32:35], v44 offset:16384
    ds_read_b64_tr_b16 v[16:17], v40 offset:0
    ds_read_b64_tr_b16 v[18:19], v40 offset:1024
    ds_read_b64_tr_b16 v[20:21], v41 offset:0
    ds_read_b64_tr_b16 v[22:23], v41 offset:1024
    v_mfma_f32_32x32x16_bf16 v[96:111], v[36:39], v[24:27], v[96:111]
    ds_read_b64_tr_b16 v[24:25], v42 offset:0
    ds_read_b64_tr_b16 v[26:27], v42 offset:1024
    v_mfma_f32_32x32x16_bf16 v[112:127], v[36:39], v[28:31], v[112:127]
    ds_read_b64_tr_b16 v[28:29], v43 offset:0
    ds_read_b64_tr_b16 v[30:31], v43 offset:1024
    s_waitcnt lgkmcnt(6)
    v_mfma_f32_32x32x16_bf16 v[64:79], v[32:35], v[16:19], v[64:79]
    ds_read_b128 v[36:39], v45 offset:16384
    ds_read_b64_tr_b16 v[16:17], v40 offset:4096
    ds_read_b64_tr_b16 v[18:19], v40 offset:5120
    s_waitcnt lgkmcnt(7)
    v_mfma_f32_32x32x16_bf16 v[80:95], v[32:35], v[20:23], v[80:95]
    ds_read_b64_tr_b16 v[20:21], v41 offset:4096
    ds_read_b64_tr_b16 v[22:23], v41 offset:5120
    s_waitcnt lgkmcnt(7)
    v_mfma_f32_32x32x16_bf16 v[96:111], v[32:35], v[24:27], v[96:111]
    ds_read_b64_tr_b16 v[24:25], v42 offset:4096
    ds_read_b64_tr_b16 v[26:27], v42 offset:5120
    s_waitcnt lgkmcnt(7)
    v_mfma_f32_32x32x16_bf16 v[112:127], v[32:35], v[28:31], v[112:127]
    ds_read_b64_tr_b16 v[28:29], v43 offset:4096
    ds_read_b64_tr_b16 v[30:31], v43 offset:5120
    s_waitcnt lgkmcnt(6)
    v_mfma_f32_32x32x16_bf16 v[64:79], v[36:39], v[16:19], v[64:79]
    ds_read_b128 v[32:35], v46 offset:16384
    ds_read_b64_tr_b16 v[16:17], v40 offset:8192
    ds_read_b64_tr_b16 v[18:19], v40 offset:9216
    s_waitcnt lgkmcnt(7)
    v_mfma_f32_32x32x16_bf16 v[80:95], v[36:39], v[20:23], v[80:95]
    ds_read_b64_tr_b16 v[20:21], v41 offset:8192
    ds_read_b64_tr_b16 v[22:23], v41 offset:9216
    s_waitcnt lgkmcnt(7)
    v_mfma_f32_32x32x16_bf16 v[96:111], v[36:39], v[24:27], v[96:111]
    ds_read_b64_tr_b16 v[24:25], v42 offset:8192
    ds_read_b64_tr_b16 v[26:27], v42 offset:9216
    s_waitcnt lgkmcnt(7)
    v_mfma_f32_32x32x16_bf16 v[112:127], v[36:39], v[28:31], v[112:127]
    ds_read_b64_tr_b16 v[28:29], v43 offset:8192
    ds_read_b64_tr_b16 v[30:31], v43 offset:9216
    s_waitcnt lgkmcnt(6)
    v_mfma_f32_32x32x16_bf16 v[64:79], v[32:35], v[16:19], v[64:79]
    ds_read_b128 v[36:39], v47 offset:16384
    ds_read_b64_tr_b16 v[16:17], v40 offset:12288
    ds_read_b64_tr_b16 v[18:19], v40 offset:13312
    s_waitcnt lgkmcnt(7)
    v_mfma_f32_32x32x16_bf16 v[80:95], v[32:35], v[20:23], v[80:95]
    ds_read_b64_tr_b16 v[20:21], v41 offset:12288
    ds_read_b64_tr_b16 v[22:23], v41 offset:13312
    s_waitcnt lgkmcnt(7)
    v_mfma_f32_32x32x16_bf16 v[96:111], v[32:35], v[24:27], v[96:111]
    ds_read_b64_tr_b16 v[24:25], v42 offset:12288
    ds_read_b64_tr_b16 v[26:27], v42 offset:13312
    s_waitcnt lgkmcnt(7)
    v_mfma_f32_32x32x16_bf16 v[112:127], v[32:35], v[28:31], v[112:127]
    ds_read_b64_tr_b16 v[28:29], v43 offset:12288
    ds_read_b64_tr_b16 v[30:31], v43 offset:13312
    s_waitcnt lgkmcnt(6)
    v_mfma_f32_32x32x16_bf16 v[64:79], v[36:39], v[16:19], v[64:79]
    s_waitcnt lgkmcnt(4)
    v_mfma_f32_32x32x16_bf16 v[80:95], v[36:39], v[20:23], v[80:95]
    s_waitcnt lgkmcnt(0)
    s_barrier
    ds_read_b128 v[32:35], v44 offset:32768
    ds_read_b64_tr_b16 v[16:17], v40 offset:16384
    ds_read_b64_tr_b16 v[18:19], v40 offset:17408
    ds_read_b64_tr_b16 v[20:21], v41 offset:16384
    ds_read_b64_tr_b16 v[22:23], v41 offset:17408
    v_mfma_f32_32x32x16_bf16 v[96:111], v[36:39], v[24:27], v[96:111]
    ds_read_b64_tr_b16 v[24:25], v42 offset:16384
    ds_read_b64_tr_b16 v[26:27], v42 offset:17408
    v_mfma_f32_32x32x16_bf16 v[112:127], v[36:39], v[28:31], v[112:127]
    ds_read_b64_tr_b16 v[28:29], v43 offset:16384
    ds_read_b64_tr_b16 v[30:31], v43 offset:17408
    s_waitcnt lgkmcnt(6)
    v_mfma_f32_32x32x16_bf16 v[64:79], v[32:35], v[16:19], v[64:79]
    ds_read_b128 v[36:39], v45 offset:32768
    ds_read_b64_tr_b16 v[16:17], v40 offset:20480
    ds_read_b64_tr_b16 v[18:19], v40 offset:21504
    s_waitcnt lgkmcnt(7)
    v_mfma_f32_32x32x16_bf16 v[80:95], v[32:35], v[20:23], v[80:95]
    ds_read_b64_tr_b16 v[20:21], v41 offset:20480
    ds_read_b64_tr_b16 v[22:23], v41 offset:21504
    s_waitcnt lgkmcnt(7)
    v_mfma_f32_32x32x16_bf16 v[96:111], v[32:35], v[24:27], v[96:111]
    ds_read_b64_tr_b16 v[24:25], v42 offset:20480
    ds_read_b64_tr_b16 v[26:27], v42 offset:21504
    s_waitcnt lgkmcnt(7)
    v_mfma_f32_32x32x16_bf16 v[112:127], v[32:35], v[28:31], v[112:127]
    ds_read_b64_tr_b16 v[28:29], v43 offset:20480
    ds_read_b64_tr_b16 v[30:31], v43 offset:21504
    s_waitcnt lgkmcnt(6)
    v_mfma_f32_32x32x16_bf16 v[64:79], v[36:39], v[16:19], v[64:79]
    ds_read_b128 v[32:35], v46 offset:32768
    ds_read_b64_tr_b16 v[16:17], v40 offset:24576
    ds_read_b64_tr_b16 v[18:19], v40 offset:25600
    s_waitcnt lgkmcnt(7)
    v_mfma_f32_32x32x16_bf16 v[80:95], v[36:39], v[20:23], v[80:95]
    ds_read_b64_tr_b16 v[20:21], v41 offset:24576
    ds_read_b64_tr_b16 v[22:23], v41 offset:25600
    s_waitcnt lgkmcnt(7)
    v_mfma_f32_32x32x16_bf16 v[96:111], v[36:39], v[24:27], v[96:111]
    ds_read_b64_tr_b16 v[24:25], v42 offset:24576
    ds_read_b64_tr_b16 v[26:27], v42 offset:25600
    s_waitcnt lgkmcnt(7)
    v_mfma_f32_32x32x16_bf16 v[112:127], v[36:39], v[28:31], v[112:127]
    ds_read_b64_tr_b16 v[28:29], v43 offset:24576
    ds_read_b64_tr_b16 v[30:31], v43 offset:25600
    s_waitcnt lgkmcnt(6)
    v_mfma_f32_32x32x16_bf16 v[64:79], v[32:35], v[16:19], v[64:79]
    ds_read_b128 v[36:39], v47 offset:32768
    ds_read_b64_tr_b16 v[16:17], v40 offset:28672
    ds_read_b64_tr_b16 v[18:19], v40 offset:29696
    s_waitcnt lgkmcnt(7)
    v_mfma_f32_32x32x16_bf16 v[80:95], v[32:35], v[20:23], v[80:95]
    ds_read_b64_tr_b16 v[20:21], v41 offset:28672
    ds_read_b64_tr_b16 v[22:23], v41 offset:29696
    s_waitcnt lgkmcnt(7)
    v_mfma_f32_32x32x16_bf16 v[96:111], v[32:35], v[24:27], v[96:111]
    ds_read_b64_tr_b16 v[24:25], v42 offset:28672
    ds_read_b64_tr_b16 v[26:27], v42 offset:29696
    s_waitcnt lgkmcnt(7)
    v_mfma_f32_32x32x16_bf16 v[112:127], v[32:35], v[28:31], v[112:127]
    ds_read_b64_tr_b16 v[28:29], v43 offset:28672
    ds_read_b64_tr_b16 v[30:31], v43 offset:29696
    s_waitcnt lgkmcnt(6)
    v_mfma_f32_32x32x16_bf16 v[64:79], v[36:39], v[16:19], v[64:79]
    s_waitcnt lgkmcnt(4)
    v_mfma_f32_32x32x16_bf16 v[80:95], v[36:39], v[20:23], v[80:95]
    s_waitcnt lgkmcnt(0)
    s_barrier
    ds_read_b128 v[32:35], v44 offset:0
    ds_read_b64_tr_b16 v[16:17], v40 offset:32768
    ds_read_b64_tr_b16 v[18:19], v40 offset:33792
    ds_read_b64_tr_b16 v[20:21], v41 offset:32768
    ds_read_b64_tr_b16 v[22:23], v41 offset:33792
    v_mfma_f32_32x32x16_bf16 v[96:111], v[36:39], v[24:27], v[96:111]
    ds_read_b64_tr_b16 v[24:25], v42 offset:32768
    ds_read_b64_tr_b16 v[26:27], v42 offset:33792
    v_mfma_f32_32x32x16_bf16 v[112:127], v[36:39], v[28:31], v[112:127]
    ds_read_b64_tr_b16 v[28:29], v43 offset:32768
    ds_read_b64_tr_b16 v[30:31], v43 offset:33792
    s_waitcnt lgkmcnt(6)
    v_mfma_f32_32x32x16_bf16 v[64:79], v[32:35], v[16:19], v[64:79]
    ds_read_b128 v[36:39], v45 offset:0
    ds_read_b64_tr_b16 v[16:17], v40 offset:36864
    ds_read_b64_tr_b16 v[18:19], v40 offset:37888
    s_waitcnt lgkmcnt(7)
    v_mfma_f32_32x32x16_bf16 v[80:95], v[32:35], v[20:23], v[80:95]
    ds_read_b64_tr_b16 v[20:21], v41 offset:36864
    ds_read_b64_tr_b16 v[22:23], v41 offset:37888
    s_waitcnt lgkmcnt(7)
    v_mfma_f32_32x32x16_bf16 v[96:111], v[32:35], v[24:27], v[96:111]
    ds_read_b64_tr_b16 v[24:25], v42 offset:36864
    ds_read_b64_tr_b16 v[26:27], v42 offset:37888
    s_waitcnt lgkmcnt(7)
    v_mfma_f32_32x32x16_bf16 v[112:127], v[32:35], v[28:31], v[112:127]
    ds_read_b64_tr_b16 v[28:29], v43 offset:36864
    ds_read_b64_tr_b16 v[30:31], v43 offset:37888
    s_waitcnt lgkmcnt(6)
    v_mfma_f32_32x32x16_bf16 v[64:79], v[36:39], v[16:19], v[64:79]
    ds_read_b128 v[32:35], v46 offset:0
    ds_read_b64_tr_b16 v[16:17], v40 offset:40960
    ds_read_b64_tr_b16 v[18:19], v40 offset:41984
    s_waitcnt lgkmcnt(7)
    v_mfma_f32_32x32x16_bf16 v[80:95], v[36:39], v[20:23], v[80:95]
    ds_read_b64_tr_b16 v[20:21], v41 offset:40960
    ds_read_b64_tr_b16 v[22:23], v41 offset:41984
    s_waitcnt lgkmcnt(7)
    v_mfma_f32_32x32x16_bf16 v[96:111], v[36:39], v[24:27], v[96:111]
    ds_read_b64_tr_b16 v[24:25], v42 offset:40960
    ds_read_b64_tr_b16 v[26:27], v42 offset:41984
    s_waitcnt lgkmcnt(7)
    v_mfma_f32_32x32x16_bf16 v[112:127], v[36:39], v[28:31], v[112:127]
    ds_read_b64_tr_b16 v[28:29], v43 offset:40960
    ds_read_b64_tr_b16 v[30:31], v43 offset:41984
    s_waitcnt lgkmcnt(6)
    v_mfma_f32_32x32x16_bf16 v[64:79], v[32:35], v[16:19], v[64:79]
    ds_read_b128 v[36:39], v47 offset:0
    ds_read_b64_tr_b16 v[16:17], v40 offset:45056
    ds_read_b64_tr_b16 v[18:19], v40 offset:46080
    s_waitcnt lgkmcnt(7)
    v_mfma_f32_32x32x16_bf16 v[80:95], v[32:35], v[20:23], v[80:95]
    ds_read_b64_tr_b16 v[20:21], v41 offset:45056
    ds_read_b64_tr_b16 v[22:23], v41 offset:46080
    s_waitcnt lgkmcnt(7)
    v_mfma_f32_32x32x16_bf16 v[96:111], v[32:35], v[24:27], v[96:111]
    ds_read_b64_tr_b16 v[24:25], v42 offset:45056
    ds_read_b64_tr_b16 v[26:27], v42 offset:46080
    s_waitcnt lgkmcnt(7)
    v_mfma_f32_32x32x16_bf16 v[112:127], v[32:35], v[28:31], v[112:127]
    ds_read_b64_tr_b16 v[28:29], v43 offset:45056
    ds_read_b64_tr_b16 v[30:31], v43 offset:46080
    s_waitcnt lgkmcnt(6)
    v_mfma_f32_32x32x16_bf16 v[64:79], v[36:39], v[16:19], v[64:79]
    s_waitcnt lgkmcnt(4)
    v_mfma_f32_32x32x16_bf16 v[80:95], v[36:39], v[20:23], v[80:95]
    s_waitcnt lgkmcnt(0)
    s_barrier
    ds_read_b128 v[32:35], v44 offset:16384
    ds_read_b64_tr_b16 v[16:17], v40 offset:49152
    ds_read_b64_tr_b16 v[18:19], v40 offset:50176
    ds_read_b64_tr_b16 v[20:21], v41 offset:49152
    ds_read_b64_tr_b16 v[22:23], v41 offset:50176
    v_mfma_f32_32x32x16_bf16 v[96:111], v[36:39], v[24:27], v[96:111]
    ds_read_b64_tr_b16 v[24:25], v42 offset:49152
    ds_read_b64_tr_b16 v[26:27], v42 offset:50176
    v_mfma_f32_32x32x16_bf16 v[112:127], v[36:39], v[28:31], v[112:127]
    ds_read_b64_tr_b16 v[28:29], v43 offset:49152
    ds_read_b64_tr_b16 v[30:31], v43 offset:50176
    s_waitcnt lgkmcnt(6)
    v_mfma_f32_32x32x16_bf16 v[64:79], v[32:35], v[16:19], v[64:79]
    ds_read_b128 v[36:39], v45 offset:16384
    ds_read_b64_tr_b16 v[16:17], v40 offset:53248
    ds_read_b64_tr_b16 v[18:19], v40 offset:54272
    s_waitcnt lgkmcnt(7)
    v_mfma_f32_32x32x16_bf16 v[80:95], v[32:35], v[20:23], v[80:95]
    ds_read_b64_tr_b16 v[20:21], v41 offset:53248
    ds_read_b64_tr_b16 v[22:23], v41 offset:54272
    s_waitcnt lgkmcnt(7)
    v_mfma_f32_32x32x16_bf16 v[96:111], v[32:35], v[24:27], v[96:111]
    ds_read_b64_tr_b16 v[24:25], v42 offset:53248
    ds_read_b64_tr_b16 v[26:27], v42 offset:54272
    s_waitcnt lgkmcnt(7)
    v_mfma_f32_32x32x16_bf16 v[112:127], v[32:35], v[28:31], v[112:127]
    ds_read_b64_tr_b16 v[28:29], v43 offset:53248
    ds_read_b64_tr_b16 v[30:31], v43 offset:54272
    s_waitcnt lgkmcnt(6)
    v_mfma_f32_32x32x16_bf16 v[64:79], v[36:39], v[16:19], v[64:79]
    ds_read_b128 v[32:35], v46 offset:16384
    ds_read_b64_tr_b16 v[16:17], v40 offset:57344
    ds_read_b64_tr_b16 v[18:19], v40 offset:58368
    s_waitcnt lgkmcnt(7)
    v_mfma_f32_32x32x16_bf16 v[80:95], v[36:39], v[20:23], v[80:95]
    ds_read_b64_tr_b16 v[20:21], v41 offset:57344
    ds_read_b64_tr_b16 v[22:23], v41 offset:58368
    s_waitcnt lgkmcnt(7)
    v_mfma_f32_32x32x16_bf16 v[96:111], v[36:39], v[24:27], v[96:111]
    ds_read_b64_tr_b16 v[24:25], v42 offset:57344
    ds_read_b64_tr_b16 v[26:27], v42 offset:58368
    s_waitcnt lgkmcnt(7)
    v_mfma_f32_32x32x16_bf16 v[112:127], v[36:39], v[28:31], v[112:127]
    ds_read_b64_tr_b16 v[28:29], v43 offset:57344
    ds_read_b64_tr_b16 v[30:31], v43 offset:58368
    s_waitcnt lgkmcnt(6)
    v_mfma_f32_32x32x16_bf16 v[64:79], v[32:35], v[16:19], v[64:79]
    ds_read_b128 v[36:39], v47 offset:16384
    ds_read_b64_tr_b16 v[16:17], v40 offset:61440
    ds_read_b64_tr_b16 v[18:19], v40 offset:62464
    s_waitcnt lgkmcnt(7)
    v_mfma_f32_32x32x16_bf16 v[80:95], v[32:35], v[20:23], v[80:95]
    ds_read_b64_tr_b16 v[20:21], v41 offset:61440
    ds_read_b64_tr_b16 v[22:23], v41 offset:62464
    s_waitcnt lgkmcnt(7)
    v_mfma_f32_32x32x16_bf16 v[96:111], v[32:35], v[24:27], v[96:111]
    ds_read_b64_tr_b16 v[24:25], v42 offset:61440
    ds_read_b64_tr_b16 v[26:27], v42 offset:62464
    s_waitcnt lgkmcnt(7)
    v_mfma_f32_32x32x16_bf16 v[112:127], v[32:35], v[28:31], v[112:127]
    ds_read_b64_tr_b16 v[28:29], v43 offset:61440
    ds_read_b64_tr_b16 v[30:31], v43 offset:62464
    s_waitcnt lgkmcnt(6)
    v_mfma_f32_32x32x16_bf16 v[64:79], v[36:39], v[16:19], v[64:79]
    s_waitcnt lgkmcnt(4)
    v_mfma_f32_32x32x16_bf16 v[80:95], v[36:39], v[20:23], v[80:95]
    s_waitcnt lgkmcnt(0)
    s_barrier
    ds_read_b128 v[32:35], v44 offset:32768
    ds_read_b64_tr_b16 v[16:17], v40 offset:0
    ds_read_b64_tr_b16 v[18:19], v40 offset:1024
    ds_read_b64_tr_b16 v[20:21], v41 offset:0
    ds_read_b64_tr_b16 v[22:23], v41 offset:1024
    v_mfma_f32_32x32x16_bf16 v[96:111], v[36:39], v[24:27], v[96:111]
    ds_read_b64_tr_b16 v[24:25], v42 offset:0
    ds_read_b64_tr_b16 v[26:27], v42 offset:1024
    v_mfma_f32_32x32x16_bf16 v[112:127], v[36:39], v[28:31], v[112:127]
    ds_read_b64_tr_b16 v[28:29], v43 offset:0
    ds_read_b64_tr_b16 v[30:31], v43 offset:1024
    s_waitcnt lgkmcnt(6)
    v_mfma_f32_32x32x16_bf16 v[64:79], v[32:35], v[16:19], v[64:79]
    ds_read_b128 v[36:39], v45 offset:32768
    ds_read_b64_tr_b16 v[16:17], v40 offset:4096
    ds_read_b64_tr_b16 v[18:19], v40 offset:5120
    s_waitcnt lgkmcnt(7)
    v_mfma_f32_32x32x16_bf16 v[80:95], v[32:35], v[20:23], v[80:95]
    ds_read_b64_tr_b16 v[20:21], v41 offset:4096
    ds_read_b64_tr_b16 v[22:23], v41 offset:5120
    s_waitcnt lgkmcnt(7)
    v_mfma_f32_32x32x16_bf16 v[96:111], v[32:35], v[24:27], v[96:111]
    ds_read_b64_tr_b16 v[24:25], v42 offset:4096
    ds_read_b64_tr_b16 v[26:27], v42 offset:5120
    s_waitcnt lgkmcnt(7)
    v_mfma_f32_32x32x16_bf16 v[112:127], v[32:35], v[28:31], v[112:127]
    ds_read_b64_tr_b16 v[28:29], v43 offset:4096
    ds_read_b64_tr_b16 v[30:31], v43 offset:5120
    s_waitcnt lgkmcnt(6)
    v_mfma_f32_32x32x16_bf16 v[64:79], v[36:39], v[16:19], v[64:79]
    ds_read_b128 v[32:35], v46 offset:32768
    ds_read_b64_tr_b16 v[16:17], v40 offset:8192
    ds_read_b64_tr_b16 v[18:19], v40 offset:9216
    s_waitcnt lgkmcnt(7)
    v_mfma_f32_32x32x16_bf16 v[80:95], v[36:39], v[20:23], v[80:95]
    ds_read_b64_tr_b16 v[20:21], v41 offset:8192
    ds_read_b64_tr_b16 v[22:23], v41 offset:9216
    s_waitcnt lgkmcnt(7)
    v_mfma_f32_32x32x16_bf16 v[96:111], v[36:39], v[24:27], v[96:111]
    ds_read_b64_tr_b16 v[24:25], v42 offset:8192
    ds_read_b64_tr_b16 v[26:27], v42 offset:9216
    s_waitcnt lgkmcnt(7)
    v_mfma_f32_32x32x16_bf16 v[112:127], v[36:39], v[28:31], v[112:127]
    ds_read_b64_tr_b16 v[28:29], v43 offset:8192
    ds_read_b64_tr_b16 v[30:31], v43 offset:9216
    s_waitcnt lgkmcnt(6)
    v_mfma_f32_32x32x16_bf16 v[64:79], v[32:35], v[16:19], v[64:79]
    ds_read_b128 v[36:39], v47 offset:32768
    ds_read_b64_tr_b16 v[16:17], v40 offset:12288
    ds_read_b64_tr_b16 v[18:19], v40 offset:13312
    s_waitcnt lgkmcnt(7)
    v_mfma_f32_32x32x16_bf16 v[80:95], v[32:35], v[20:23], v[80:95]
    ds_read_b64_tr_b16 v[20:21], v41 offset:12288
    ds_read_b64_tr_b16 v[22:23], v41 offset:13312
    s_waitcnt lgkmcnt(7)
    v_mfma_f32_32x32x16_bf16 v[96:111], v[32:35], v[24:27], v[96:111]
    ds_read_b64_tr_b16 v[24:25], v42 offset:12288
    ds_read_b64_tr_b16 v[26:27], v42 offset:13312
    s_waitcnt lgkmcnt(7)
    v_mfma_f32_32x32x16_bf16 v[112:127], v[32:35], v[28:31], v[112:127]
    ds_read_b64_tr_b16 v[28:29], v43 offset:12288
    ds_read_b64_tr_b16 v[30:31], v43 offset:13312
    s_waitcnt lgkmcnt(6)
    v_mfma_f32_32x32x16_bf16 v[64:79], v[36:39], v[16:19], v[64:79]
    s_waitcnt lgkmcnt(4)
    v_mfma_f32_32x32x16_bf16 v[80:95], v[36:39], v[20:23], v[80:95]
    s_waitcnt lgkmcnt(0)
    s_barrier
    ds_read_b128 v[32:35], v44 offset:0
    ds_read_b64_tr_b16 v[16:17], v40 offset:16384
    ds_read_b64_tr_b16 v[18:19], v40 offset:17408
    ds_read_b64_tr_b16 v[20:21], v41 offset:16384
    ds_read_b64_tr_b16 v[22:23], v41 offset:17408
    v_mfma_f32_32x32x16_bf16 v[96:111], v[36:39], v[24:27], v[96:111]
    ds_read_b64_tr_b16 v[24:25], v42 offset:16384
    ds_read_b64_tr_b16 v[26:27], v42 offset:17408
    v_mfma_f32_32x32x16_bf16 v[112:127], v[36:39], v[28:31], v[112:127]
    ds_read_b64_tr_b16 v[28:29], v43 offset:16384
    ds_read_b64_tr_b16 v[30:31], v43 offset:17408
    s_waitcnt lgkmcnt(6)
    v_mfma_f32_32x32x16_bf16 v[64:79], v[32:35], v[16:19], v[64:79]
    ds_read_b128 v[36:39], v45 offset:0
    ds_read_b64_tr_b16 v[16:17], v40 offset:20480
    ds_read_b64_tr_b16 v[18:19], v40 offset:21504
    s_waitcnt lgkmcnt(7)
    v_mfma_f32_32x32x16_bf16 v[80:95], v[32:35], v[20:23], v[80:95]
    ds_read_b64_tr_b16 v[20:21], v41 offset:20480
    ds_read_b64_tr_b16 v[22:23], v41 offset:21504
    s_waitcnt lgkmcnt(7)
    v_mfma_f32_32x32x16_bf16 v[96:111], v[32:35], v[24:27], v[96:111]
    ds_read_b64_tr_b16 v[24:25], v42 offset:20480
    ds_read_b64_tr_b16 v[26:27], v42 offset:21504
    s_waitcnt lgkmcnt(7)
    v_mfma_f32_32x32x16_bf16 v[112:127], v[32:35], v[28:31], v[112:127]
    ds_read_b64_tr_b16 v[28:29], v43 offset:20480
    ds_read_b64_tr_b16 v[30:31], v43 offset:21504
    s_waitcnt lgkmcnt(6)
    v_mfma_f32_32x32x16_bf16 v[64:79], v[36:39], v[16:19], v[64:79]
    ds_read_b128 v[32:35], v46 offset:0
    ds_read_b64_tr_b16 v[16:17], v40 offset:24576
    ds_read_b64_tr_b16 v[18:19], v40 offset:25600
    s_waitcnt lgkmcnt(7)
    v_mfma_f32_32x32x16_bf16 v[80:95], v[36:39], v[20:23], v[80:95]
    ds_read_b64_tr_b16 v[20:21], v41 offset:24576
    ds_read_b64_tr_b16 v[22:23], v41 offset:25600
    s_waitcnt lgkmcnt(7)
    v_mfma_f32_32x32x16_bf16 v[96:111], v[36:39], v[24:27], v[96:111]
    ds_read_b64_tr_b16 v[24:25], v42 offset:24576
    ds_read_b64_tr_b16 v[26:27], v42 offset:25600
    s_waitcnt lgkmcnt(7)
    v_mfma_f32_32x32x16_bf16 v[112:127], v[36:39], v[28:31], v[112:127]
    ds_read_b64_tr_b16 v[28:29], v43 offset:24576
    ds_read_b64_tr_b16 v[30:31], v43 offset:25600
    s_waitcnt lgkmcnt(6)
    v_mfma_f32_32x32x16_bf16 v[64:79], v[32:35], v[16:19], v[64:79]
    ds_read_b128 v[36:39], v47 offset:0
    ds_read_b64_tr_b16 v[16:17], v40 offset:28672
    ds_read_b64_tr_b16 v[18:19], v40 offset:29696
    s_waitcnt lgkmcnt(7)
    v_mfma_f32_32x32x16_bf16 v[80:95], v[32:35], v[20:23], v[80:95]
    ds_read_b64_tr_b16 v[20:21], v41 offset:28672
    ds_read_b64_tr_b16 v[22:23], v41 offset:29696
    s_waitcnt lgkmcnt(7)
    v_mfma_f32_32x32x16_bf16 v[96:111], v[32:35], v[24:27], v[96:111]
    ds_read_b64_tr_b16 v[24:25], v42 offset:28672
    ds_read_b64_tr_b16 v[26:27], v42 offset:29696
    s_waitcnt lgkmcnt(7)
    v_mfma_f32_32x32x16_bf16 v[112:127], v[32:35], v[28:31], v[112:127]
    ds_read_b64_tr_b16 v[28:29], v43 offset:28672
    ds_read_b64_tr_b16 v[30:31], v43 offset:29696
    s_waitcnt lgkmcnt(6)
    v_mfma_f32_32x32x16_bf16 v[64:79], v[36:39], v[16:19], v[64:79]
    s_waitcnt lgkmcnt(4)
    v_mfma_f32_32x32x16_bf16 v[80:95], v[36:39], v[20:23], v[80:95]
    s_waitcnt lgkmcnt(2)
    v_mfma_f32_32x32x16_bf16 v[96:111], v[36:39], v[24:27], v[96:111]
    s_waitcnt lgkmcnt(0)
    v_mfma_f32_32x32x16_bf16 v[112:127], v[36:39], v[28:31], v[112:127]
    s_nop 11
    v_cvt_pk_bf16_f32 v16, v64, v65
    v_cvt_pk_bf16_f32 v17, v66, v67
    v_cvt_pk_bf16_f32 v18, v68, v69
    v_cvt_pk_bf16_f32 v19, v70, v71
    buffer_store_dwordx4 v[16:19], v128, s[56:59], s78 offen offset:1280 sc1
    v_cvt_pk_bf16_f32 v20, v72, v73
    v_cvt_pk_bf16_f32 v21, v74, v75
    v_cvt_pk_bf16_f32 v22, v76, v77
    v_cvt_pk_bf16_f32 v23, v78, v79
    buffer_store_dwordx4 v[20:23], v128, s[56:59], s78 offen offset:1920 sc1
    v_cvt_pk_bf16_f32 v24, v80, v81
    v_cvt_pk_bf16_f32 v25, v82, v83
    v_cvt_pk_bf16_f32 v26, v84, v85
    v_cvt_pk_bf16_f32 v27, v86, v87
    buffer_store_dwordx4 v[24:27], v129, s[56:59], s78 offen offset:1280 sc1
    v_cvt_pk_bf16_f32 v28, v88, v89
    v_cvt_pk_bf16_f32 v29, v90, v91
    v_cvt_pk_bf16_f32 v30, v92, v93
    v_cvt_pk_bf16_f32 v31, v94, v95
    buffer_store_dwordx4 v[28:31], v129, s[56:59], s78 offen offset:1920 sc1
    v_cvt_pk_bf16_f32 v16, v96, v97
    v_cvt_pk_bf16_f32 v17, v98, v99
    v_cvt_pk_bf16_f32 v18, v100, v101
    v_cvt_pk_bf16_f32 v19, v102, v103
    buffer_store_dwordx4 v[16:19], v130, s[56:59], s78 offen offset:1280 sc1
    v_cvt_pk_bf16_f32 v20, v104, v105
    v_cvt_pk_bf16_f32 v21, v106, v107
    v_cvt_pk_bf16_f32 v22, v108, v109
    v_cvt_pk_bf16_f32 v23, v110, v111
    buffer_store_dwordx4 v[20:23], v130, s[56:59], s78 offen offset:1920 sc1
    v_cvt_pk_bf16_f32 v24, v112, v113
    v_cvt_pk_bf16_f32 v25, v114, v115
    v_cvt_pk_bf16_f32 v26, v116, v117
    v_cvt_pk_bf16_f32 v27, v118, v119
    buffer_store_dwordx4 v[24:27], v131, s[56:59], s78 offen offset:1280 sc1
    v_cvt_pk_bf16_f32 v28, v120, v121
    v_cvt_pk_bf16_f32 v29, v122, v123
    v_cvt_pk_bf16_f32 v30, v124, v125
    v_cvt_pk_bf16_f32 v31, v126, v127
    buffer_store_dwordx4 v[28:31], v131, s[56:59], s78 offen offset:1920 sc1
P1_fin_21:
    s_waitcnt vmcnt(0)
    s_barrier
    s_lshl_b32 s71, s69, 4
    s_add_u32 s71, s71, s68
    s_cmp_lg_u32 s40, 0
    s_cbranch_scc1 sig_30
    s_lshl_b32 s94, s71, 6
    s_add_u32 s94, s94, 16448
    v_mov_b32 v250, s41
    v_mov_b32 v251, 0
    s_mov_b64 exec, 1
    buffer_store_dword v250, v251, s[96:99], s94 offen sc1
    s_mov_b64 exec, -1
sig_30:
    s_branch P1_end_18
P1_spare_19:
P1_end_18:
    s_and_b32 s68, s2, 31
    s_lshr_b32 s72, s2, 5
    s_lshl_b32 s72, s72, 3
    s_add_u32 s69, s72, s40
    s_add_u32 s44, s38, 0x800000
    s_addc_u32 s45, s39, 0
    s_mov_b32 s46, 0x280000
    s_mov_b32 s47, 0x20000
    s_add_u32 s48, s38, 0xc00000
    s_addc_u32 s49, s39, 0
    s_mov_b32 s50, 0x500000
    s_mov_b32 s51, 0x20000
    s_add_u32 s52, s38, 0x1400000
    s_addc_u32 s53, s39, 0
    s_mov_b32 s54, 0x280000
    s_mov_b32 s55, 0x20000
    v_lshlrev_b32 v1, 4, v0
    v_and_b32 v2, 31, v0
    v_lshrrev_b32 v3, 5, v0
    v_and_b32 v6, 15, v0
    v_mov_b32 v7, 0x1221
    v_lshrrev_b32 v7, v6, v7
    v_and_b32 v7, 1, v7
    v_mul_u32_u24 v7, 0x3f80, v7
    v_lshl_or_b32 v7, v7, 16, v7
    v_mov_b32 v32, v7
    v_mov_b32 v33, v7
    v_mov_b32 v34, v7
    v_mov_b32 v35, v7
    v_lshrrev_b32 v6, 4, v0
    s_lshl_b32 s74, s40, 2
    v_add_u32 v6, s74, v6
    v_lshrrev_b32 v7, 1, v6
    v_mul_u32_u24 v7, 2560, v7
    v_and_b32 v6, 1, v6
    v_mul_u32_u24 v6, 640, v6
    v_add_u32 v7, v7, v6
    v_and_b32 v6, 15, v0
    v_lshl_add_u32 v7, v6, 4, v7
    v_add_u32 v7, 124160, v7
    ds_write_b128 v7, v[32:35]
    v_lshlrev_b32 v4, 3, v2
    v_add_u32 v4, 1024, v4
    v_mul_u32_u24 v6, 320, v3
    v_lshl_add_u32 v6, v2, 4, v6
    v_cmp_gt_u32 vcc, 28, v2
    v_mov_b32 v7, 192
    v_mov_b32 v14, 64
    v_cndmask_b32 v7, v7, v14, vcc
    v_lshlrev_b32 v14, 6, v3
    v_add_u32 v7, v7, v14
    v_and_b32 v7, 255, v7
    v_cmp_eq_u32 vcc, 24, v2
    v_add_u32 v14, 16, v7
    s_nop 0
    v_cndmask_b32 v7, v7, v14, vcc
    v_cmp_lt_u32 vcc, 28, v2
    v_add_u32 v14, 16, v7
    s_nop 0
    v_cndmask_b32 v7, v7, v14, vcc
    v_add_u32 v7, 122880, v7
    v_cmp_gt_u32 vcc, 20, v2
    v_lshlrev_b32 v129, 3, v2
    v_lshl_add_u32 v129, v3, 8, v129
    v_add_u32 v120, 0, v129
    v_add_u32 v123, 0, v4
    v_add_u32 v14, 0, v6
    v_cndmask_b32 v126, v7, v14, vcc
    v_add_u32 v121, 40960, v129
    v_add_u32 v124, 40960, v4
    v_add_u32 v14, 40960, v6
    v_cndmask_b32 v127, v7, v14, vcc
    v_add_u32 v122, 81920, v129
    v_add_u32 v125, 81920, v4
    v_add_u32 v14, 81920, v6
    v_cndmask_b32 v128, v7, v14, vcc
    s_lshl_b32 s71, s68, 6
    s_add_u32 s71, s71, s69
    s_mul_i32 s76, s71, 1280
    s_mul_i32 s77, s68, 163840
    s_lshl_b32 s73, s40, 10
    v_add_u32 v5, s73, v1
    v_mov_b32 v12, 0
    v_mov_b32 v13, 0
    s_mov_b32 s84, 0
    s_mov_b32 s56, s20
    s_mov_b32 s57, s21
    s_mov_b32 s58, 0xc8000
    s_mov_b32 s59, 0x20000
    s_add_u32 s60, s38, 0x1800000
    s_addc_u32 s61, s39, 0
    s_mov_b32 s62, 0xc8000
    s_mov_b32 s63, 0x20000
    s_mov_b32 s85, 0
    s_mov_b32 s78, 0
    v_mov_b32 v160, 0
    v_mov_b32 v161, 0
    v_mov_b32 v162, 0
    v_mov_b32 v163, 0
    v_mov_b32 v164, 0
    s_lshl_b32 s79, s40, 8
    s_add_u32 s79, s79, s2
    s_cmp_lt_u32 s79, 1280
    s_cbranch_scc1 rt_gu_31
    s_cmp_lt_u32 s79, 1664
    s_cbranch_scc1 rt_d_32
    s_cmp_lt_u32 s79, 1824
    s_cbranch_scc1 rt_o_33
    s_branch rt_n_34
rt_gu_31:
    s_mov_b32 s84, 3
    v_add_u32 v136, 0, v0
    v_mul_u32_u24 v137, 87382, v136
    v_lshrrev_b32 v137, 20, v137
    v_mul_u32_u24 v138, 12, v137
    v_sub_u32 v138, v136, v138
    v_mul_u32_u24 v137, 3072, v137
    v_lshl_add_u32 v160, v138, 4, v137
    v_add_u32 v136, 64, v0
    v_mul_u32_u24 v137, 87382, v136
    v_lshrrev_b32 v137, 20, v137
    v_mul_u32_u24 v138, 12, v137
    v_sub_u32 v138, v136, v138
    v_mul_u32_u24 v137, 3072, v137
    v_lshl_add_u32 v161, v138, 4, v137
    v_add_u32 v136, 128, v0
    v_mul_u32_u24 v137, 87382, v136
    v_lshrrev_b32 v137, 20, v137
    v_mul_u32_u24 v138, 12, v137
    v_sub_u32 v138, v136, v138
    v_mul_u32_u24 v137, 3072, v137
    v_lshl_add_u32 v162, v138, 4, v137
    s_and_b32 s80, s79, 1
    s_lshr_b32 s79, s79, 1
    s_mul_hi_u32 s81, s79, 0x6666667
    s_mul_i32 s82, s81, 40
    s_sub_u32 s82, s79, s82
    s_cmp_eq_u32 s80, 0
    s_cselect_b32 s56, s24, s26
    s_cselect_b32 s57, s25, s27
    s_mov_b32 s58, 0x1e0000
    s_mov_b32 s59, 0x20000
    s_add_u32 s60, s38, 0x2100000
    s_addc_u32 s61, s39, 0
    s_mov_b32 s62, 0x3c0000
    s_mov_b32 s63, 0x20000
    s_mul_i32 s85, s82, 49152
    s_mul_i32 s83, s81, 192
    s_add_u32 s85, s85, s83
    s_mul_i32 s78, s81, 245760
    s_lshr_b32 s83, s82, 2
    s_mul_i32 s83, s83, 24576
    s_add_u32 s78, s78, s83
    s_mul_i32 s83, s80, 12288
    s_add_u32 s78, s78, s83
    s_and_b32 s83, s82, 3
    s_mul_i32 s83, s83, 3072
    s_add_u32 s78, s78, s83
    s_branch rt_n_34
rt_d_32:
    s_mov_b32 s84, 5
    v_add_u32 v136, 0, v0
    v_mul_u32_u24 v137, 104858, v136
    v_lshrrev_b32 v137, 20, v137
    v_mul_u32_u24 v138, 10, v137
    v_sub_u32 v138, v136, v138
    v_mul_u32_u24 v137, 1280, v137
    v_lshl_add_u32 v160, v138, 4, v137
    v_add_u32 v136, 64, v0
    v_mul_u32_u24 v137, 104858, v136
    v_lshrrev_b32 v137, 20, v137
    v_mul_u32_u24 v138, 10, v137
    v_sub_u32 v138, v136, v138
    v_mul_u32_u24 v137, 1280, v137
    v_lshl_add_u32 v161, v138, 4, v137
    v_add_u32 v136, 128, v0
    v_mul_u32_u24 v137, 104858, v136
    v_lshrrev_b32 v137, 20, v137
    v_mul_u32_u24 v138, 10, v137
    v_sub_u32 v138, v136, v138
    v_mul_u32_u24 v137, 1280, v137
    v_lshl_add_u32 v162, v138, 4, v137
    v_add_u32 v136, 192, v0
    v_mul_u32_u24 v137, 104858, v136
    v_lshrrev_b32 v137, 20, v137
    v_mul_u32_u24 v138, 10, v137
    v_sub_u32 v138, v136, v138
    v_mul_u32_u24 v137, 1280, v137
    v_lshl_add_u32 v163, v138, 4, v137
    v_add_u32 v136, 256, v0
    v_mul_u32_u24 v137, 104858, v136
    v_lshrrev_b32 v137, 20, v137
    v_mul_u32_u24 v138, 10, v137
    v_sub_u32 v138, v136, v138
    v_mul_u32_u24 v137, 1280, v137
    v_lshl_add_u32 v164, v138, 4, v137
    s_sub_u32 s79, s79, 1280
    s_mul_hi_u32 s81, s79, 0x5555556
    s_mul_i32 s82, s81, 48
    s_sub_u32 s82, s79, s82
    s_mov_b32 s56, s28
    s_mov_b32 s57, s29
    s_mov_b32 s58, 0x1e0000
    s_mov_b32 s59, 0x20000
    s_add_u32 s60, s38, 0x2c00000
    s_addc_u32 s61, s39, 0
    s_mov_b32 s62, 0x1e0000
    s_mov_b32 s63, 0x20000
    s_mul_i32 s85, s82, 40960
    s_mul_i32 s83, s81, 160
    s_add_u32 s85, s85, s83
    s_mul_i32 s78, s81, 245760
    s_mul_i32 s83, s82, 5120
    s_add_u32 s78, s78, s83
    s_branch rt_n_34
rt_o_33:
    s_mov_b32 s84, 5
    v_add_u32 v136, 0, v0
    v_mul_u32_u24 v137, 104858, v136
    v_lshrrev_b32 v137, 20, v137
    v_mul_u32_u24 v138, 10, v137
    v_sub_u32 v138, v136, v138
    v_mul_u32_u24 v137, 1280, v137
    v_lshl_add_u32 v160, v138, 4, v137
    v_add_u32 v136, 64, v0
    v_mul_u32_u24 v137, 104858, v136
    v_lshrrev_b32 v137, 20, v137
    v_mul_u32_u24 v138, 10, v137
    v_sub_u32 v138, v136, v138
    v_mul_u32_u24 v137, 1280, v137
    v_lshl_add_u32 v161, v138, 4, v137
    v_add_u32 v136, 128, v0
    v_mul_u32_u24 v137, 104858, v136
    v_lshrrev_b32 v137, 20, v137
    v_mul_u32_u24 v138, 10, v137
    v_sub_u32 v138, v136, v138
    v_mul_u32_u24 v137, 1280, v137
    v_lshl_add_u32 v162, v138, 4, v137
    v_add_u32 v136, 192, v0
    v_mul_u32_u24 v137, 104858, v136
    v_lshrrev_b32 v137, 20, v137
    v_mul_u32_u24 v138, 10, v137
    v_sub_u32 v138, v136, v138
    v_mul_u32_u24 v137, 1280, v137
    v_lshl_add_u32 v163, v138, 4, v137
    v_add_u32 v136, 256, v0
    v_mul_u32_u24 v137, 104858, v136
    v_lshrrev_b32 v137, 20, v137
    v_mul_u32_u24 v138, 10, v137
    v_sub_u32 v138, v136, v138
    v_mul_u32_u24 v137, 1280, v137
    v_lshl_add_u32 v164, v138, 4, v137
    s_sub_u32 s79, s79, 1664
    s_mul_hi_u32 s81, s79, 0xccccccd
    s_mul_i32 s82, s81, 20
    s_sub_u32 s82, s79, s82
    s_mov_b32 s56, s20
    s_mov_b32 s57, s21
    s_mov_b32 s58, 0xc8000
    s_mov_b32 s59, 0x20000
    s_add_u32 s60, s38, 0x1800000
    s_addc_u32 s61, s39, 0
    s_mov_b32 s62, 0xc8000
    s_mov_b32 s63, 0x20000
    s_mul_i32 s85, s82, 40960
    s_mul_i32 s83, s81, 160
    s_add_u32 s85, s85, s83
    s_mul_i32 s78, s81, 102400
    s_mul_i32 s83, s82, 5120
    s_add_u32 s78, s78, s83
rt_n_34:
    s_mul_i32 s71, s68, 20
    s_lshr_b32 s72, s71, 7
    s_add_u32 s71, s71, 19
    s_lshr_b32 s71, s71, 7
    v_min_u32 v242, 47, v0
    v_lshrrev_b32 v243, 4, v242
    v_mul_u32_u24 v243, 80, v243
    v_and_b32 v242, 15, v242
    v_add_u32 v242, v242, v243
    s_lshl_b32 s72, s72, 4
    s_lshl_b32 s71, s71, 4
    v_add_u32 v240, s72, v242
    v_add_u32 v241, s71, v242
    s_cmp_lg_u32 s40, 0
    s_cbranch_scc1 wf_35
    s_cmp_lg_u32 s42, 0
    s_cbranch_scc1 wf_35
    v_lshlrev_b32 v240, 6, v240
    v_add_u32 v240, 16448, v240
    v_lshlrev_b32 v241, 6, v241
    v_add_u32 v241, 16448, v241
    s_mov_b32 s94, 30000
wf_poll_36:
    buffer_load_dword v250, v240, s[96:99], 0 offen sc1
    buffer_load_dword v251, v241, s[96:99], 0 offen sc1
    s_waitcnt vmcnt(0)
    v_cmp_ne_u32 vcc, s41, v250
    v_cmp_ne_u32 s[92:93], s41, v251
    s_nop 1
    s_or_b64 vcc, vcc, s[92:93]
    s_nop 1
    s_cbranch_vccz wf_35
    s_sleep 1
    s_sub_u32 s94, s94, 1
    s_cmp_lg_u32 s94, 0
    s_cbranch_scc1 wf_poll_36
wf_done_37:
    s_mov_b32 s42, 1
wf_35:
    s_barrier
    buffer_load_dwordx2 v[8:9], v129, s[44:47], s76 offen sc1
    buffer_load_dwordx2 v[10:11], v129, s[44:47], s76 offen offset:512 sc1
    s_mov_b32 exec_lo, -1
    s_mov_b32 exec_hi, 0
    buffer_load_dwordx2 v[12:13], v4, s[44:47], s76 offen sc1
    s_mov_b64 exec, -1
    buffer_load_dwordx2 v[88:89], v129, s[48:51], s77 offen sc1
    buffer_load_dwordx2 v[90:91], v129, s[48:51], s77 offen offset:512 sc1
    buffer_load_dwordx2 v[92:93], v4, s[48:51], s77 offen sc1
    s_add_u32 m0, s73, 0
    s_add_u32 s74, s77, 0
    buffer_load_dwordx4 v5, s[48:51], s74 offen sc1 lds
    s_add_u32 m0, s73, 8192
    s_add_u32 s74, s77, 8192
    buffer_load_dwordx4 v5, s[48:51], s74 offen sc1 lds
    s_add_u32 m0, s73, 16384
    s_add_u32 s74, s77, 16384
    buffer_load_dwordx4 v5, s[48:51], s74 offen sc1 lds
    s_add_u32 m0, s73, 24576
    s_add_u32 s74, s77, 24576
    buffer_load_dwordx4 v5, s[48:51], s74 offen sc1 lds
    s_add_u32 m0, s73, 32768
    s_add_u32 s74, s77, 32768
    buffer_load_dwordx4 v5, s[48:51], s74 offen sc1 lds
    s_waitcnt vmcnt(5)
    v_mfma_f32_32x32x16_bf16 v[32:47], v[88:91], v[8:11], 0
    v_mfma_f32_32x32x8bf16_1k v[32:47], v[92:93], v[12:13], v[32:47]
    s_add_u32 m0, s73, 40960
    s_add_u32 s74, s77, 40960
    buffer_load_dwordx4 v5, s[48:51], s74 offen sc1 lds
    s_add_u32 m0, s73, 49152
    s_add_u32 s74, s77, 49152
    buffer_load_dwordx4 v5, s[48:51], s74 offen sc1 lds
    s_add_u32 m0, s73, 57344
    s_add_u32 s74, s77, 57344
    buffer_load_dwordx4 v5, s[48:51], s74 offen sc1 lds
    s_add_u32 m0, s73, 65536
    s_add_u32 s74, s77, 65536
    buffer_load_dwordx4 v5, s[48:51], s74 offen sc1 lds
    s_add_u32 m0, s73, 73728
    s_add_u32 s74, s77, 73728
    buffer_load_dwordx4 v5, s[48:51], s74 offen sc1 lds
    s_nop 1
    v_max3_f32 v15, v32, v33, v34
    v_max3_f32 v15, v15, v35, v36
    v_max3_f32 v15, v15, v37, v38
    v_max3_f32 v15, v15, v39, v40
    v_max3_f32 v15, v15, v41, v42
    v_max3_f32 v15, v15, v43, v44
    v_max3_f32 v15, v15, v45, v46
    v_max_f32 v15, v15, v47
    v_mov_b32 v14, v15
    s_nop 1
    v_permlane32_swap_b32 v15, v14
    s_nop 1
    v_max_f32 v15, v15, v14
    v_sub_f32 v16, 0, v15
    v_sub_f32 v17, 0, v15
    v_sub_f32 v18, 0, v15
    v_sub_f32 v19, 0, v15
    v_sub_f32 v20, 0, v15
    v_sub_f32 v21, 0, v15
    v_sub_f32 v22, 0, v15
    v_sub_f32 v23, 0, v15
    v_sub_f32 v24, 0, v15
    v_sub_f32 v25, 0, v15
    v_sub_f32 v26, 0, v15
    v_sub_f32 v27, 0, v15
    v_sub_f32 v28, 0, v15
    v_sub_f32 v29, 0, v15
    v_sub_f32 v30, 0, v15
    v_sub_f32 v31, 0, v15
    s_waitcnt vmcnt(9)
    s_waitcnt lgkmcnt(0)
    s_barrier
    ds_read2st64_b64 v[88:91], v120 offset0:0 offset1:1
    ds_read_b64 v[92:93], v123 offset:0
    ds_read2st64_b64 v[96:99], v120 offset0:5 offset1:6
    ds_read_b64 v[100:101], v123 offset:2560
    ds_read_b128 v[104:107], v126 offset:1280
    ds_read_b128 v[108:111], v126 offset:1920
    s_waitcnt lgkmcnt(4)
    v_mfma_f32_32x32x16_bf16 v[32:47], v[88:91], v[8:11], v[16:31]
    v_mfma_f32_32x32x8bf16_1k v[32:47], v[92:93], v[12:13], v[32:47]
    s_nop 7
    s_waitcnt lgkmcnt(0)
    v_mfma_f32_32x32x16_bf16 v[48:63], v[96:99], v[8:11], v[16:31]
    ds_read2st64_b64 v[88:91], v120 offset0:10 offset1:11
    ds_read_b64 v[92:93], v123 offset:5120
    ds_read_b128 v[112:115], v126 offset:3840
    ds_read_b128 v[116:119], v126 offset:4480
    v_exp_f32 v32, v32
    v_exp_f32 v33, v33
    v_exp_f32 v34, v34
    v_cvt_pk_bf16_f32 v80, v32, v33
    v_exp_f32 v35, v35
    v_exp_f32 v36, v36
    s_add_u32 m0, s73, 81920
    s_add_u32 s74, s77, 81920
    buffer_load_dwordx4 v5, s[48:51], s74 offen sc1 lds
    v_cvt_pk_bf16_f32 v81, v34, v35
    v_exp_f32 v37, v37
    v_exp_f32 v38, v38
    v_cvt_pk_bf16_f32 v82, v36, v37
    v_exp_f32 v39, v39
    v_exp_f32 v40, v40
    v_mfma_f32_32x32x8bf16_1k v[48:63], v[100:101], v[12:13], v[48:63]
    v_cvt_pk_bf16_f32 v83, v38, v39
    v_exp_f32 v41, v41
    v_exp_f32 v42, v42
    v_cvt_pk_bf16_f32 v84, v40, v41
    v_exp_f32 v43, v43
    v_exp_f32 v44, v44
    v_mfma_f32_32x32x16_bf16 v[64:79], v[104:107], v[80:83], 0
    v_cvt_pk_bf16_f32 v85, v42, v43
    v_exp_f32 v45, v45
    v_exp_f32 v46, v46
    v_exp_f32 v47, v47
    v_cvt_pk_bf16_f32 v86, v44, v45
    v_cvt_pk_bf16_f32 v87, v46, v47
    s_waitcnt vmcnt(6)
    s_barrier
    s_waitcnt lgkmcnt(0)
    v_mfma_f32_32x32x16_bf16 v[32:47], v[88:91], v[8:11], v[16:31]
    ds_read2st64_b64 v[96:99], v120 offset0:15 offset1:16
    ds_read_b64 v[100:101], v123 offset:7680
    ds_read_b128 v[104:107], v126 offset:6400
    ds_read_b128 v[132:135], v126 offset:7040
    v_exp_f32 v48, v48
    v_exp_f32 v49, v49
    v_exp_f32 v50, v50
    v_cvt_pk_bf16_f32 v80, v48, v49
    v_exp_f32 v51, v51
    v_exp_f32 v52, v52
    v_mfma_f32_32x32x16_bf16 v[64:79], v[108:111], v[84:87], v[64:79]
    s_add_u32 m0, s73, 90112
    s_add_u32 s74, s77, 90112
    buffer_load_dwordx4 v5, s[48:51], s74 offen sc1 lds
    v_cvt_pk_bf16_f32 v81, v50, v51
    v_exp_f32 v53, v53
    v_exp_f32 v54, v54
    v_cvt_pk_bf16_f32 v82, v52, v53
    v_exp_f32 v55, v55
    v_exp_f32 v56, v56
    v_mfma_f32_32x32x8bf16_1k v[32:47], v[92:93], v[12:13], v[32:47]
    v_cvt_pk_bf16_f32 v83, v54, v55
    v_exp_f32 v57, v57
    v_exp_f32 v58, v58
    v_cvt_pk_bf16_f32 v84, v56, v57
    v_exp_f32 v59, v59
    v_exp_f32 v60, v60
    v_mfma_f32_32x32x16_bf16 v[64:79], v[112:115], v[80:83], v[64:79]
    v_cvt_pk_bf16_f32 v85, v58, v59
    v_exp_f32 v61, v61
    v_exp_f32 v62, v62
    v_exp_f32 v63, v63
    v_cvt_pk_bf16_f32 v86, v60, v61
    v_cvt_pk_bf16_f32 v87, v62, v63
    s_waitcnt lgkmcnt(0)
    v_mfma_f32_32x32x16_bf16 v[48:63], v[96:99], v[8:11], v[16:31]
    ds_read2st64_b64 v[88:91], v120 offset0:20 offset1:21
    ds_read_b64 v[92:93], v123 offset:10240
    ds_read_b128 v[112:115], v126 offset:8960
    ds_read_b128 v[108:111], v126 offset:9600
    v_exp_f32 v32, v32
    v_exp_f32 v33, v33
    v_exp_f32 v34, v34
    v_cvt_pk_bf16_f32 v80, v32, v33
    v_exp_f32 v35, v35
    v_exp_f32 v36, v36
    v_mfma_f32_32x32x16_bf16 v[64:79], v[116:119], v[84:87], v[64:79]
    s_add_u32 m0, s73, 98304
    s_add_u32 s74, s77, 98304
    buffer_load_dwordx4 v5, s[48:51], s74 offen sc1 lds
    v_cvt_pk_bf16_f32 v81, v34, v35
    v_exp_f32 v37, v37
    v_exp_f32 v38, v38
    v_cvt_pk_bf16_f32 v82, v36, v37
    v_exp_f32 v39, v39
    v_exp_f32 v40, v40
    v_mfma_f32_32x32x8bf16_1k v[48:63], v[100:101], v[12:13], v[48:63]
    v_cvt_pk_bf16_f32 v83, v38, v39
    v_exp_f32 v41, v41
    v_exp_f32 v42, v42
    v_cvt_pk_bf16_f32 v84, v40, v41
    v_exp_f32 v43, v43
    v_exp_f32 v44, v44
    v_mfma_f32_32x32x16_bf16 v[64:79], v[104:107], v[80:83], v[64:79]
    v_cvt_pk_bf16_f32 v85, v42, v43
    v_exp_f32 v45, v45
    v_exp_f32 v46, v46
    v_exp_f32 v47, v47
    v_cvt_pk_bf16_f32 v86, v44, v45
    v_cvt_pk_bf16_f32 v87, v46, v47
    s_waitcnt lgkmcnt(0)
    v_mfma_f32_32x32x16_bf16 v[32:47], v[88:91], v[8:11], v[16:31]
    ds_read2st64_b64 v[96:99], v120 offset0:25 offset1:26
    ds_read_b64 v[100:101], v123 offset:12800
    ds_read_b128 v[104:107], v126 offset:11520
    ds_read_b128 v[116:119], v126 offset:12160
    v_exp_f32 v48, v48
    v_exp_f32 v49, v49
    v_exp_f32 v50, v50
    v_cvt_pk_bf16_f32 v80, v48, v49
    v_exp_f32 v51, v51
    v_exp_f32 v52, v52
    v_mfma_f32_32x32x16_bf16 v[64:79], v[132:135], v[84:87], v[64:79]
    s_add_u32 m0, s73, 106496
    s_add_u32 s74, s77, 106496
    buffer_load_dwordx4 v5, s[48:51], s74 offen sc1 lds
    v_cvt_pk_bf16_f32 v81, v50, v51
    v_exp_f32 v53, v53
    v_exp_f32 v54, v54
    v_cvt_pk_bf16_f32 v82, v52, v53
    v_exp_f32 v55, v55
    v_exp_f32 v56, v56
    v_mfma_f32_32x32x8bf16_1k v[32:47], v[92:93], v[12:13], v[32:47]
    v_cvt_pk_bf16_f32 v83, v54, v55
    v_exp_f32 v57, v57
    v_exp_f32 v58, v58
    v_cvt_pk_bf16_f32 v84, v56, v57
    v_exp_f32 v59, v59
    v_exp_f32 v60, v60
    v_mfma_f32_32x32x16_bf16 v[64:79], v[112:115], v[80:83], v[64:79]
    v_cvt_pk_bf16_f32 v85, v58, v59
    v_exp_f32 v61, v61
    v_exp_f32 v62, v62
    v_exp_f32 v63, v63
    v_cvt_pk_bf16_f32 v86, v60, v61
    v_cvt_pk_bf16_f32 v87, v62, v63
    s_waitcnt lgkmcnt(0)
    v_mfma_f32_32x32x16_bf16 v[48:63], v[96:99], v[8:11], v[16:31]
    ds_read2st64_b64 v[88:91], v120 offset0:30 offset1:31
    ds_read_b64 v[92:93], v123 offset:15360
    ds_read_b128 v[112:115], v126 offset:14080
    ds_read_b128 v[132:135], v126 offset:14720
    v_exp_f32 v32, v32
    v_exp_f32 v33, v33
    v_exp_f32 v34, v34
    v_cvt_pk_bf16_f32 v80, v32, v33
    v_exp_f32 v35, v35
    v_exp_f32 v36, v36
    v_mfma_f32_32x32x16_bf16 v[64:79], v[108:111], v[84:87], v[64:79]
    s_add_u32 m0, s73, 114688
    s_add_u32 s74, s77, 114688
    buffer_load_dwordx4 v5, s[48:51], s74 offen sc1 lds
    v_cvt_pk_bf16_f32 v81, v34, v35
    v_exp_f32 v37, v37
    v_exp_f32 v38, v38
    v_cvt_pk_bf16_f32 v82, v36, v37
    v_exp_f32 v39, v39
    v_exp_f32 v40, v40
    v_mfma_f32_32x32x8bf16_1k v[48:63], v[100:101], v[12:13], v[48:63]
    v_cvt_pk_bf16_f32 v83, v38, v39
    v_exp_f32 v41, v41
    v_exp_f32 v42, v42
    v_cvt_pk_bf16_f32 v84, v40, v41
    v_exp_f32 v43, v43
    v_exp_f32 v44, v44
    v_mfma_f32_32x32x16_bf16 v[64:79], v[104:107], v[80:83], v[64:79]
    v_cvt_pk_bf16_f32 v85, v42, v43
    v_exp_f32 v45, v45
    v_exp_f32 v46, v46
    v_exp_f32 v47, v47
    v_cvt_pk_bf16_f32 v86, v44, v45
    v_cvt_pk_bf16_f32 v87, v46, v47
    s_waitcnt lgkmcnt(0)
    v_mfma_f32_32x32x16_bf16 v[32:47], v[88:91], v[8:11], v[16:31]
    ds_read2st64_b64 v[96:99], v120 offset0:35 offset1:36
    ds_read_b64 v[100:101], v123 offset:17920
    ds_read_b128 v[104:107], v126 offset:16640
    ds_read_b128 v[108:111], v126 offset:17280
    v_exp_f32 v48, v48
    v_exp_f32 v49, v49
    v_exp_f32 v50, v50
    v_cvt_pk_bf16_f32 v80, v48, v49
    v_exp_f32 v51, v51
    v_exp_f32 v52, v52
    v_mfma_f32_32x32x16_bf16 v[64:79], v[116:119], v[84:87], v[64:79]
    v_cvt_pk_bf16_f32 v81, v50, v51
    v_exp_f32 v53, v53
    v_exp_f32 v54, v54
    v_cvt_pk_bf16_f32 v82, v52, v53
    v_exp_f32 v55, v55
    v_exp_f32 v56, v56
    v_mfma_f32_32x32x8bf16_1k v[32:47], v[92:93], v[12:13], v[32:47]
    v_cvt_pk_bf16_f32 v83, v54, v55
    v_exp_f32 v57, v57
    v_exp_f32 v58, v58
    v_cvt_pk_bf16_f32 v84, v56, v57
    v_exp_f32 v59, v59
    v_exp_f32 v60, v60
    v_mfma_f32_32x32x16_bf16 v[64:79], v[112:115], v[80:83], v[64:79]
    v_cvt_pk_bf16_f32 v85, v58, v59
    v_exp_f32 v61, v61
    v_exp_f32 v62, v62
    v_exp_f32 v63, v63
    v_cvt_pk_bf16_f32 v86, v60, v61
    v_cvt_pk_bf16_f32 v87, v62, v63
    s_waitcnt lgkmcnt(0)
    v_mfma_f32_32x32x16_bf16 v[48:63], v[96:99], v[8:11], v[16:31]
    ds_read2st64_b64 v[88:91], v120 offset0:40 offset1:41
    ds_read_b64 v[92:93], v123 offset:20480
    ds_read_b128 v[112:115], v126 offset:19200
    ds_read_b128 v[116:119], v126 offset:19840
    v_exp_f32 v32, v32
    v_exp_f32 v33, v33
    v_exp_f32 v34, v34
    v_cvt_pk_bf16_f32 v80, v32, v33
    v_exp_f32 v35, v35
    v_exp_f32 v36, v36
    v_mfma_f32_32x32x16_bf16 v[64:79], v[132:135], v[84:87], v[64:79]
    v_cvt_pk_bf16_f32 v81, v34, v35
    v_exp_f32 v37, v37
    v_exp_f32 v38, v38
    v_cvt_pk_bf16_f32 v82, v36, v37
    v_exp_f32 v39, v39
    v_exp_f32 v40, v40
    v_mfma_f32_32x32x8bf16_1k v[48:63], v[100:101], v[12:13], v[48:63]
    v_cvt_pk_bf16_f32 v83, v38, v39
    v_exp_f32 v41, v41
    v_exp_f32 v42, v42
    v_cvt_pk_bf16_f32 v84, v40, v41
    v_exp_f32 v43, v43
    v_exp_f32 v44, v44
    v_mfma_f32_32x32x16_bf16 v[64:79], v[104:107], v[80:83], v[64:79]
    v_cvt_pk_bf16_f32 v85, v42, v43
    v_exp_f32 v45, v45
    v_exp_f32 v46, v46
    v_exp_f32 v47, v47
    v_cvt_pk_bf16_f32 v86, v44, v45
    v_cvt_pk_bf16_f32 v87, v46, v47
    s_waitcnt lgkmcnt(0)
    v_mfma_f32_32x32x16_bf16 v[32:47], v[88:91], v[8:11], v[16:31]
    ds_read2st64_b64 v[96:99], v120 offset0:45 offset1:46
    ds_read_b64 v[100:101], v123 offset:23040
    ds_read_b128 v[104:107], v126 offset:21760
    ds_read_b128 v[132:135], v126 offset:22400
    v_exp_f32 v48, v48
    v_exp_f32 v49, v49
    v_exp_f32 v50, v50
    v_cvt_pk_bf16_f32 v80, v48, v49
    v_exp_f32 v51, v51
    v_exp_f32 v52, v52
    v_mfma_f32_32x32x16_bf16 v[64:79], v[108:111], v[84:87], v[64:79]
    v_cvt_pk_bf16_f32 v81, v50, v51
    v_exp_f32 v53, v53
    v_exp_f32 v54, v54
    v_cvt_pk_bf16_f32 v82, v52, v53
    v_exp_f32 v55, v55
    v_exp_f32 v56, v56
    v_mfma_f32_32x32x8bf16_1k v[32:47], v[92:93], v[12:13], v[32:47]
    v_cvt_pk_bf16_f32 v83, v54, v55
    v_exp_f32 v57, v57
    v_exp_f32 v58, v58
    v_cvt_pk_bf16_f32 v84, v56, v57
    v_exp_f32 v59, v59
    v_exp_f32 v60, v60
    v_mfma_f32_32x32x16_bf16 v[64:79], v[112:115], v[80:83], v[64:79]
    v_cvt_pk_bf16_f32 v85, v58, v59
    v_exp_f32 v61, v61
    v_exp_f32 v62, v62
    v_exp_f32 v63, v63
    v_cvt_pk_bf16_f32 v86, v60, v61
    v_cvt_pk_bf16_f32 v87, v62, v63
    s_waitcnt lgkmcnt(0)
    v_mfma_f32_32x32x16_bf16 v[48:63], v[96:99], v[8:11], v[16:31]
    ds_read2st64_b64 v[88:91], v120 offset0:50 offset1:51
    ds_read_b64 v[92:93], v123 offset:25600
    ds_read_b128 v[112:115], v126 offset:24320
    ds_read_b128 v[108:111], v126 offset:24960
    v_exp_f32 v32, v32
    v_exp_f32 v33, v33
    v_exp_f32 v34, v34
    v_cvt_pk_bf16_f32 v80, v32, v33
    v_exp_f32 v35, v35
    v_exp_f32 v36, v36
    v_mfma_f32_32x32x16_bf16 v[64:79], v[116:119], v[84:87], v[64:79]
    v_cvt_pk_bf16_f32 v81, v34, v35
    v_exp_f32 v37, v37
    v_exp_f32 v38, v38
    v_cvt_pk_bf16_f32 v82, v36, v37
    v_exp_f32 v39, v39
    v_exp_f32 v40, v40
    v_mfma_f32_32x32x8bf16_1k v[48:63], v[100:101], v[12:13], v[48:63]
    v_cvt_pk_bf16_f32 v83, v38, v39
    v_exp_f32 v41, v41
    v_exp_f32 v42, v42
    v_cvt_pk_bf16_f32 v84, v40, v41
    v_exp_f32 v43, v43
    v_exp_f32 v44, v44
    v_mfma_f32_32x32x16_bf16 v[64:79], v[104:107], v[80:83], v[64:79]
    v_cvt_pk_bf16_f32 v85, v42, v43
    v_exp_f32 v45, v45
    v_exp_f32 v46, v46
    v_exp_f32 v47, v47
    v_cvt_pk_bf16_f32 v86, v44, v45
    v_cvt_pk_bf16_f32 v87, v46, v47
    s_waitcnt lgkmcnt(0)
    v_mfma_f32_32x32x16_bf16 v[32:47], v[88:91], v[8:11], v[16:31]
    ds_read2st64_b64 v[96:99], v120 offset0:55 offset1:56
    ds_read_b64 v[100:101], v123 offset:28160
    ds_read_b128 v[104:107], v126 offset:26880
    ds_read_b128 v[116:119], v126 offset:27520
    v_exp_f32 v48, v48
    v_exp_f32 v49, v49
    v_exp_f32 v50, v50
    v_cvt_pk_bf16_f32 v80, v48, v49
    v_exp_f32 v51, v51
    v_exp_f32 v52, v52
    v_mfma_f32_32x32x16_bf16 v[64:79], v[132:135], v[84:87], v[64:79]
    v_cvt_pk_bf16_f32 v81, v50, v51
    v_exp_f32 v53, v53
    v_exp_f32 v54, v54
    v_cvt_pk_bf16_f32 v82, v52, v53
    v_exp_f32 v55, v55
    v_exp_f32 v56, v56
    v_mfma_f32_32x32x8bf16_1k v[32:47], v[92:93], v[12:13], v[32:47]
    v_cvt_pk_bf16_f32 v83, v54, v55
    v_exp_f32 v57, v57
    v_exp_f32 v58, v58
    v_cvt_pk_bf16_f32 v84, v56, v57
    v_exp_f32 v59, v59
    v_exp_f32 v60, v60
    v_mfma_f32_32x32x16_bf16 v[64:79], v[112:115], v[80:83], v[64:79]
    v_cvt_pk_bf16_f32 v85, v58, v59
    v_exp_f32 v61, v61
    v_exp_f32 v62, v62
    v_exp_f32 v63, v63
    v_cvt_pk_bf16_f32 v86, v60, v61
    v_cvt_pk_bf16_f32 v87, v62, v63
    s_waitcnt lgkmcnt(0)
    v_mfma_f32_32x32x16_bf16 v[48:63], v[96:99], v[8:11], v[16:31]
    ds_read2st64_b64 v[88:91], v120 offset0:60 offset1:61
    ds_read_b64 v[92:93], v123 offset:30720
    ds_read_b128 v[112:115], v126 offset:29440
    ds_read_b128 v[132:135], v126 offset:30080
    v_exp_f32 v32, v32
    v_exp_f32 v33, v33
    v_exp_f32 v34, v34
    v_cvt_pk_bf16_f32 v80, v32, v33
    v_exp_f32 v35, v35
    v_exp_f32 v36, v36
    v_mfma_f32_32x32x16_bf16 v[64:79], v[108:111], v[84:87], v[64:79]
    v_cvt_pk_bf16_f32 v81, v34, v35
    v_exp_f32 v37, v37
    v_exp_f32 v38, v38
    v_cvt_pk_bf16_f32 v82, v36, v37
    v_exp_f32 v39, v39
    v_exp_f32 v40, v40
    v_mfma_f32_32x32x8bf16_1k v[48:63], v[100:101], v[12:13], v[48:63]
    v_cvt_pk_bf16_f32 v83, v38, v39
    v_exp_f32 v41, v41
    v_exp_f32 v42, v42
    v_cvt_pk_bf16_f32 v84, v40, v41
    v_exp_f32 v43, v43
    v_exp_f32 v44, v44
    v_mfma_f32_32x32x16_bf16 v[64:79], v[104:107], v[80:83], v[64:79]
    v_cvt_pk_bf16_f32 v85, v42, v43
    v_exp_f32 v45, v45
    v_exp_f32 v46, v46
    v_exp_f32 v47, v47
    v_cvt_pk_bf16_f32 v86, v44, v45
    v_cvt_pk_bf16_f32 v87, v46, v47
    s_waitcnt lgkmcnt(0)
    v_mfma_f32_32x32x16_bf16 v[32:47], v[88:91], v[8:11], v[16:31]
    ds_read2st64_b64 v[96:99], v120 offset0:65 offset1:66
    ds_read_b64 v[100:101], v123 offset:33280
    ds_read_b128 v[104:107], v126 offset:32000
    ds_read_b128 v[108:111], v126 offset:32640
    v_exp_f32 v48, v48
    v_exp_f32 v49, v49
    v_exp_f32 v50, v50
    v_cvt_pk_bf16_f32 v80, v48, v49
    v_exp_f32 v51, v51
    v_exp_f32 v52, v52
    v_mfma_f32_32x32x16_bf16 v[64:79], v[116:119], v[84:87], v[64:79]
    v_cvt_pk_bf16_f32 v81, v50, v51
    v_exp_f32 v53, v53
    v_exp_f32 v54, v54
    v_cvt_pk_bf16_f32 v82, v52, v53
    v_exp_f32 v55, v55
    v_exp_f32 v56, v56
    v_mfma_f32_32x32x8bf16_1k v[32:47], v[92:93], v[12:13], v[32:47]
    v_cvt_pk_bf16_f32 v83, v54, v55
    v_exp_f32 v57, v57
    v_exp_f32 v58, v58
    v_cvt_pk_bf16_f32 v84, v56, v57
    v_exp_f32 v59, v59
    v_exp_f32 v60, v60
    v_mfma_f32_32x32x16_bf16 v[64:79], v[112:115], v[80:83], v[64:79]
    v_cvt_pk_bf16_f32 v85, v58, v59
    v_exp_f32 v61, v61
    v_exp_f32 v62, v62
    v_exp_f32 v63, v63
    v_cvt_pk_bf16_f32 v86, v60, v61
    v_cvt_pk_bf16_f32 v87, v62, v63
    s_waitcnt lgkmcnt(0)
    v_mfma_f32_32x32x16_bf16 v[48:63], v[96:99], v[8:11], v[16:31]
    ds_read2st64_b64 v[88:91], v120 offset0:70 offset1:71
    ds_read_b64 v[92:93], v123 offset:35840
    ds_read_b128 v[112:115], v126 offset:34560
    ds_read_b128 v[116:119], v126 offset:35200
    v_exp_f32 v32, v32
    v_exp_f32 v33, v33
    v_exp_f32 v34, v34
    v_cvt_pk_bf16_f32 v80, v32, v33
    v_exp_f32 v35, v35
    v_exp_f32 v36, v36
    v_mfma_f32_32x32x16_bf16 v[64:79], v[132:135], v[84:87], v[64:79]
    v_cvt_pk_bf16_f32 v81, v34, v35
    v_exp_f32 v37, v37
    v_exp_f32 v38, v38
    v_cvt_pk_bf16_f32 v82, v36, v37
    v_exp_f32 v39, v39
    v_exp_f32 v40, v40
    v_mfma_f32_32x32x8bf16_1k v[48:63], v[100:101], v[12:13], v[48:63]
    v_cvt_pk_bf16_f32 v83, v38, v39
    v_exp_f32 v41, v41
    v_exp_f32 v42, v42
    v_cvt_pk_bf16_f32 v84, v40, v41
    v_exp_f32 v43, v43
    v_exp_f32 v44, v44
    v_mfma_f32_32x32x16_bf16 v[64:79], v[104:107], v[80:83], v[64:79]
    v_cvt_pk_bf16_f32 v85, v42, v43
    v_exp_f32 v45, v45
    v_exp_f32 v46, v46
    v_exp_f32 v47, v47
    v_cvt_pk_bf16_f32 v86, v44, v45
    v_cvt_pk_bf16_f32 v87, v46, v47
    s_waitcnt lgkmcnt(0)
    v_mfma_f32_32x32x16_bf16 v[32:47], v[88:91], v[8:11], v[16:31]
    ds_read2st64_b64 v[96:99], v120 offset0:75 offset1:76
    ds_read_b64 v[100:101], v123 offset:38400
    ds_read_b128 v[104:107], v126 offset:37120
    ds_read_b128 v[132:135], v126 offset:37760
    v_exp_f32 v48, v48
    v_exp_f32 v49, v49
    v_exp_f32 v50, v50
    v_cvt_pk_bf16_f32 v80, v48, v49
    v_exp_f32 v51, v51
    v_exp_f32 v52, v52
    v_mfma_f32_32x32x16_bf16 v[64:79], v[108:111], v[84:87], v[64:79]
    v_cvt_pk_bf16_f32 v81, v50, v51
    v_exp_f32 v53, v53
    v_exp_f32 v54, v54
    v_cvt_pk_bf16_f32 v82, v52, v53
    v_exp_f32 v55, v55
    v_exp_f32 v56, v56
    v_mfma_f32_32x32x8bf16_1k v[32:47], v[92:93], v[12:13], v[32:47]
    v_cvt_pk_bf16_f32 v83, v54, v55
    v_exp_f32 v57, v57
    v_exp_f32 v58, v58
    v_cvt_pk_bf16_f32 v84, v56, v57
    v_exp_f32 v59, v59
    v_exp_f32 v60, v60
    v_mfma_f32_32x32x16_bf16 v[64:79], v[112:115], v[80:83], v[64:79]
    v_cvt_pk_bf16_f32 v85, v58, v59
    v_exp_f32 v61, v61
    v_exp_f32 v62, v62
    v_exp_f32 v63, v63
    v_cvt_pk_bf16_f32 v86, v60, v61
    v_cvt_pk_bf16_f32 v87, v62, v63
    s_waitcnt vmcnt(5)
    s_barrier
    s_waitcnt lgkmcnt(0)
    v_mfma_f32_32x32x16_bf16 v[48:63], v[96:99], v[8:11], v[16:31]
    ds_read2st64_b64 v[88:91], v121 offset0:0 offset1:1
    ds_read_b64 v[92:93], v124 offset:0
    ds_read_b128 v[112:115], v126 offset:39680
    ds_read_b128 v[108:111], v126 offset:40320
    v_exp_f32 v32, v32
    v_exp_f32 v33, v33
    v_exp_f32 v34, v34
    v_cvt_pk_bf16_f32 v80, v32, v33
    v_exp_f32 v35, v35
    v_exp_f32 v36, v36
    v_mfma_f32_32x32x16_bf16 v[64:79], v[116:119], v[84:87], v[64:79]
    v_cvt_pk_bf16_f32 v81, v34, v35
    v_exp_f32 v37, v37
    v_exp_f32 v38, v38
    v_cvt_pk_bf16_f32 v82, v36, v37
    v_exp_f32 v39, v39
    v_exp_f32 v40, v40
    v_mfma_f32_32x32x8bf16_1k v[48:63], v[100:101], v[12:13], v[48:63]
    v_cvt_pk_bf16_f32 v83, v38, v39
    v_exp_f32 v41, v41
    v_exp_f32 v42, v42
    v_cvt_pk_bf16_f32 v84, v40, v41
    v_exp_f32 v43, v43
    v_exp_f32 v44, v44
    v_mfma_f32_32x32x16_bf16 v[64:79], v[104:107], v[80:83], v[64:79]
    v_cvt_pk_bf16_f32 v85, v42, v43
    v_exp_f32 v45, v45
    v_exp_f32 v46, v46
    v_exp_f32 v47, v47
    v_cvt_pk_bf16_f32 v86, v44, v45
    v_cvt_pk_bf16_f32 v87, v46, v47
    s_waitcnt lgkmcnt(0)
    v_mfma_f32_32x32x16_bf16 v[32:47], v[88:91], v[8:11], v[16:31]
    ds_read2st64_b64 v[96:99], v121 offset0:5 offset1:6
    ds_read_b64 v[100:101], v124 offset:2560
    ds_read_b128 v[104:107], v127 offset:1280
    ds_read_b128 v[116:119], v127 offset:1920
    v_exp_f32 v48, v48
    v_exp_f32 v49, v49
    v_exp_f32 v50, v50
    v_cvt_pk_bf16_f32 v80, v48, v49
    v_exp_f32 v51, v51
    v_exp_f32 v52, v52
    v_mfma_f32_32x32x16_bf16 v[64:79], v[132:135], v[84:87], v[64:79]
    s_cmp_le_u32 s84, 0
    s_cbranch_scc1 rl_38
    buffer_load_dwordx4 v[136:139], v160, s[56:59], s85 offen
rl_38:
    v_cvt_pk_bf16_f32 v81, v50, v51
    v_exp_f32 v53, v53
    v_exp_f32 v54, v54
    v_cvt_pk_bf16_f32 v82, v52, v53
    v_exp_f32 v55, v55
    v_exp_f32 v56, v56
    v_mfma_f32_32x32x8bf16_1k v[32:47], v[92:93], v[12:13], v[32:47]
    v_cvt_pk_bf16_f32 v83, v54, v55
    v_exp_f32 v57, v57
    v_exp_f32 v58, v58
    v_cvt_pk_bf16_f32 v84, v56, v57
    v_exp_f32 v59, v59
    v_exp_f32 v60, v60
    v_mfma_f32_32x32x16_bf16 v[64:79], v[112:115], v[80:83], v[64:79]
    v_cvt_pk_bf16_f32 v85, v58, v59
    v_exp_f32 v61, v61
    v_exp_f32 v62, v62
    v_exp_f32 v63, v63
    v_cvt_pk_bf16_f32 v86, v60, v61
    v_cvt_pk_bf16_f32 v87, v62, v63
    s_waitcnt lgkmcnt(0)
    v_mfma_f32_32x32x16_bf16 v[48:63], v[96:99], v[8:11], v[16:31]
    ds_read2st64_b64 v[88:91], v121 offset0:10 offset1:11
    ds_read_b64 v[92:93], v124 offset:5120
    ds_read_b128 v[112:115], v127 offset:3840
    ds_read_b128 v[132:135], v127 offset:4480
    v_exp_f32 v32, v32
    v_exp_f32 v33, v33
    v_exp_f32 v34, v34
    v_cvt_pk_bf16_f32 v80, v32, v33
    v_exp_f32 v35, v35
    v_exp_f32 v36, v36
    v_mfma_f32_32x32x16_bf16 v[64:79], v[108:111], v[84:87], v[64:79]
    s_cmp_le_u32 s84, 1
    s_cbranch_scc1 rl_39
    buffer_load_dwordx4 v[140:143], v161, s[56:59], s85 offen
rl_39:
    v_cvt_pk_bf16_f32 v81, v34, v35
    v_exp_f32 v37, v37
    v_exp_f32 v38, v38
    v_cvt_pk_bf16_f32 v82, v36, v37
    v_exp_f32 v39, v39
    v_exp_f32 v40, v40
    v_mfma_f32_32x32x8bf16_1k v[48:63], v[100:101], v[12:13], v[48:63]
    v_cvt_pk_bf16_f32 v83, v38, v39
    v_exp_f32 v41, v41
    v_exp_f32 v42, v42
    v_cvt_pk_bf16_f32 v84, v40, v41
    v_exp_f32 v43, v43
    v_exp_f32 v44, v44
    v_mfma_f32_32x32x16_bf16 v[64:79], v[104:107], v[80:83], v[64:79]
    v_cvt_pk_bf16_f32 v85, v42, v43
    v_exp_f32 v45, v45
    v_exp_f32 v46, v46
    v_exp_f32 v47, v47
    v_cvt_pk_bf16_f32 v86, v44, v45
    v_cvt_pk_bf16_f32 v87, v46, v47
    s_waitcnt lgkmcnt(0)
    v_mfma_f32_32x32x16_bf16 v[32:47], v[88:91], v[8:11], v[16:31]
    ds_read2st64_b64 v[96:99], v121 offset0:15 offset1:16
    ds_read_b64 v[100:101], v124 offset:7680
    ds_read_b128 v[104:107], v127 offset:6400
    ds_read_b128 v[108:111], v127 offset:7040
    v_exp_f32 v48, v48
    v_exp_f32 v49, v49
    v_exp_f32 v50, v50
    v_cvt_pk_bf16_f32 v80, v48, v49
    v_exp_f32 v51, v51
    v_exp_f32 v52, v52
    v_mfma_f32_32x32x16_bf16 v[64:79], v[116:119], v[84:87], v[64:79]
    s_cmp_le_u32 s84, 2
    s_cbranch_scc1 rl_40
    buffer_load_dwordx4 v[144:147], v162, s[56:59], s85 offen
rl_40:
    v_cvt_pk_bf16_f32 v81, v50, v51
    v_exp_f32 v53, v53
    v_exp_f32 v54, v54
    v_cvt_pk_bf16_f32 v82, v52, v53
    v_exp_f32 v55, v55
    v_exp_f32 v56, v56
    v_mfma_f32_32x32x8bf16_1k v[32:47], v[92:93], v[12:13], v[32:47]
    v_cvt_pk_bf16_f32 v83, v54, v55
    v_exp_f32 v57, v57
    v_exp_f32 v58, v58
    v_cvt_pk_bf16_f32 v84, v56, v57
    v_exp_f32 v59, v59
    v_exp_f32 v60, v60
    v_mfma_f32_32x32x16_bf16 v[64:79], v[112:115], v[80:83], v[64:79]
    v_cvt_pk_bf16_f32 v85, v58, v59
    v_exp_f32 v61, v61
    v_exp_f32 v62, v62
    v_exp_f32 v63, v63
    v_cvt_pk_bf16_f32 v86, v60, v61
    v_cvt_pk_bf16_f32 v87, v62, v63
    s_waitcnt lgkmcnt(0)
    v_mfma_f32_32x32x16_bf16 v[48:63], v[96:99], v[8:11], v[16:31]
    ds_read2st64_b64 v[88:91], v121 offset0:20 offset1:21
    ds_read_b64 v[92:93], v124 offset:10240
    ds_read_b128 v[112:115], v127 offset:8960
    ds_read_b128 v[116:119], v127 offset:9600
    v_exp_f32 v32, v32
    v_exp_f32 v33, v33
    v_exp_f32 v34, v34
    v_cvt_pk_bf16_f32 v80, v32, v33
    v_exp_f32 v35, v35
    v_exp_f32 v36, v36
    v_mfma_f32_32x32x16_bf16 v[64:79], v[132:135], v[84:87], v[64:79]
    s_cmp_le_u32 s84, 3
    s_cbranch_scc1 rl_41
    buffer_load_dwordx4 v[148:151], v163, s[56:59], s85 offen
rl_41:
    v_cvt_pk_bf16_f32 v81, v34, v35
    v_exp_f32 v37, v37
    v_exp_f32 v38, v38
    v_cvt_pk_bf16_f32 v82, v36, v37
    v_exp_f32 v39, v39
    v_exp_f32 v40, v40
    v_mfma_f32_32x32x8bf16_1k v[48:63], v[100:101], v[12:13], v[48:63]
    v_cvt_pk_bf16_f32 v83, v38, v39
    v_exp_f32 v41, v41
    v_exp_f32 v42, v42
    v_cvt_pk_bf16_f32 v84, v40, v41
    v_exp_f32 v43, v43
    v_exp_f32 v44, v44
    v_mfma_f32_32x32x16_bf16 v[64:79], v[104:107], v[80:83], v[64:79]
    v_cvt_pk_bf16_f32 v85, v42, v43
    v_exp_f32 v45, v45
    v_exp_f32 v46, v46
    v_exp_f32 v47, v47
    v_cvt_pk_bf16_f32 v86, v44, v45
    v_cvt_pk_bf16_f32 v87, v46, v47
    s_waitcnt lgkmcnt(0)
    v_mfma_f32_32x32x16_bf16 v[32:47], v[88:91], v[8:11], v[16:31]
    ds_read2st64_b64 v[96:99], v121 offset0:25 offset1:26
    ds_read_b64 v[100:101], v124 offset:12800
    ds_read_b128 v[104:107], v127 offset:11520
    ds_read_b128 v[132:135], v127 offset:12160
    v_exp_f32 v48, v48
    v_exp_f32 v49, v49
    v_exp_f32 v50, v50
    v_cvt_pk_bf16_f32 v80, v48, v49
    v_exp_f32 v51, v51
    v_exp_f32 v52, v52
    v_mfma_f32_32x32x16_bf16 v[64:79], v[108:111], v[84:87], v[64:79]
    s_cmp_le_u32 s84, 4
    s_cbranch_scc1 rl_42
    buffer_load_dwordx4 v[152:155], v164, s[56:59], s85 offen
rl_42:
    v_cvt_pk_bf16_f32 v81, v50, v51
    v_exp_f32 v53, v53
    v_exp_f32 v54, v54
    v_cvt_pk_bf16_f32 v82, v52, v53
    v_exp_f32 v55, v55
    v_exp_f32 v56, v56
    v_mfma_f32_32x32x8bf16_1k v[32:47], v[92:93], v[12:13], v[32:47]
    v_cvt_pk_bf16_f32 v83, v54, v55
    v_exp_f32 v57, v57
    v_exp_f32 v58, v58
    v_cvt_pk_bf16_f32 v84, v56, v57
    v_exp_f32 v59, v59
    v_exp_f32 v60, v60
    v_mfma_f32_32x32x16_bf16 v[64:79], v[112:115], v[80:83], v[64:79]
    v_cvt_pk_bf16_f32 v85, v58, v59
    v_exp_f32 v61, v61
    v_exp_f32 v62, v62
    v_exp_f32 v63, v63
    v_cvt_pk_bf16_f32 v86, v60, v61
    v_cvt_pk_bf16_f32 v87, v62, v63
    s_waitcnt lgkmcnt(0)
    v_mfma_f32_32x32x16_bf16 v[48:63], v[96:99], v[8:11], v[16:31]
    ds_read2st64_b64 v[88:91], v121 offset0:30 offset1:31
    ds_read_b64 v[92:93], v124 offset:15360
    ds_read_b128 v[112:115], v127 offset:14080
    ds_read_b128 v[108:111], v127 offset:14720
    v_exp_f32 v32, v32
    v_exp_f32 v33, v33
    v_exp_f32 v34, v34
    v_cvt_pk_bf16_f32 v80, v32, v33
    v_exp_f32 v35, v35
    v_exp_f32 v36, v36
    v_mfma_f32_32x32x16_bf16 v[64:79], v[116:119], v[84:87], v[64:79]
    v_cvt_pk_bf16_f32 v81, v34, v35
    v_exp_f32 v37, v37
    v_exp_f32 v38, v38
    v_cvt_pk_bf16_f32 v82, v36, v37
    v_exp_f32 v39, v39
    v_exp_f32 v40, v40
    v_mfma_f32_32x32x8bf16_1k v[48:63], v[100:101], v[12:13], v[48:63]
    v_cvt_pk_bf16_f32 v83, v38, v39
    v_exp_f32 v41, v41
    v_exp_f32 v42, v42
    v_cvt_pk_bf16_f32 v84, v40, v41
    v_exp_f32 v43, v43
    v_exp_f32 v44, v44
    v_mfma_f32_32x32x16_bf16 v[64:79], v[104:107], v[80:83], v[64:79]
    v_cvt_pk_bf16_f32 v85, v42, v43
    v_exp_f32 v45, v45
    v_exp_f32 v46, v46
    v_exp_f32 v47, v47
    v_cvt_pk_bf16_f32 v86, v44, v45
    v_cvt_pk_bf16_f32 v87, v46, v47
    s_waitcnt lgkmcnt(0)
    v_mfma_f32_32x32x16_bf16 v[32:47], v[88:91], v[8:11], v[16:31]
    ds_read2st64_b64 v[96:99], v121 offset0:35 offset1:36
    ds_read_b64 v[100:101], v124 offset:17920
    ds_read_b128 v[104:107], v127 offset:16640
    ds_read_b128 v[116:119], v127 offset:17280
    v_exp_f32 v48, v48
    v_exp_f32 v49, v49
    v_exp_f32 v50, v50
    v_cvt_pk_bf16_f32 v80, v48, v49
    v_exp_f32 v51, v51
    v_exp_f32 v52, v52
    v_mfma_f32_32x32x16_bf16 v[64:79], v[132:135], v[84:87], v[64:79]
    v_cvt_pk_bf16_f32 v81, v50, v51
    v_exp_f32 v53, v53
    v_exp_f32 v54, v54
    v_cvt_pk_bf16_f32 v82, v52, v53
    v_exp_f32 v55, v55
    v_exp_f32 v56, v56
    v_mfma_f32_32x32x8bf16_1k v[32:47], v[92:93], v[12:13], v[32:47]
    v_cvt_pk_bf16_f32 v83, v54, v55
    v_exp_f32 v57, v57
    v_exp_f32 v58, v58
    v_cvt_pk_bf16_f32 v84, v56, v57
    v_exp_f32 v59, v59
    v_exp_f32 v60, v60
    v_mfma_f32_32x32x16_bf16 v[64:79], v[112:115], v[80:83], v[64:79]
    v_cvt_pk_bf16_f32 v85, v58, v59
    v_exp_f32 v61, v61
    v_exp_f32 v62, v62
    v_exp_f32 v63, v63
    v_cvt_pk_bf16_f32 v86, v60, v61
    v_cvt_pk_bf16_f32 v87, v62, v63
    s_waitcnt lgkmcnt(0)
    v_mfma_f32_32x32x16_bf16 v[48:63], v[96:99], v[8:11], v[16:31]
    ds_read2st64_b64 v[88:91], v121 offset0:40 offset1:41
    ds_read_b64 v[92:93], v124 offset:20480
    ds_read_b128 v[112:115], v127 offset:19200
    ds_read_b128 v[132:135], v127 offset:19840
    v_exp_f32 v32, v32
    v_exp_f32 v33, v33
    v_exp_f32 v34, v34
    v_cvt_pk_bf16_f32 v80, v32, v33
    v_exp_f32 v35, v35
    v_exp_f32 v36, v36
    v_mfma_f32_32x32x16_bf16 v[64:79], v[108:111], v[84:87], v[64:79]
    v_cvt_pk_bf16_f32 v81, v34, v35
    v_exp_f32 v37, v37
    v_exp_f32 v38, v38
    v_cvt_pk_bf16_f32 v82, v36, v37
    v_exp_f32 v39, v39
    v_exp_f32 v40, v40
    v_mfma_f32_32x32x8bf16_1k v[48:63], v[100:101], v[12:13], v[48:63]
    v_cvt_pk_bf16_f32 v83, v38, v39
    v_exp_f32 v41, v41
    v_exp_f32 v42, v42
    v_cvt_pk_bf16_f32 v84, v40, v41
    v_exp_f32 v43, v43
    v_exp_f32 v44, v44
    v_mfma_f32_32x32x16_bf16 v[64:79], v[104:107], v[80:83], v[64:79]
    v_cvt_pk_bf16_f32 v85, v42, v43
    v_exp_f32 v45, v45
    v_exp_f32 v46, v46
    v_exp_f32 v47, v47
    v_cvt_pk_bf16_f32 v86, v44, v45
    v_cvt_pk_bf16_f32 v87, v46, v47
    s_waitcnt lgkmcnt(0)
    v_mfma_f32_32x32x16_bf16 v[32:47], v[88:91], v[8:11], v[16:31]
    ds_read2st64_b64 v[96:99], v121 offset0:45 offset1:46
    ds_read_b64 v[100:101], v124 offset:23040
    ds_read_b128 v[104:107], v127 offset:21760
    ds_read_b128 v[108:111], v127 offset:22400
    v_exp_f32 v48, v48
    v_exp_f32 v49, v49
    v_exp_f32 v50, v50
    v_cvt_pk_bf16_f32 v80, v48, v49
    v_exp_f32 v51, v51
    v_exp_f32 v52, v52
    v_mfma_f32_32x32x16_bf16 v[64:79], v[116:119], v[84:87], v[64:79]
    v_cvt_pk_bf16_f32 v81, v50, v51
    v_exp_f32 v53, v53
    v_exp_f32 v54, v54
    v_cvt_pk_bf16_f32 v82, v52, v53
    v_exp_f32 v55, v55
    v_exp_f32 v56, v56
    v_mfma_f32_32x32x8bf16_1k v[32:47], v[92:93], v[12:13], v[32:47]
    v_cvt_pk_bf16_f32 v83, v54, v55
    v_exp_f32 v57, v57
    v_exp_f32 v58, v58
    v_cvt_pk_bf16_f32 v84, v56, v57
    v_exp_f32 v59, v59
    v_exp_f32 v60, v60
    v_mfma_f32_32x32x16_bf16 v[64:79], v[112:115], v[80:83], v[64:79]
    v_cvt_pk_bf16_f32 v85, v58, v59
    v_exp_f32 v61, v61
    v_exp_f32 v62, v62
    v_exp_f32 v63, v63
    v_cvt_pk_bf16_f32 v86, v60, v61
    v_cvt_pk_bf16_f32 v87, v62, v63
    s_waitcnt lgkmcnt(0)
    v_mfma_f32_32x32x16_bf16 v[48:63], v[96:99], v[8:11], v[16:31]
    ds_read2st64_b64 v[88:91], v121 offset0:50 offset1:51
    ds_read_b64 v[92:93], v124 offset:25600
    ds_read_b128 v[112:115], v127 offset:24320
    ds_read_b128 v[116:119], v127 offset:24960
    v_exp_f32 v32, v32
    v_exp_f32 v33, v33
    v_exp_f32 v34, v34
    v_cvt_pk_bf16_f32 v80, v32, v33
    v_exp_f32 v35, v35
    v_exp_f32 v36, v36
    v_mfma_f32_32x32x16_bf16 v[64:79], v[132:135], v[84:87], v[64:79]
    v_cvt_pk_bf16_f32 v81, v34, v35
    v_exp_f32 v37, v37
    v_exp_f32 v38, v38
    v_cvt_pk_bf16_f32 v82, v36, v37
    v_exp_f32 v39, v39
    v_exp_f32 v40, v40
    v_mfma_f32_32x32x8bf16_1k v[48:63], v[100:101], v[12:13], v[48:63]
    v_cvt_pk_bf16_f32 v83, v38, v39
    v_exp_f32 v41, v41
    v_exp_f32 v42, v42
    v_cvt_pk_bf16_f32 v84, v40, v41
    v_exp_f32 v43, v43
    v_exp_f32 v44, v44
    v_mfma_f32_32x32x16_bf16 v[64:79], v[104:107], v[80:83], v[64:79]
    v_cvt_pk_bf16_f32 v85, v42, v43
    v_exp_f32 v45, v45
    v_exp_f32 v46, v46
    v_exp_f32 v47, v47
    v_cvt_pk_bf16_f32 v86, v44, v45
    v_cvt_pk_bf16_f32 v87, v46, v47
    s_waitcnt lgkmcnt(0)
    v_mfma_f32_32x32x16_bf16 v[32:47], v[88:91], v[8:11], v[16:31]
    ds_read2st64_b64 v[96:99], v121 offset0:55 offset1:56
    ds_read_b64 v[100:101], v124 offset:28160
    ds_read_b128 v[104:107], v127 offset:26880
    ds_read_b128 v[132:135], v127 offset:27520
    v_exp_f32 v48, v48
    v_exp_f32 v49, v49
    v_exp_f32 v50, v50
    v_cvt_pk_bf16_f32 v80, v48, v49
    v_exp_f32 v51, v51
    v_exp_f32 v52, v52
    v_mfma_f32_32x32x16_bf16 v[64:79], v[108:111], v[84:87], v[64:79]
    v_cvt_pk_bf16_f32 v81, v50, v51
    v_exp_f32 v53, v53
    v_exp_f32 v54, v54
    v_cvt_pk_bf16_f32 v82, v52, v53
    v_exp_f32 v55, v55
    v_exp_f32 v56, v56
    v_mfma_f32_32x32x8bf16_1k v[32:47], v[92:93], v[12:13], v[32:47]
    v_cvt_pk_bf16_f32 v83, v54, v55
    v_exp_f32 v57, v57
    v_exp_f32 v58, v58
    v_cvt_pk_bf16_f32 v84, v56, v57
    v_exp_f32 v59, v59
    v_exp_f32 v60, v60
    v_mfma_f32_32x32x16_bf16 v[64:79], v[112:115], v[80:83], v[64:79]
    v_cvt_pk_bf16_f32 v85, v58, v59
    v_exp_f32 v61, v61
    v_exp_f32 v62, v62
    v_exp_f32 v63, v63
    v_cvt_pk_bf16_f32 v86, v60, v61
    v_cvt_pk_bf16_f32 v87, v62, v63
    s_waitcnt lgkmcnt(0)
    v_mfma_f32_32x32x16_bf16 v[48:63], v[96:99], v[8:11], v[16:31]
    ds_read2st64_b64 v[88:91], v121 offset0:60 offset1:61
    ds_read_b64 v[92:93], v124 offset:30720
    ds_read_b128 v[112:115], v127 offset:29440
    ds_read_b128 v[108:111], v127 offset:30080
    v_exp_f32 v32, v32
    v_exp_f32 v33, v33
    v_exp_f32 v34, v34
    v_cvt_pk_bf16_f32 v80, v32, v33
    v_exp_f32 v35, v35
    v_exp_f32 v36, v36
    v_mfma_f32_32x32x16_bf16 v[64:79], v[116:119], v[84:87], v[64:79]
    v_cvt_pk_bf16_f32 v81, v34, v35
    v_exp_f32 v37, v37
    v_exp_f32 v38, v38
    v_cvt_pk_bf16_f32 v82, v36, v37
    v_exp_f32 v39, v39
    v_exp_f32 v40, v40
    v_mfma_f32_32x32x8bf16_1k v[48:63], v[100:101], v[12:13], v[48:63]
    v_cvt_pk_bf16_f32 v83, v38, v39
    v_exp_f32 v41, v41
    v_exp_f32 v42, v42
    v_cvt_pk_bf16_f32 v84, v40, v41
    v_exp_f32 v43, v43
    v_exp_f32 v44, v44
    v_mfma_f32_32x32x16_bf16 v[64:79], v[104:107], v[80:83], v[64:79]
    v_cvt_pk_bf16_f32 v85, v42, v43
    v_exp_f32 v45, v45
    v_exp_f32 v46, v46
    v_exp_f32 v47, v47
    v_cvt_pk_bf16_f32 v86, v44, v45
    v_cvt_pk_bf16_f32 v87, v46, v47
    s_waitcnt lgkmcnt(0)
    v_mfma_f32_32x32x16_bf16 v[32:47], v[88:91], v[8:11], v[16:31]
    ds_read2st64_b64 v[96:99], v121 offset0:65 offset1:66
    ds_read_b64 v[100:101], v124 offset:33280
    ds_read_b128 v[104:107], v127 offset:32000
    ds_read_b128 v[116:119], v127 offset:32640
    v_exp_f32 v48, v48
    v_exp_f32 v49, v49
    v_exp_f32 v50, v50
    v_cvt_pk_bf16_f32 v80, v48, v49
    v_exp_f32 v51, v51
    v_exp_f32 v52, v52
    v_mfma_f32_32x32x16_bf16 v[64:79], v[132:135], v[84:87], v[64:79]
    v_cvt_pk_bf16_f32 v81, v50, v51
    v_exp_f32 v53, v53
    v_exp_f32 v54, v54
    v_cvt_pk_bf16_f32 v82, v52, v53
    v_exp_f32 v55, v55
    v_exp_f32 v56, v56
    v_mfma_f32_32x32x8bf16_1k v[32:47], v[92:93], v[12:13], v[32:47]
    v_cvt_pk_bf16_f32 v83, v54, v55
    v_exp_f32 v57, v57
    v_exp_f32 v58, v58
    v_cvt_pk_bf16_f32 v84, v56, v57
    v_exp_f32 v59, v59
    v_exp_f32 v60, v60
    v_mfma_f32_32x32x16_bf16 v[64:79], v[112:115], v[80:83], v[64:79]
    v_cvt_pk_bf16_f32 v85, v58, v59
    v_exp_f32 v61, v61
    v_exp_f32 v62, v62
    v_exp_f32 v63, v63
    v_cvt_pk_bf16_f32 v86, v60, v61
    v_cvt_pk_bf16_f32 v87, v62, v63
    s_waitcnt lgkmcnt(0)
    v_mfma_f32_32x32x16_bf16 v[48:63], v[96:99], v[8:11], v[16:31]
    ds_read2st64_b64 v[88:91], v121 offset0:70 offset1:71
    ds_read_b64 v[92:93], v124 offset:35840
    ds_read_b128 v[112:115], v127 offset:34560
    ds_read_b128 v[132:135], v127 offset:35200
    v_exp_f32 v32, v32
    v_exp_f32 v33, v33
    v_exp_f32 v34, v34
    v_cvt_pk_bf16_f32 v80, v32, v33
    v_exp_f32 v35, v35
    v_exp_f32 v36, v36
    v_mfma_f32_32x32x16_bf16 v[64:79], v[108:111], v[84:87], v[64:79]
    v_cvt_pk_bf16_f32 v81, v34, v35
    v_exp_f32 v37, v37
    v_exp_f32 v38, v38
    v_cvt_pk_bf16_f32 v82, v36, v37
    v_exp_f32 v39, v39
    v_exp_f32 v40, v40
    v_mfma_f32_32x32x8bf16_1k v[48:63], v[100:101], v[12:13], v[48:63]
    v_cvt_pk_bf16_f32 v83, v38, v39
    v_exp_f32 v41, v41
    v_exp_f32 v42, v42
    v_cvt_pk_bf16_f32 v84, v40, v41
    v_exp_f32 v43, v43
    v_exp_f32 v44, v44
    v_mfma_f32_32x32x16_bf16 v[64:79], v[104:107], v[80:83], v[64:79]
    v_cvt_pk_bf16_f32 v85, v42, v43
    v_exp_f32 v45, v45
    v_exp_f32 v46, v46
    v_exp_f32 v47, v47
    v_cvt_pk_bf16_f32 v86, v44, v45
    v_cvt_pk_bf16_f32 v87, v46, v47
    s_waitcnt lgkmcnt(0)
    v_mfma_f32_32x32x16_bf16 v[32:47], v[88:91], v[8:11], v[16:31]
    ds_read2st64_b64 v[96:99], v121 offset0:75 offset1:76
    ds_read_b64 v[100:101], v124 offset:38400
    ds_read_b128 v[104:107], v127 offset:37120
    ds_read_b128 v[108:111], v127 offset:37760
    v_exp_f32 v48, v48
    v_exp_f32 v49, v49
    v_exp_f32 v50, v50
    v_cvt_pk_bf16_f32 v80, v48, v49
    v_exp_f32 v51, v51
    v_exp_f32 v52, v52
    v_mfma_f32_32x32x16_bf16 v[64:79], v[116:119], v[84:87], v[64:79]
    v_cvt_pk_bf16_f32 v81, v50, v51
    v_exp_f32 v53, v53
    v_exp_f32 v54, v54
    v_cvt_pk_bf16_f32 v82, v52, v53
    v_exp_f32 v55, v55
    v_exp_f32 v56, v56
    v_mfma_f32_32x32x8bf16_1k v[32:47], v[92:93], v[12:13], v[32:47]
    v_cvt_pk_bf16_f32 v83, v54, v55
    v_exp_f32 v57, v57
    v_exp_f32 v58, v58
    v_cvt_pk_bf16_f32 v84, v56, v57
    v_exp_f32 v59, v59
    v_exp_f32 v60, v60
    v_mfma_f32_32x32x16_bf16 v[64:79], v[112:115], v[80:83], v[64:79]
    v_cvt_pk_bf16_f32 v85, v58, v59
    v_exp_f32 v61, v61
    v_exp_f32 v62, v62
    v_exp_f32 v63, v63
    v_cvt_pk_bf16_f32 v86, v60, v61
    v_cvt_pk_bf16_f32 v87, v62, v63
    s_waitcnt vmcnt(0)
    s_barrier
    s_waitcnt lgkmcnt(0)
    v_mfma_f32_32x32x16_bf16 v[48:63], v[96:99], v[8:11], v[16:31]
    ds_read2st64_b64 v[88:91], v122 offset0:0 offset1:1
    ds_read_b64 v[92:93], v125 offset:0
    ds_read_b128 v[112:115], v127 offset:39680
    ds_read_b128 v[116:119], v127 offset:40320
    v_exp_f32 v32, v32
    v_exp_f32 v33, v33
    v_exp_f32 v34, v34
    v_cvt_pk_bf16_f32 v80, v32, v33
    v_exp_f32 v35, v35
    v_exp_f32 v36, v36
    v_mfma_f32_32x32x16_bf16 v[64:79], v[132:135], v[84:87], v[64:79]
    v_cvt_pk_bf16_f32 v81, v34, v35
    v_exp_f32 v37, v37
    v_exp_f32 v38, v38
    v_cvt_pk_bf16_f32 v82, v36, v37
    v_exp_f32 v39, v39
    v_exp_f32 v40, v40
    v_mfma_f32_32x32x8bf16_1k v[48:63], v[100:101], v[12:13], v[48:63]
    v_cvt_pk_bf16_f32 v83, v38, v39
    v_exp_f32 v41, v41
    v_exp_f32 v42, v42
    v_cvt_pk_bf16_f32 v84, v40, v41
    v_exp_f32 v43, v43
    v_exp_f32 v44, v44
    v_mfma_f32_32x32x16_bf16 v[64:79], v[104:107], v[80:83], v[64:79]
    v_cvt_pk_bf16_f32 v85, v42, v43
    v_exp_f32 v45, v45
    v_exp_f32 v46, v46
    v_exp_f32 v47, v47
    v_cvt_pk_bf16_f32 v86, v44, v45
    v_cvt_pk_bf16_f32 v87, v46, v47
    s_waitcnt lgkmcnt(0)
    v_mfma_f32_32x32x16_bf16 v[32:47], v[88:91], v[8:11], v[16:31]
    ds_read2st64_b64 v[96:99], v122 offset0:5 offset1:6
    ds_read_b64 v[100:101], v125 offset:2560
    ds_read_b128 v[104:107], v128 offset:1280
    ds_read_b128 v[132:135], v128 offset:1920
    v_exp_f32 v48, v48
    v_exp_f32 v49, v49
    v_exp_f32 v50, v50
    v_cvt_pk_bf16_f32 v80, v48, v49
    v_exp_f32 v51, v51
    v_exp_f32 v52, v52
    v_mfma_f32_32x32x16_bf16 v[64:79], v[108:111], v[84:87], v[64:79]
    s_add_u32 m0, s73, 0
    s_add_u32 s74, s77, 122880
    buffer_load_dwordx4 v5, s[48:51], s74 offen sc1 lds
    v_cvt_pk_bf16_f32 v81, v50, v51
    v_exp_f32 v53, v53
    v_exp_f32 v54, v54
    v_cvt_pk_bf16_f32 v82, v52, v53
    v_exp_f32 v55, v55
    v_exp_f32 v56, v56
    v_mfma_f32_32x32x8bf16_1k v[32:47], v[92:93], v[12:13], v[32:47]
    v_cvt_pk_bf16_f32 v83, v54, v55
    v_exp_f32 v57, v57
    v_exp_f32 v58, v58
    v_cvt_pk_bf16_f32 v84, v56, v57
    v_exp_f32 v59, v59
    v_exp_f32 v60, v60
    v_mfma_f32_32x32x16_bf16 v[64:79], v[112:115], v[80:83], v[64:79]
    v_cvt_pk_bf16_f32 v85, v58, v59
    v_exp_f32 v61, v61
    v_exp_f32 v62, v62
    v_exp_f32 v63, v63
    v_cvt_pk_bf16_f32 v86, v60, v61
    v_cvt_pk_bf16_f32 v87, v62, v63
    s_waitcnt lgkmcnt(0)
    v_mfma_f32_32x32x16_bf16 v[48:63], v[96:99], v[8:11], v[16:31]
    ds_read2st64_b64 v[88:91], v122 offset0:10 offset1:11
    ds_read_b64 v[92:93], v125 offset:5120
    ds_read_b128 v[112:115], v128 offset:3840
    ds_read_b128 v[108:111], v128 offset:4480
    v_exp_f32 v32, v32
    v_exp_f32 v33, v33
    v_exp_f32 v34, v34
    v_cvt_pk_bf16_f32 v80, v32, v33
    v_exp_f32 v35, v35
    v_exp_f32 v36, v36
    v_mfma_f32_32x32x16_bf16 v[64:79], v[116:119], v[84:87], v[64:79]
    s_add_u32 m0, s73, 8192
    s_add_u32 s74, s77, 131072
    buffer_load_dwordx4 v5, s[48:51], s74 offen sc1 lds
    v_cvt_pk_bf16_f32 v81, v34, v35
    v_exp_f32 v37, v37
    v_exp_f32 v38, v38
    v_cvt_pk_bf16_f32 v82, v36, v37
    v_exp_f32 v39, v39
    v_exp_f32 v40, v40
    v_mfma_f32_32x32x8bf16_1k v[48:63], v[100:101], v[12:13], v[48:63]
    v_cvt_pk_bf16_f32 v83, v38, v39
    v_exp_f32 v41, v41
    v_exp_f32 v42, v42
    v_cvt_pk_bf16_f32 v84, v40, v41
    v_exp_f32 v43, v43
    v_exp_f32 v44, v44
    v_mfma_f32_32x32x16_bf16 v[64:79], v[104:107], v[80:83], v[64:79]
    v_cvt_pk_bf16_f32 v85, v42, v43
    v_exp_f32 v45, v45
    v_exp_f32 v46, v46
    v_exp_f32 v47, v47
    v_cvt_pk_bf16_f32 v86, v44, v45
    v_cvt_pk_bf16_f32 v87, v46, v47
    s_waitcnt lgkmcnt(0)
    v_mfma_f32_32x32x16_bf16 v[32:47], v[88:91], v[8:11], v[16:31]
    ds_read2st64_b64 v[96:99], v122 offset0:15 offset1:16
    ds_read_b64 v[100:101], v125 offset:7680
    ds_read_b128 v[104:107], v128 offset:6400
    ds_read_b128 v[116:119], v128 offset:7040
    v_exp_f32 v48, v48
    v_exp_f32 v49, v49
    v_exp_f32 v50, v50
    v_cvt_pk_bf16_f32 v80, v48, v49
    v_exp_f32 v51, v51
    v_exp_f32 v52, v52
    v_mfma_f32_32x32x16_bf16 v[64:79], v[132:135], v[84:87], v[64:79]
    s_add_u32 m0, s73, 16384
    s_add_u32 s74, s77, 139264
    buffer_load_dwordx4 v5, s[48:51], s74 offen sc1 lds
    v_cvt_pk_bf16_f32 v81, v50, v51
    v_exp_f32 v53, v53
    v_exp_f32 v54, v54
    v_cvt_pk_bf16_f32 v82, v52, v53
    v_exp_f32 v55, v55
    v_exp_f32 v56, v56
    v_mfma_f32_32x32x8bf16_1k v[32:47], v[92:93], v[12:13], v[32:47]
    v_cvt_pk_bf16_f32 v83, v54, v55
    v_exp_f32 v57, v57
    v_exp_f32 v58, v58
    v_cvt_pk_bf16_f32 v84, v56, v57
    v_exp_f32 v59, v59
    v_exp_f32 v60, v60
    v_mfma_f32_32x32x16_bf16 v[64:79], v[112:115], v[80:83], v[64:79]
    v_cvt_pk_bf16_f32 v85, v58, v59
    v_exp_f32 v61, v61
    v_exp_f32 v62, v62
    v_exp_f32 v63, v63
    v_cvt_pk_bf16_f32 v86, v60, v61
    v_cvt_pk_bf16_f32 v87, v62, v63
    s_waitcnt lgkmcnt(0)
    v_mfma_f32_32x32x16_bf16 v[48:63], v[96:99], v[8:11], v[16:31]
    ds_read2st64_b64 v[88:91], v122 offset0:20 offset1:21
    ds_read_b64 v[92:93], v125 offset:10240
    ds_read_b128 v[112:115], v128 offset:8960
    ds_read_b128 v[132:135], v128 offset:9600
    v_exp_f32 v32, v32
    v_exp_f32 v33, v33
    v_exp_f32 v34, v34
    v_cvt_pk_bf16_f32 v80, v32, v33
    v_exp_f32 v35, v35
    v_exp_f32 v36, v36
    v_mfma_f32_32x32x16_bf16 v[64:79], v[108:111], v[84:87], v[64:79]
    s_add_u32 m0, s73, 24576
    s_add_u32 s74, s77, 147456
    buffer_load_dwordx4 v5, s[48:51], s74 offen sc1 lds
    v_cvt_pk_bf16_f32 v81, v34, v35
    v_exp_f32 v37, v37
    v_exp_f32 v38, v38
    v_cvt_pk_bf16_f32 v82, v36, v37
    v_exp_f32 v39, v39
    v_exp_f32 v40, v40
    v_mfma_f32_32x32x8bf16_1k v[48:63], v[100:101], v[12:13], v[48:63]
    v_cvt_pk_bf16_f32 v83, v38, v39
    v_exp_f32 v41, v41
    v_exp_f32 v42, v42
    v_cvt_pk_bf16_f32 v84, v40, v41
    v_exp_f32 v43, v43
    v_exp_f32 v44, v44
    v_mfma_f32_32x32x16_bf16 v[64:79], v[104:107], v[80:83], v[64:79]
    v_cvt_pk_bf16_f32 v85, v42, v43
    v_exp_f32 v45, v45
    v_exp_f32 v46, v46
    v_exp_f32 v47, v47
    v_cvt_pk_bf16_f32 v86, v44, v45
    v_cvt_pk_bf16_f32 v87, v46, v47
    s_waitcnt lgkmcnt(0)
    v_mfma_f32_32x32x16_bf16 v[32:47], v[88:91], v[8:11], v[16:31]
    ds_read2st64_b64 v[96:99], v122 offset0:25 offset1:26
    ds_read_b64 v[100:101], v125 offset:12800
    ds_read_b128 v[104:107], v128 offset:11520
    ds_read_b128 v[108:111], v128 offset:12160
    v_exp_f32 v48, v48
    v_exp_f32 v49, v49
    v_exp_f32 v50, v50
    v_cvt_pk_bf16_f32 v80, v48, v49
    v_exp_f32 v51, v51
    v_exp_f32 v52, v52
    v_mfma_f32_32x32x16_bf16 v[64:79], v[116:119], v[84:87], v[64:79]
    s_add_u32 m0, s73, 32768
    s_add_u32 s74, s77, 155648
    buffer_load_dwordx4 v5, s[48:51], s74 offen sc1 lds
    v_cvt_pk_bf16_f32 v81, v50, v51
    v_exp_f32 v53, v53
    v_exp_f32 v54, v54
    v_cvt_pk_bf16_f32 v82, v52, v53
    v_exp_f32 v55, v55
    v_exp_f32 v56, v56
    v_mfma_f32_32x32x8bf16_1k v[32:47], v[92:93], v[12:13], v[32:47]
    v_cvt_pk_bf16_f32 v83, v54, v55
    v_exp_f32 v57, v57
    v_exp_f32 v58, v58
    v_cvt_pk_bf16_f32 v84, v56, v57
    v_exp_f32 v59, v59
    v_exp_f32 v60, v60
    v_mfma_f32_32x32x16_bf16 v[64:79], v[112:115], v[80:83], v[64:79]
    v_cvt_pk_bf16_f32 v85, v58, v59
    v_exp_f32 v61, v61
    v_exp_f32 v62, v62
    v_exp_f32 v63, v63
    v_cvt_pk_bf16_f32 v86, v60, v61
    v_cvt_pk_bf16_f32 v87, v62, v63
    s_waitcnt lgkmcnt(0)
    v_mfma_f32_32x32x16_bf16 v[48:63], v[96:99], v[8:11], v[16:31]
    ds_read2st64_b64 v[88:91], v122 offset0:30 offset1:31
    ds_read_b64 v[92:93], v125 offset:15360
    ds_read_b128 v[112:115], v128 offset:14080
    ds_read_b128 v[116:119], v128 offset:14720
    v_exp_f32 v32, v32
    v_exp_f32 v33, v33
    v_exp_f32 v34, v34
    v_cvt_pk_bf16_f32 v80, v32, v33
    v_exp_f32 v35, v35
    v_exp_f32 v36, v36
    v_mfma_f32_32x32x16_bf16 v[64:79], v[132:135], v[84:87], v[64:79]
    s_cmp_le_u32 s84, 0
    s_cbranch_scc1 rs_43
    s_add_u32 s79, s78, 0
    buffer_store_dwordx4 v[136:139], v1, s[60:63], s79 offen sc1
rs_43:
    v_cvt_pk_bf16_f32 v81, v34, v35
    v_exp_f32 v37, v37
    v_exp_f32 v38, v38
    v_cvt_pk_bf16_f32 v82, v36, v37
    v_exp_f32 v39, v39
    v_exp_f32 v40, v40
    v_mfma_f32_32x32x8bf16_1k v[48:63], v[100:101], v[12:13], v[48:63]
    v_cvt_pk_bf16_f32 v83, v38, v39
    v_exp_f32 v41, v41
    v_exp_f32 v42, v42
    v_cvt_pk_bf16_f32 v84, v40, v41
    v_exp_f32 v43, v43
    v_exp_f32 v44, v44
    v_mfma_f32_32x32x16_bf16 v[64:79], v[104:107], v[80:83], v[64:79]
    v_cvt_pk_bf16_f32 v85, v42, v43
    v_exp_f32 v45, v45
    v_exp_f32 v46, v46
    v_exp_f32 v47, v47
    v_cvt_pk_bf16_f32 v86, v44, v45
    v_cvt_pk_bf16_f32 v87, v46, v47
    s_waitcnt lgkmcnt(0)
    v_mfma_f32_32x32x16_bf16 v[32:47], v[88:91], v[8:11], v[16:31]
    ds_read2st64_b64 v[96:99], v122 offset0:35 offset1:36
    ds_read_b64 v[100:101], v125 offset:17920
    ds_read_b128 v[104:107], v128 offset:16640
    ds_read_b128 v[132:135], v128 offset:17280
    v_exp_f32 v48, v48
    v_exp_f32 v49, v49
    v_exp_f32 v50, v50
    v_cvt_pk_bf16_f32 v80, v48, v49
    v_exp_f32 v51, v51
    v_exp_f32 v52, v52
    v_mfma_f32_32x32x16_bf16 v[64:79], v[108:111], v[84:87], v[64:79]
    s_cmp_le_u32 s84, 1
    s_cbranch_scc1 rs_44
    s_add_u32 s79, s78, 1024
    buffer_store_dwordx4 v[140:143], v1, s[60:63], s79 offen sc1
rs_44:
    v_cvt_pk_bf16_f32 v81, v50, v51
    v_exp_f32 v53, v53
    v_exp_f32 v54, v54
    v_cvt_pk_bf16_f32 v82, v52, v53
    v_exp_f32 v55, v55
    v_exp_f32 v56, v56
    v_mfma_f32_32x32x8bf16_1k v[32:47], v[92:93], v[12:13], v[32:47]
    v_cvt_pk_bf16_f32 v83, v54, v55
    v_exp_f32 v57, v57
    v_exp_f32 v58, v58
    v_cvt_pk_bf16_f32 v84, v56, v57
    v_exp_f32 v59, v59
    v_exp_f32 v60, v60
    v_mfma_f32_32x32x16_bf16 v[64:79], v[112:115], v[80:83], v[64:79]
    v_cvt_pk_bf16_f32 v85, v58, v59
    v_exp_f32 v61, v61
    v_exp_f32 v62, v62
    v_exp_f32 v63, v63
    v_cvt_pk_bf16_f32 v86, v60, v61
    v_cvt_pk_bf16_f32 v87, v62, v63
    s_waitcnt lgkmcnt(0)
    v_mfma_f32_32x32x16_bf16 v[48:63], v[96:99], v[8:11], v[16:31]
    ds_read2st64_b64 v[88:91], v122 offset0:40 offset1:41
    ds_read_b64 v[92:93], v125 offset:20480
    ds_read_b128 v[112:115], v128 offset:19200
    ds_read_b128 v[108:111], v128 offset:19840
    v_exp_f32 v32, v32
    v_exp_f32 v33, v33
    v_exp_f32 v34, v34
    v_cvt_pk_bf16_f32 v80, v32, v33
    v_exp_f32 v35, v35
    v_exp_f32 v36, v36
    v_mfma_f32_32x32x16_bf16 v[64:79], v[116:119], v[84:87], v[64:79]
    s_cmp_le_u32 s84, 2
    s_cbranch_scc1 rs_45
    s_add_u32 s79, s78, 2048
    buffer_store_dwordx4 v[144:147], v1, s[60:63], s79 offen sc1
rs_45:
    v_cvt_pk_bf16_f32 v81, v34, v35
    v_exp_f32 v37, v37
    v_exp_f32 v38, v38
    v_cvt_pk_bf16_f32 v82, v36, v37
    v_exp_f32 v39, v39
    v_exp_f32 v40, v40
    v_mfma_f32_32x32x8bf16_1k v[48:63], v[100:101], v[12:13], v[48:63]
    v_cvt_pk_bf16_f32 v83, v38, v39
    v_exp_f32 v41, v41
    v_exp_f32 v42, v42
    v_cvt_pk_bf16_f32 v84, v40, v41
    v_exp_f32 v43, v43
    v_exp_f32 v44, v44
    v_mfma_f32_32x32x16_bf16 v[64:79], v[104:107], v[80:83], v[64:79]
    v_cvt_pk_bf16_f32 v85, v42, v43
    v_exp_f32 v45, v45
    v_exp_f32 v46, v46
    v_exp_f32 v47, v47
    v_cvt_pk_bf16_f32 v86, v44, v45
    v_cvt_pk_bf16_f32 v87, v46, v47
    s_waitcnt lgkmcnt(0)
    v_mfma_f32_32x32x16_bf16 v[32:47], v[88:91], v[8:11], v[16:31]
    ds_read2st64_b64 v[96:99], v122 offset0:45 offset1:46
    ds_read_b64 v[100:101], v125 offset:23040
    ds_read_b128 v[104:107], v128 offset:21760
    ds_read_b128 v[116:119], v128 offset:22400
    v_exp_f32 v48, v48
    v_exp_f32 v49, v49
    v_exp_f32 v50, v50
    v_cvt_pk_bf16_f32 v80, v48, v49
    v_exp_f32 v51, v51
    v_exp_f32 v52, v52
    v_mfma_f32_32x32x16_bf16 v[64:79], v[132:135], v[84:87], v[64:79]
    s_cmp_le_u32 s84, 3
    s_cbranch_scc1 rs_46
    s_add_u32 s79, s78, 3072
    buffer_store_dwordx4 v[148:151], v1, s[60:63], s79 offen sc1
rs_46:
    v_cvt_pk_bf16_f32 v81, v50, v51
    v_exp_f32 v53, v53
    v_exp_f32 v54, v54
    v_cvt_pk_bf16_f32 v82, v52, v53
    v_exp_f32 v55, v55
    v_exp_f32 v56, v56
    v_mfma_f32_32x32x8bf16_1k v[32:47], v[92:93], v[12:13], v[32:47]
    v_cvt_pk_bf16_f32 v83, v54, v55
    v_exp_f32 v57, v57
    v_exp_f32 v58, v58
    v_cvt_pk_bf16_f32 v84, v56, v57
    v_exp_f32 v59, v59
    v_exp_f32 v60, v60
    v_mfma_f32_32x32x16_bf16 v[64:79], v[112:115], v[80:83], v[64:79]
    v_cvt_pk_bf16_f32 v85, v58, v59
    v_exp_f32 v61, v61
    v_exp_f32 v62, v62
    v_exp_f32 v63, v63
    v_cvt_pk_bf16_f32 v86, v60, v61
    v_cvt_pk_bf16_f32 v87, v62, v63
    s_waitcnt lgkmcnt(0)
    v_mfma_f32_32x32x16_bf16 v[48:63], v[96:99], v[8:11], v[16:31]
    ds_read2st64_b64 v[88:91], v122 offset0:50 offset1:51
    ds_read_b64 v[92:93], v125 offset:25600
    ds_read_b128 v[112:115], v128 offset:24320
    ds_read_b128 v[132:135], v128 offset:24960
    v_exp_f32 v32, v32
    v_exp_f32 v33, v33
    v_exp_f32 v34, v34
    v_cvt_pk_bf16_f32 v80, v32, v33
    v_exp_f32 v35, v35
    v_exp_f32 v36, v36
    v_mfma_f32_32x32x16_bf16 v[64:79], v[108:111], v[84:87], v[64:79]
    s_cmp_le_u32 s84, 4
    s_cbranch_scc1 rs_47
    s_add_u32 s79, s78, 4096
    buffer_store_dwordx4 v[152:155], v1, s[60:63], s79 offen sc1
rs_47:
    v_cvt_pk_bf16_f32 v81, v34, v35
    v_exp_f32 v37, v37
    v_exp_f32 v38, v38
    v_cvt_pk_bf16_f32 v82, v36, v37
    v_exp_f32 v39, v39
    v_exp_f32 v40, v40
    v_mfma_f32_32x32x8bf16_1k v[48:63], v[100:101], v[12:13], v[48:63]
    v_cvt_pk_bf16_f32 v83, v38, v39
    v_exp_f32 v41, v41
    v_exp_f32 v42, v42
    v_cvt_pk_bf16_f32 v84, v40, v41
    v_exp_f32 v43, v43
    v_exp_f32 v44, v44
    v_mfma_f32_32x32x16_bf16 v[64:79], v[104:107], v[80:83], v[64:79]
    v_cvt_pk_bf16_f32 v85, v42, v43
    v_exp_f32 v45, v45
    v_exp_f32 v46, v46
    v_exp_f32 v47, v47
    v_cvt_pk_bf16_f32 v86, v44, v45
    v_cvt_pk_bf16_f32 v87, v46, v47
    s_waitcnt lgkmcnt(0)
    v_mfma_f32_32x32x16_bf16 v[32:47], v[88:91], v[8:11], v[16:31]
    ds_read2st64_b64 v[96:99], v122 offset0:55 offset1:56
    ds_read_b64 v[100:101], v125 offset:28160
    ds_read_b128 v[104:107], v128 offset:26880
    ds_read_b128 v[108:111], v128 offset:27520
    v_exp_f32 v48, v48
    v_exp_f32 v49, v49
    v_exp_f32 v50, v50
    v_cvt_pk_bf16_f32 v80, v48, v49
    v_exp_f32 v51, v51
    v_exp_f32 v52, v52
    v_mfma_f32_32x32x16_bf16 v[64:79], v[116:119], v[84:87], v[64:79]
    v_cvt_pk_bf16_f32 v81, v50, v51
    v_exp_f32 v53, v53
    v_exp_f32 v54, v54
    v_cvt_pk_bf16_f32 v82, v52, v53
    v_exp_f32 v55, v55
    v_exp_f32 v56, v56
    v_mfma_f32_32x32x8bf16_1k v[32:47], v[92:93], v[12:13], v[32:47]
    v_cvt_pk_bf16_f32 v83, v54, v55
    v_exp_f32 v57, v57
    v_exp_f32 v58, v58
    v_cvt_pk_bf16_f32 v84, v56, v57
    v_exp_f32 v59, v59
    v_exp_f32 v60, v60
    v_mfma_f32_32x32x16_bf16 v[64:79], v[112:115], v[80:83], v[64:79]
    v_cvt_pk_bf16_f32 v85, v58, v59
    v_exp_f32 v61, v61
    v_exp_f32 v62, v62
    v_exp_f32 v63, v63
    v_cvt_pk_bf16_f32 v86, v60, v61
    v_cvt_pk_bf16_f32 v87, v62, v63
    s_waitcnt lgkmcnt(0)
    v_mfma_f32_32x32x16_bf16 v[48:63], v[96:99], v[8:11], v[16:31]
    ds_read2st64_b64 v[88:91], v122 offset0:60 offset1:61
    ds_read_b64 v[92:93], v125 offset:30720
    ds_read_b128 v[112:115], v128 offset:29440
    ds_read_b128 v[116:119], v128 offset:30080
    v_exp_f32 v32, v32
    v_exp_f32 v33, v33
    v_exp_f32 v34, v34
    v_cvt_pk_bf16_f32 v80, v32, v33
    v_exp_f32 v35, v35
    v_exp_f32 v36, v36
    v_mfma_f32_32x32x16_bf16 v[64:79], v[132:135], v[84:87], v[64:79]
    v_cvt_pk_bf16_f32 v81, v34, v35
    v_exp_f32 v37, v37
    v_exp_f32 v38, v38
    v_cvt_pk_bf16_f32 v82, v36, v37
    v_exp_f32 v39, v39
    v_exp_f32 v40, v40
    v_mfma_f32_32x32x8bf16_1k v[48:63], v[100:101], v[12:13], v[48:63]
    v_cvt_pk_bf16_f32 v83, v38, v39
    v_exp_f32 v41, v41
    v_exp_f32 v42, v42
    v_cvt_pk_bf16_f32 v84, v40, v41
    v_exp_f32 v43, v43
    v_exp_f32 v44, v44
    v_mfma_f32_32x32x16_bf16 v[64:79], v[104:107], v[80:83], v[64:79]
    v_cvt_pk_bf16_f32 v85, v42, v43
    v_exp_f32 v45, v45
    v_exp_f32 v46, v46
    v_exp_f32 v47, v47
    v_cvt_pk_bf16_f32 v86, v44, v45
    v_cvt_pk_bf16_f32 v87, v46, v47
    s_waitcnt lgkmcnt(0)
    v_mfma_f32_32x32x16_bf16 v[32:47], v[88:91], v[8:11], v[16:31]
    ds_read2st64_b64 v[96:99], v122 offset0:65 offset1:66
    ds_read_b64 v[100:101], v125 offset:33280
    ds_read_b128 v[104:107], v128 offset:32000
    ds_read_b128 v[132:135], v128 offset:32640
    v_exp_f32 v48, v48
    v_exp_f32 v49, v49
    v_exp_f32 v50, v50
    v_cvt_pk_bf16_f32 v80, v48, v49
    v_exp_f32 v51, v51
    v_exp_f32 v52, v52
    v_mfma_f32_32x32x16_bf16 v[64:79], v[108:111], v[84:87], v[64:79]
    v_cvt_pk_bf16_f32 v81, v50, v51
    v_exp_f32 v53, v53
    v_exp_f32 v54, v54
    v_cvt_pk_bf16_f32 v82, v52, v53
    v_exp_f32 v55, v55
    v_exp_f32 v56, v56
    v_mfma_f32_32x32x8bf16_1k v[32:47], v[92:93], v[12:13], v[32:47]
    v_cvt_pk_bf16_f32 v83, v54, v55
    v_exp_f32 v57, v57
    v_exp_f32 v58, v58
    v_cvt_pk_bf16_f32 v84, v56, v57
    v_exp_f32 v59, v59
    v_exp_f32 v60, v60
    v_mfma_f32_32x32x16_bf16 v[64:79], v[112:115], v[80:83], v[64:79]
    v_cvt_pk_bf16_f32 v85, v58, v59
    v_exp_f32 v61, v61
    v_exp_f32 v62, v62
    v_exp_f32 v63, v63
    v_cvt_pk_bf16_f32 v86, v60, v61
    v_cvt_pk_bf16_f32 v87, v62, v63
    s_waitcnt lgkmcnt(0)
    v_mfma_f32_32x32x16_bf16 v[48:63], v[96:99], v[8:11], v[16:31]
    ds_read2st64_b64 v[88:91], v122 offset0:70 offset1:71
    ds_read_b64 v[92:93], v125 offset:35840
    ds_read_b128 v[112:115], v128 offset:34560
    ds_read_b128 v[108:111], v128 offset:35200
    v_exp_f32 v32, v32
    v_exp_f32 v33, v33
    v_exp_f32 v34, v34
    v_cvt_pk_bf16_f32 v80, v32, v33
    v_exp_f32 v35, v35
    v_exp_f32 v36, v36
    v_mfma_f32_32x32x16_bf16 v[64:79], v[116:119], v[84:87], v[64:79]
    v_cvt_pk_bf16_f32 v81, v34, v35
    v_exp_f32 v37, v37
    v_exp_f32 v38, v38
    v_cvt_pk_bf16_f32 v82, v36, v37
    v_exp_f32 v39, v39
    v_exp_f32 v40, v40
    v_mfma_f32_32x32x8bf16_1k v[48:63], v[100:101], v[12:13], v[48:63]
    v_cvt_pk_bf16_f32 v83, v38, v39
    v_exp_f32 v41, v41
    v_exp_f32 v42, v42
    v_cvt_pk_bf16_f32 v84, v40, v41
    v_exp_f32 v43, v43
    v_exp_f32 v44, v44
    v_mfma_f32_32x32x16_bf16 v[64:79], v[104:107], v[80:83], v[64:79]
    v_cvt_pk_bf16_f32 v85, v42, v43
    v_exp_f32 v45, v45
    v_exp_f32 v46, v46
    v_exp_f32 v47, v47
    v_cvt_pk_bf16_f32 v86, v44, v45
    v_cvt_pk_bf16_f32 v87, v46, v47
    s_waitcnt lgkmcnt(0)
    v_mfma_f32_32x32x16_bf16 v[32:47], v[88:91], v[8:11], v[16:31]
    ds_read2st64_b64 v[96:99], v122 offset0:75 offset1:76
    ds_read_b64 v[100:101], v125 offset:38400
    ds_read_b128 v[104:107], v128 offset:37120
    ds_read_b128 v[116:119], v128 offset:37760
    v_exp_f32 v48, v48
    v_exp_f32 v49, v49
    v_exp_f32 v50, v50
    v_cvt_pk_bf16_f32 v80, v48, v49
    v_exp_f32 v51, v51
    v_exp_f32 v52, v52
    v_mfma_f32_32x32x16_bf16 v[64:79], v[132:135], v[84:87], v[64:79]
    v_cvt_pk_bf16_f32 v81, v50, v51
    v_exp_f32 v53, v53
    v_exp_f32 v54, v54
    v_cvt_pk_bf16_f32 v82, v52, v53
    v_exp_f32 v55, v55
    v_exp_f32 v56, v56
    v_mfma_f32_32x32x8bf16_1k v[32:47], v[92:93], v[12:13], v[32:47]
    v_cvt_pk_bf16_f32 v83, v54, v55
    v_exp_f32 v57, v57
    v_exp_f32 v58, v58
    v_cvt_pk_bf16_f32 v84, v56, v57
    v_exp_f32 v59, v59
    v_exp_f32 v60, v60
    v_mfma_f32_32x32x16_bf16 v[64:79], v[112:115], v[80:83], v[64:79]
    v_cvt_pk_bf16_f32 v85, v58, v59
    v_exp_f32 v61, v61
    v_exp_f32 v62, v62
    v_exp_f32 v63, v63
    v_cvt_pk_bf16_f32 v86, v60, v61
    v_cvt_pk_bf16_f32 v87, v62, v63
    s_waitcnt vmcnt(0)
    s_barrier
    s_cmp_lg_u32 s40, 0
    s_cbranch_scc1 sig_48
    s_lshl_b32 s94, s2, 6
    s_add_u32 s94, s94, 81984
    v_mov_b32 v250, s41
    v_mov_b32 v251, 0
    s_mov_b64 exec, 1
    buffer_store_dword v250, v251, s[96:99], s94 offen sc1
    s_mov_b64 exec, -1
sig_48:
    s_cmp_lg_u32 s40, 7
    s_cbranch_scc1 cp_49
    s_getpc_b64 s[92:93]
cp_here_50:
    s_sub_u32 s92, s92, cp_here_50-adaLN_cond__mha_block__glu_gated_glu__prompt_kernel
    s_subb_u32 s93, s93, 0
    s_lshr_b32 s94, s2, 3
    s_and_b32 s94, s94, 31
    s_mul_i32 s94, s94, (L_fin-adaLN_cond__mha_block__glu_gated_glu__prompt_kernel+4095)/4096*128
    v_min_u32 v252, (L_fin-adaLN_cond__mha_block__glu_gated_glu__prompt_kernel+4095)/4096-1, v0
    v_lshlrev_b32 v252, 7, v252
    v_add_u32 v252, s94, v252
    v_min_u32 v252, L_fin-adaLN_cond__mha_block__glu_gated_glu__prompt_kernel, v252
    v_mov_b32 v253, s93
    v_add_co_u32 v252, vcc, s92, v252
    s_nop 1
    v_addc_co_u32 v253, vcc, 0, v253, vcc
    global_load_dword v254, v[252:253], off
cp_49:
    s_waitcnt lgkmcnt(0)
    v_mfma_f32_32x32x16_bf16 v[48:63], v[96:99], v[8:11], v[16:31]
    ds_read2st64_b64 v[88:91], v120 offset0:0 offset1:1
    ds_read_b64 v[92:93], v123 offset:0
    ds_read_b128 v[112:115], v128 offset:39680
    ds_read_b128 v[132:135], v128 offset:40320
    v_exp_f32 v32, v32
    v_exp_f32 v33, v33
    v_exp_f32 v34, v34
    v_cvt_pk_bf16_f32 v80, v32, v33
    v_exp_f32 v35, v35
    v_exp_f32 v36, v36
    v_mfma_f32_32x32x16_bf16 v[64:79], v[108:111], v[84:87], v[64:79]
    v_cvt_pk_bf16_f32 v81, v34, v35
    v_exp_f32 v37, v37
    v_exp_f32 v38, v38
    v_cvt_pk_bf16_f32 v82, v36, v37
    v_exp_f32 v39, v39
    v_exp_f32 v40, v40
    v_mfma_f32_32x32x8bf16_1k v[48:63], v[100:101], v[12:13], v[48:63]
    v_cvt_pk_bf16_f32 v83, v38, v39
    v_exp_f32 v41, v41
    v_exp_f32 v42, v42
    v_cvt_pk_bf16_f32 v84, v40, v41
    v_exp_f32 v43, v43
    v_exp_f32 v44, v44
    v_mfma_f32_32x32x16_bf16 v[64:79], v[104:107], v[80:83], v[64:79]
    v_cvt_pk_bf16_f32 v85, v42, v43
    v_exp_f32 v45, v45
    v_exp_f32 v46, v46
    v_exp_f32 v47, v47
    v_cvt_pk_bf16_f32 v86, v44, v45
    v_cvt_pk_bf16_f32 v87, v46, v47
    s_waitcnt lgkmcnt(0)
    v_mfma_f32_32x32x16_bf16 v[32:47], v[88:91], v[8:11], v[16:31]
    ds_read2st64_b64 v[96:99], v120 offset0:5 offset1:6
    ds_read_b64 v[100:101], v123 offset:2560
    ds_read_b128 v[104:107], v126 offset:1280
    ds_read_b128 v[108:111], v126 offset:1920
    v_exp_f32 v48, v48
    v_exp_f32 v49, v49
    v_exp_f32 v50, v50
    v_cvt_pk_bf16_f32 v80, v48, v49
    v_exp_f32 v51, v51
    v_exp_f32 v52, v52
    v_mfma_f32_32x32x16_bf16 v[64:79], v[116:119], v[84:87], v[64:79]
    v_cvt_pk_bf16_f32 v81, v50, v51
    v_exp_f32 v53, v53
    v_exp_f32 v54, v54
    v_cvt_pk_bf16_f32 v82, v52, v53
    v_exp_f32 v55, v55
    v_exp_f32 v56, v56
    v_mfma_f32_32x32x8bf16_1k v[32:47], v[92:93], v[12:13], v[32:47]
    v_cvt_pk_bf16_f32 v83, v54, v55
    v_exp_f32 v57, v57
    v_exp_f32 v58, v58
    v_cvt_pk_bf16_f32 v84, v56, v57
    v_exp_f32 v59, v59
    v_exp_f32 v60, v60
    v_mfma_f32_32x32x16_bf16 v[64:79], v[112:115], v[80:83], v[64:79]
    v_cvt_pk_bf16_f32 v85, v58, v59
    v_exp_f32 v61, v61
    v_exp_f32 v62, v62
    v_exp_f32 v63, v63
    v_cvt_pk_bf16_f32 v86, v60, v61
    v_cvt_pk_bf16_f32 v87, v62, v63
    s_waitcnt lgkmcnt(0)
    v_mfma_f32_32x32x16_bf16 v[48:63], v[96:99], v[8:11], v[16:31]
    ds_read2st64_b64 v[88:91], v120 offset0:10 offset1:11
    ds_read_b64 v[92:93], v123 offset:5120
    ds_read_b128 v[112:115], v126 offset:3840
    ds_read_b128 v[116:119], v126 offset:4480
    v_exp_f32 v32, v32
    v_exp_f32 v33, v33
    v_exp_f32 v34, v34
    v_cvt_pk_bf16_f32 v80, v32, v33
    v_exp_f32 v35, v35
    v_exp_f32 v36, v36
    v_mfma_f32_32x32x16_bf16 v[64:79], v[132:135], v[84:87], v[64:79]
    v_cvt_pk_bf16_f32 v81, v34, v35
    v_exp_f32 v37, v37
    v_exp_f32 v38, v38
    v_cvt_pk_bf16_f32 v82, v36, v37
    v_exp_f32 v39, v39
    v_exp_f32 v40, v40
    v_mfma_f32_32x32x8bf16_1k v[48:63], v[100:101], v[12:13], v[48:63]
    v_cvt_pk_bf16_f32 v83, v38, v39
    v_exp_f32 v41, v41
    v_exp_f32 v42, v42
    v_cvt_pk_bf16_f32 v84, v40, v41
    v_exp_f32 v43, v43
    v_exp_f32 v44, v44
    v_mfma_f32_32x32x16_bf16 v[64:79], v[104:107], v[80:83], v[64:79]
    v_cvt_pk_bf16_f32 v85, v42, v43
    v_exp_f32 v45, v45
    v_exp_f32 v46, v46
    v_exp_f32 v47, v47
    v_cvt_pk_bf16_f32 v86, v44, v45
    v_cvt_pk_bf16_f32 v87, v46, v47
    s_waitcnt lgkmcnt(0)
    v_mfma_f32_32x32x16_bf16 v[32:47], v[88:91], v[8:11], v[16:31]
    ds_read2st64_b64 v[96:99], v120 offset0:15 offset1:16
    ds_read_b64 v[100:101], v123 offset:7680
    ds_read_b128 v[104:107], v126 offset:6400
    ds_read_b128 v[132:135], v126 offset:7040
    v_exp_f32 v48, v48
    v_exp_f32 v49, v49
    v_exp_f32 v50, v50
    v_cvt_pk_bf16_f32 v80, v48, v49
    v_exp_f32 v51, v51
    v_exp_f32 v52, v52
    v_mfma_f32_32x32x16_bf16 v[64:79], v[108:111], v[84:87], v[64:79]
    v_cvt_pk_bf16_f32 v81, v50, v51
    v_exp_f32 v53, v53
    v_exp_f32 v54, v54
    v_cvt_pk_bf16_f32 v82, v52, v53
    v_exp_f32 v55, v55
    v_exp_f32 v56, v56
    v_mfma_f32_32x32x8bf16_1k v[32:47], v[92:93], v[12:13], v[32:47]
    v_cvt_pk_bf16_f32 v83, v54, v55
    v_exp_f32 v57, v57
    v_exp_f32 v58, v58
    v_cvt_pk_bf16_f32 v84, v56, v57
    v_exp_f32 v59, v59
    v_exp_f32 v60, v60
    v_mfma_f32_32x32x16_bf16 v[64:79], v[112:115], v[80:83], v[64:79]
    v_cvt_pk_bf16_f32 v85, v58, v59
    v_exp_f32 v61, v61
    v_exp_f32 v62, v62
    v_exp_f32 v63, v63
    v_cvt_pk_bf16_f32 v86, v60, v61
    v_cvt_pk_bf16_f32 v87, v62, v63
    s_waitcnt lgkmcnt(0)
    v_mfma_f32_32x32x16_bf16 v[48:63], v[96:99], v[8:11], v[16:31]
    ds_read2st64_b64 v[88:91], v120 offset0:20 offset1:21
    ds_read_b64 v[92:93], v123 offset:10240
    ds_read_b128 v[112:115], v126 offset:8960
    ds_read_b128 v[108:111], v126 offset:9600
    v_exp_f32 v32, v32
    v_exp_f32 v33, v33
    v_exp_f32 v34, v34
    v_cvt_pk_bf16_f32 v80, v32, v33
    v_exp_f32 v35, v35
    v_exp_f32 v36, v36
    v_mfma_f32_32x32x16_bf16 v[64:79], v[116:119], v[84:87], v[64:79]
    v_cvt_pk_bf16_f32 v81, v34, v35
    v_exp_f32 v37, v37
    v_exp_f32 v38, v38
    v_cvt_pk_bf16_f32 v82, v36, v37
    v_exp_f32 v39, v39
    v_exp_f32 v40, v40
    v_mfma_f32_32x32x8bf16_1k v[48:63], v[100:101], v[12:13], v[48:63]
    v_cvt_pk_bf16_f32 v83, v38, v39
    v_exp_f32 v41, v41
    v_exp_f32 v42, v42
    v_cvt_pk_bf16_f32 v84, v40, v41
    v_exp_f32 v43, v43
    v_exp_f32 v44, v44
    v_mfma_f32_32x32x16_bf16 v[64:79], v[104:107], v[80:83], v[64:79]
    v_cvt_pk_bf16_f32 v85, v42, v43
    v_exp_f32 v45, v45
    v_exp_f32 v46, v46
    v_exp_f32 v47, v47
    v_cvt_pk_bf16_f32 v86, v44, v45
    v_cvt_pk_bf16_f32 v87, v46, v47
    s_waitcnt lgkmcnt(0)
    v_mfma_f32_32x32x16_bf16 v[32:47], v[88:91], v[8:11], v[16:31]
    ds_read2st64_b64 v[96:99], v120 offset0:25 offset1:26
    ds_read_b64 v[100:101], v123 offset:12800
    ds_read_b128 v[104:107], v126 offset:11520
    ds_read_b128 v[116:119], v126 offset:12160
    v_exp_f32 v48, v48
    v_exp_f32 v49, v49
    v_exp_f32 v50, v50
    v_cvt_pk_bf16_f32 v80, v48, v49
    v_exp_f32 v51, v51
    v_exp_f32 v52, v52
    v_mfma_f32_32x32x16_bf16 v[64:79], v[132:135], v[84:87], v[64:79]
    v_cvt_pk_bf16_f32 v81, v50, v51
    v_exp_f32 v53, v53
    v_exp_f32 v54, v54
    v_cvt_pk_bf16_f32 v82, v52, v53
    v_exp_f32 v55, v55
    v_exp_f32 v56, v56
    v_mfma_f32_32x32x8bf16_1k v[32:47], v[92:93], v[12:13], v[32:47]
    v_cvt_pk_bf16_f32 v83, v54, v55
    v_exp_f32 v57, v57
    v_exp_f32 v58, v58
    v_cvt_pk_bf16_f32 v84, v56, v57
    v_exp_f32 v59, v59
    v_exp_f32 v60, v60
    v_mfma_f32_32x32x16_bf16 v[64:79], v[112:115], v[80:83], v[64:79]
    v_cvt_pk_bf16_f32 v85, v58, v59
    v_exp_f32 v61, v61
    v_exp_f32 v62, v62
    v_exp_f32 v63, v63
    v_cvt_pk_bf16_f32 v86, v60, v61
    v_cvt_pk_bf16_f32 v87, v62, v63
    s_waitcnt lgkmcnt(0)
    v_mfma_f32_32x32x16_bf16 v[48:63], v[96:99], v[8:11], v[16:31]
    ds_read2st64_b64 v[88:91], v120 offset0:30 offset1:31
    ds_read_b64 v[92:93], v123 offset:15360
    ds_read_b128 v[112:115], v126 offset:14080
    ds_read_b128 v[132:135], v126 offset:14720
    v_exp_f32 v32, v32
    v_exp_f32 v33, v33
    v_exp_f32 v34, v34
    v_cvt_pk_bf16_f32 v80, v32, v33
    v_exp_f32 v35, v35
    v_exp_f32 v36, v36
    v_mfma_f32_32x32x16_bf16 v[64:79], v[108:111], v[84:87], v[64:79]
    v_cvt_pk_bf16_f32 v81, v34, v35
    v_exp_f32 v37, v37
    v_exp_f32 v38, v38
    v_cvt_pk_bf16_f32 v82, v36, v37
    v_exp_f32 v39, v39
    v_exp_f32 v40, v40
    v_mfma_f32_32x32x8bf16_1k v[48:63], v[100:101], v[12:13], v[48:63]
    v_cvt_pk_bf16_f32 v83, v38, v39
    v_exp_f32 v41, v41
    v_exp_f32 v42, v42
    v_cvt_pk_bf16_f32 v84, v40, v41
    v_exp_f32 v43, v43
    v_exp_f32 v44, v44
    v_mfma_f32_32x32x16_bf16 v[64:79], v[104:107], v[80:83], v[64:79]
    v_cvt_pk_bf16_f32 v85, v42, v43
    v_exp_f32 v45, v45
    v_exp_f32 v46, v46
    v_exp_f32 v47, v47
    v_cvt_pk_bf16_f32 v86, v44, v45
    v_cvt_pk_bf16_f32 v87, v46, v47
    s_waitcnt lgkmcnt(0)
    v_mfma_f32_32x32x16_bf16 v[32:47], v[88:91], v[8:11], v[16:31]
    ds_read2st64_b64 v[96:99], v120 offset0:35 offset1:36
    ds_read_b64 v[100:101], v123 offset:17920
    ds_read_b128 v[104:107], v126 offset:16640
    ds_read_b128 v[108:111], v126 offset:17280
    v_exp_f32 v48, v48
    v_exp_f32 v49, v49
    v_exp_f32 v50, v50
    v_cvt_pk_bf16_f32 v80, v48, v49
    v_exp_f32 v51, v51
    v_exp_f32 v52, v52
    v_mfma_f32_32x32x16_bf16 v[64:79], v[116:119], v[84:87], v[64:79]
    v_cvt_pk_bf16_f32 v81, v50, v51
    v_exp_f32 v53, v53
    v_exp_f32 v54, v54
    v_cvt_pk_bf16_f32 v82, v52, v53
    v_exp_f32 v55, v55
    v_exp_f32 v56, v56
    v_mfma_f32_32x32x8bf16_1k v[32:47], v[92:93], v[12:13], v[32:47]
    v_cvt_pk_bf16_f32 v83, v54, v55
    v_exp_f32 v57, v57
    v_exp_f32 v58, v58
    v_cvt_pk_bf16_f32 v84, v56, v57
    v_exp_f32 v59, v59
    v_exp_f32 v60, v60
    v_mfma_f32_32x32x16_bf16 v[64:79], v[112:115], v[80:83], v[64:79]
    v_cvt_pk_bf16_f32 v85, v58, v59
    v_exp_f32 v61, v61
    v_exp_f32 v62, v62
    v_exp_f32 v63, v63
    v_cvt_pk_bf16_f32 v86, v60, v61
    v_cvt_pk_bf16_f32 v87, v62, v63
    s_waitcnt lgkmcnt(0)
    v_mfma_f32_32x32x16_bf16 v[48:63], v[96:99], v[8:11], v[16:31]
    ds_read2st64_b64 v[88:91], v120 offset0:40 offset1:41
    ds_read_b64 v[92:93], v123 offset:20480
    ds_read_b128 v[112:115], v126 offset:19200
    ds_read_b128 v[116:119], v126 offset:19840
    v_exp_f32 v32, v32
    v_exp_f32 v33, v33
    v_exp_f32 v34, v34
    v_cvt_pk_bf16_f32 v80, v32, v33
    v_exp_f32 v35, v35
    v_exp_f32 v36, v36
    v_mfma_f32_32x32x16_bf16 v[64:79], v[132:135], v[84:87], v[64:79]
    v_cvt_pk_bf16_f32 v81, v34, v35
    v_exp_f32 v37, v37
    v_exp_f32 v38, v38
    v_cvt_pk_bf16_f32 v82, v36, v37
    v_exp_f32 v39, v39
    v_exp_f32 v40, v40
    v_mfma_f32_32x32x8bf16_1k v[48:63], v[100:101], v[12:13], v[48:63]
    v_cvt_pk_bf16_f32 v83, v38, v39
    v_exp_f32 v41, v41
    v_exp_f32 v42, v42
    v_cvt_pk_bf16_f32 v84, v40, v41
    v_exp_f32 v43, v43
    v_exp_f32 v44, v44
    v_mfma_f32_32x32x16_bf16 v[64:79], v[104:107], v[80:83], v[64:79]
    v_cvt_pk_bf16_f32 v85, v42, v43
    v_exp_f32 v45, v45
    v_exp_f32 v46, v46
    v_exp_f32 v47, v47
    v_cvt_pk_bf16_f32 v86, v44, v45
    v_cvt_pk_bf16_f32 v87, v46, v47
    s_waitcnt lgkmcnt(0)
    v_mfma_f32_32x32x16_bf16 v[32:47], v[88:91], v[8:11], v[16:31]
    ds_read2st64_b64 v[96:99], v120 offset0:45 offset1:46
    ds_read_b64 v[100:101], v123 offset:23040
    ds_read_b128 v[104:107], v126 offset:21760
    ds_read_b128 v[132:135], v126 offset:22400
    v_exp_f32 v48, v48
    v_exp_f32 v49, v49
    v_exp_f32 v50, v50
    v_cvt_pk_bf16_f32 v80, v48, v49
    v_exp_f32 v51, v51
    v_exp_f32 v52, v52
    v_mfma_f32_32x32x16_bf16 v[64:79], v[108:111], v[84:87], v[64:79]
    v_cvt_pk_bf16_f32 v81, v50, v51
    v_exp_f32 v53, v53
    v_exp_f32 v54, v54
    v_cvt_pk_bf16_f32 v82, v52, v53
    v_exp_f32 v55, v55
    v_exp_f32 v56, v56
    v_mfma_f32_32x32x8bf16_1k v[32:47], v[92:93], v[12:13], v[32:47]
    v_cvt_pk_bf16_f32 v83, v54, v55
    v_exp_f32 v57, v57
    v_exp_f32 v58, v58
    v_cvt_pk_bf16_f32 v84, v56, v57
    v_exp_f32 v59, v59
    v_exp_f32 v60, v60
    v_mfma_f32_32x32x16_bf16 v[64:79], v[112:115], v[80:83], v[64:79]
    v_cvt_pk_bf16_f32 v85, v58, v59
    v_exp_f32 v61, v61
    v_exp_f32 v62, v62
    v_exp_f32 v63, v63
    v_cvt_pk_bf16_f32 v86, v60, v61
    v_cvt_pk_bf16_f32 v87, v62, v63
    s_waitcnt lgkmcnt(0)
    v_mfma_f32_32x32x16_bf16 v[48:63], v[96:99], v[8:11], v[16:31]
    ds_read2st64_b64 v[88:91], v120 offset0:50 offset1:51
    ds_read_b64 v[92:93], v123 offset:25600
    ds_read_b128 v[112:115], v126 offset:24320
    ds_read_b128 v[108:111], v126 offset:24960
    v_exp_f32 v32, v32
    v_exp_f32 v33, v33
    v_exp_f32 v34, v34
    v_cvt_pk_bf16_f32 v80, v32, v33
    v_exp_f32 v35, v35
    v_exp_f32 v36, v36
    v_mfma_f32_32x32x16_bf16 v[64:79], v[116:119], v[84:87], v[64:79]
    v_cvt_pk_bf16_f32 v81, v34, v35
    v_exp_f32 v37, v37
    v_exp_f32 v38, v38
    v_cvt_pk_bf16_f32 v82, v36, v37
    v_exp_f32 v39, v39
    v_exp_f32 v40, v40
    v_mfma_f32_32x32x8bf16_1k v[48:63], v[100:101], v[12:13], v[48:63]
    v_cvt_pk_bf16_f32 v83, v38, v39
    v_exp_f32 v41, v41
    v_exp_f32 v42, v42
    v_cvt_pk_bf16_f32 v84, v40, v41
    v_exp_f32 v43, v43
    v_exp_f32 v44, v44
    v_mfma_f32_32x32x16_bf16 v[64:79], v[104:107], v[80:83], v[64:79]
    v_cvt_pk_bf16_f32 v85, v42, v43
    v_exp_f32 v45, v45
    v_exp_f32 v46, v46
    v_exp_f32 v47, v47
    v_cvt_pk_bf16_f32 v86, v44, v45
    v_cvt_pk_bf16_f32 v87, v46, v47
    s_waitcnt lgkmcnt(0)
    v_mfma_f32_32x32x16_bf16 v[32:47], v[88:91], v[8:11], v[16:31]
    ds_read2st64_b64 v[96:99], v120 offset0:55 offset1:56
    ds_read_b64 v[100:101], v123 offset:28160
    ds_read_b128 v[104:107], v126 offset:26880
    ds_read_b128 v[116:119], v126 offset:27520
    v_exp_f32 v48, v48
    v_exp_f32 v49, v49
    v_exp_f32 v50, v50
    v_cvt_pk_bf16_f32 v80, v48, v49
    v_exp_f32 v51, v51
    v_exp_f32 v52, v52
    v_mfma_f32_32x32x16_bf16 v[64:79], v[132:135], v[84:87], v[64:79]
    v_cvt_pk_bf16_f32 v81, v50, v51
    v_exp_f32 v53, v53
    v_exp_f32 v54, v54
    v_cvt_pk_bf16_f32 v82, v52, v53
    v_exp_f32 v55, v55
    v_exp_f32 v56, v56
    v_mfma_f32_32x32x8bf16_1k v[32:47], v[92:93], v[12:13], v[32:47]
    v_cvt_pk_bf16_f32 v83, v54, v55
    v_exp_f32 v57, v57
    v_exp_f32 v58, v58
    v_cvt_pk_bf16_f32 v84, v56, v57
    v_exp_f32 v59, v59
    v_exp_f32 v60, v60
    v_mfma_f32_32x32x16_bf16 v[64:79], v[112:115], v[80:83], v[64:79]
    v_cvt_pk_bf16_f32 v85, v58, v59
    v_exp_f32 v61, v61
    v_exp_f32 v62, v62
    v_exp_f32 v63, v63
    v_cvt_pk_bf16_f32 v86, v60, v61
    v_cvt_pk_bf16_f32 v87, v62, v63
    s_waitcnt lgkmcnt(0)
    v_mfma_f32_32x32x16_bf16 v[48:63], v[96:99], v[8:11], v[16:31]
    ds_read2st64_b64 v[88:91], v120 offset0:60 offset1:61
    ds_read_b64 v[92:93], v123 offset:30720
    ds_read_b128 v[112:115], v126 offset:29440
    ds_read_b128 v[132:135], v126 offset:30080
    v_exp_f32 v32, v32
    v_exp_f32 v33, v33
    v_exp_f32 v34, v34
    v_cvt_pk_bf16_f32 v80, v32, v33
    v_exp_f32 v35, v35
    v_exp_f32 v36, v36
    v_mfma_f32_32x32x16_bf16 v[64:79], v[108:111], v[84:87], v[64:79]
    v_cvt_pk_bf16_f32 v81, v34, v35
    v_exp_f32 v37, v37
    v_exp_f32 v38, v38
    v_cvt_pk_bf16_f32 v82, v36, v37
    v_exp_f32 v39, v39
    v_exp_f32 v40, v40
    v_mfma_f32_32x32x8bf16_1k v[48:63], v[100:101], v[12:13], v[48:63]
    v_cvt_pk_bf16_f32 v83, v38, v39
    v_exp_f32 v41, v41
    v_exp_f32 v42, v42
    v_cvt_pk_bf16_f32 v84, v40, v41
    v_exp_f32 v43, v43
    v_exp_f32 v44, v44
    v_mfma_f32_32x32x16_bf16 v[64:79], v[104:107], v[80:83], v[64:79]
    v_cvt_pk_bf16_f32 v85, v42, v43
    v_exp_f32 v45, v45
    v_exp_f32 v46, v46
    v_exp_f32 v47, v47
    v_cvt_pk_bf16_f32 v86, v44, v45
    v_cvt_pk_bf16_f32 v87, v46, v47
    s_waitcnt lgkmcnt(0)
    v_mfma_f32_32x32x16_bf16 v[32:47], v[88:91], v[8:11], v[16:31]
    ds_read2st64_b64 v[96:99], v120 offset0:65 offset1:66
    ds_read_b64 v[100:101], v123 offset:33280
    ds_read_b128 v[104:107], v126 offset:32000
    ds_read_b128 v[108:111], v126 offset:32640
    v_exp_f32 v48, v48
    v_exp_f32 v49, v49
    v_exp_f32 v50, v50
    v_cvt_pk_bf16_f32 v80, v48, v49
    v_exp_f32 v51, v51
    v_exp_f32 v52, v52
    v_mfma_f32_32x32x16_bf16 v[64:79], v[116:119], v[84:87], v[64:79]
    v_cvt_pk_bf16_f32 v81, v50, v51
    v_exp_f32 v53, v53
    v_exp_f32 v54, v54
    v_cvt_pk_bf16_f32 v82, v52, v53
    v_exp_f32 v55, v55
    v_exp_f32 v56, v56
    v_mfma_f32_32x32x8bf16_1k v[32:47], v[92:93], v[12:13], v[32:47]
    v_cvt_pk_bf16_f32 v83, v54, v55
    v_exp_f32 v57, v57
    v_exp_f32 v58, v58
    v_cvt_pk_bf16_f32 v84, v56, v57
    v_exp_f32 v59, v59
    v_exp_f32 v60, v60
    v_mfma_f32_32x32x16_bf16 v[64:79], v[112:115], v[80:83], v[64:79]
    v_cvt_pk_bf16_f32 v85, v58, v59
    v_exp_f32 v61, v61
    v_exp_f32 v62, v62
    v_exp_f32 v63, v63
    v_cvt_pk_bf16_f32 v86, v60, v61
    v_cvt_pk_bf16_f32 v87, v62, v63
    s_waitcnt lgkmcnt(0)
    v_mfma_f32_32x32x16_bf16 v[48:63], v[96:99], v[8:11], v[16:31]
    ds_read2st64_b64 v[88:91], v120 offset0:70 offset1:71
    ds_read_b64 v[92:93], v123 offset:35840
    ds_read_b128 v[112:115], v126 offset:34560
    ds_read_b128 v[116:119], v126 offset:35200
    v_exp_f32 v32, v32
    v_exp_f32 v33, v33
    v_exp_f32 v34, v34
    v_cvt_pk_bf16_f32 v80, v32, v33
    v_exp_f32 v35, v35
    v_exp_f32 v36, v36
    v_mfma_f32_32x32x16_bf16 v[64:79], v[132:135], v[84:87], v[64:79]
    v_cvt_pk_bf16_f32 v81, v34, v35
    v_exp_f32 v37, v37
    v_exp_f32 v38, v38
    v_cvt_pk_bf16_f32 v82, v36, v37
    v_exp_f32 v39, v39
    v_exp_f32 v40, v40
    v_mfma_f32_32x32x8bf16_1k v[48:63], v[100:101], v[12:13], v[48:63]
    v_cvt_pk_bf16_f32 v83, v38, v39
    v_exp_f32 v41, v41
    v_exp_f32 v42, v42
    v_cvt_pk_bf16_f32 v84, v40, v41
    v_exp_f32 v43, v43
    v_exp_f32 v44, v44
    v_mfma_f32_32x32x16_bf16 v[64:79], v[104:107], v[80:83], v[64:79]
    v_cvt_pk_bf16_f32 v85, v42, v43
    v_exp_f32 v45, v45
    v_exp_f32 v46, v46
    v_exp_f32 v47, v47
    v_cvt_pk_bf16_f32 v86, v44, v45
    v_cvt_pk_bf16_f32 v87, v46, v47
    s_waitcnt lgkmcnt(0)
    v_mfma_f32_32x32x16_bf16 v[32:47], v[88:91], v[8:11], v[16:31]
    ds_read2st64_b64 v[96:99], v120 offset0:75 offset1:76
    ds_read_b64 v[100:101], v123 offset:38400
    ds_read_b128 v[104:107], v126 offset:37120
    ds_read_b128 v[132:135], v126 offset:37760
    v_exp_f32 v48, v48
    v_exp_f32 v49, v49
    v_exp_f32 v50, v50
    v_cvt_pk_bf16_f32 v80, v48, v49
    v_exp_f32 v51, v51
    v_exp_f32 v52, v52
    v_mfma_f32_32x32x16_bf16 v[64:79], v[108:111], v[84:87], v[64:79]
    v_cvt_pk_bf16_f32 v81, v50, v51
    v_exp_f32 v53, v53
    v_exp_f32 v54, v54
    v_cvt_pk_bf16_f32 v82, v52, v53
    v_exp_f32 v55, v55
    v_exp_f32 v56, v56
    v_mfma_f32_32x32x8bf16_1k v[32:47], v[92:93], v[12:13], v[32:47]
    v_cvt_pk_bf16_f32 v83, v54, v55
    v_exp_f32 v57, v57
    v_exp_f32 v58, v58
    v_cvt_pk_bf16_f32 v84, v56, v57
    v_exp_f32 v59, v59
    v_exp_f32 v60, v60
    v_mfma_f32_32x32x16_bf16 v[64:79], v[112:115], v[80:83], v[64:79]
    v_cvt_pk_bf16_f32 v85, v58, v59
    v_exp_f32 v61, v61
    v_exp_f32 v62, v62
    v_exp_f32 v63, v63
    v_cvt_pk_bf16_f32 v86, v60, v61
    v_cvt_pk_bf16_f32 v87, v62, v63
    s_waitcnt lgkmcnt(0)
    v_mfma_f32_32x32x16_bf16 v[48:63], v[96:99], v[8:11], v[16:31]
    s_nop 1
    ds_read_b128 v[112:115], v126 offset:39680
    ds_read_b128 v[108:111], v126 offset:40320
    v_exp_f32 v32, v32
    v_exp_f32 v33, v33
    v_exp_f32 v34, v34
    v_cvt_pk_bf16_f32 v80, v32, v33
    v_exp_f32 v35, v35
    v_exp_f32 v36, v36
    v_mfma_f32_32x32x16_bf16 v[64:79], v[116:119], v[84:87], v[64:79]
    v_cvt_pk_bf16_f32 v81, v34, v35
    v_exp_f32 v37, v37
    v_exp_f32 v38, v38
    v_cvt_pk_bf16_f32 v82, v36, v37
    v_exp_f32 v39, v39
    v_exp_f32 v40, v40
    v_mfma_f32_32x32x8bf16_1k v[48:63], v[100:101], v[12:13], v[48:63]
    v_cvt_pk_bf16_f32 v83, v38, v39
    v_exp_f32 v41, v41
    v_exp_f32 v42, v42
    v_cvt_pk_bf16_f32 v84, v40, v41
    v_exp_f32 v43, v43
    v_exp_f32 v44, v44
    v_mfma_f32_32x32x16_bf16 v[64:79], v[104:107], v[80:83], v[64:79]
    v_cvt_pk_bf16_f32 v85, v42, v43
    v_exp_f32 v45, v45
    v_exp_f32 v46, v46
    v_exp_f32 v47, v47
    v_cvt_pk_bf16_f32 v86, v44, v45
    v_cvt_pk_bf16_f32 v87, v46, v47
    s_waitcnt lgkmcnt(0)
    s_nop 1
    v_exp_f32 v48, v48
    v_exp_f32 v49, v49
    v_exp_f32 v50, v50
    v_cvt_pk_bf16_f32 v80, v48, v49
    v_exp_f32 v51, v51
    v_exp_f32 v52, v52
    v_mfma_f32_32x32x16_bf16 v[64:79], v[132:135], v[84:87], v[64:79]
    v_cvt_pk_bf16_f32 v81, v50, v51
    v_exp_f32 v53, v53
    v_exp_f32 v54, v54
    v_cvt_pk_bf16_f32 v82, v52, v53
    v_exp_f32 v55, v55
    v_exp_f32 v56, v56
    v_cvt_pk_bf16_f32 v83, v54, v55
    v_exp_f32 v57, v57
    v_exp_f32 v58, v58
    v_cvt_pk_bf16_f32 v84, v56, v57
    v_exp_f32 v59, v59
    v_exp_f32 v60, v60
    v_mfma_f32_32x32x16_bf16 v[64:79], v[112:115], v[80:83], v[64:79]
    v_cvt_pk_bf16_f32 v85, v58, v59
    v_exp_f32 v61, v61
    v_exp_f32 v62, v62
    v_exp_f32 v63, v63
    v_cvt_pk_bf16_f32 v86, v60, v61
    v_cvt_pk_bf16_f32 v87, v62, v63
    s_waitcnt lgkmcnt(0)
    s_nop 0
    v_mfma_f32_32x32x16_bf16 v[64:79], v[108:111], v[84:87], v[64:79]
    s_nop 11
    v_max3_f32 v14, abs(v64), abs(v65), abs(v66)
    v_max3_f32 v14, v14, abs(v67), abs(v68)
    v_max3_f32 v14, v14, abs(v69), abs(v70)
    v_max3_f32 v14, v14, abs(v71), abs(v72)
    v_max3_f32 v14, v14, abs(v73), abs(v74)
    v_max_f32 v14, v14, abs(v75)
    v_mov_b32 v15, 0x5d800000
    v_cmp_nlt_f32 vcc, v76, v15
    v_mov_b32 v15, 0x7b800000
    v_cmp_nlt_f32 s[80:81], v14, v15
    s_nop 1
    s_or_b64 vcc, vcc, s[80:81]
    s_cbranch_vccnz P2_slow_51
P2_epi_52:
    v_rcp_f32 v14, v76
    s_mul_i32 s74, s69, 40960
    s_mul_i32 s75, s68, 5
    v_mul_f32 v64, v64, v14
    v_mul_f32 v65, v65, v14
    v_mul_f32 v66, v66, v14
    v_mul_f32 v67, v67, v14
    v_mul_f32 v68, v68, v14
    v_mul_f32 v69, v69, v14
    v_mul_f32 v70, v70, v14
    v_mul_f32 v71, v71, v14
    v_mul_f32 v72, v72, v14
    v_mul_f32 v73, v73, v14
    v_mul_f32 v74, v74, v14
    v_mul_f32 v75, v75, v14
    v_cvt_pk_bf16_f32 v80, v64, v65
    v_cvt_pk_bf16_f32 v81, v66, v67
    v_cvt_pk_bf16_f32 v82, v68, v69
    v_cvt_pk_bf16_f32 v83, v70, v71
    v_cvt_pk_bf16_f32 v84, v72, v73
    v_cvt_pk_bf16_f32 v85, v74, v75
    v_add_u32 v6, s75, v3
    v_lshlrev_b32 v6, 8, v6
    v_lshl_add_u32 v6, v2, 3, v6
    buffer_store_dwordx2 v[80:81], v6, s[52:55], s74 offen offset:0 sc1
    buffer_store_dwordx2 v[82:83], v6, s[52:55], s74 offen offset:512 sc1
    s_mov_b32 exec_lo, -1
    s_mov_b32 exec_hi, 0
    buffer_store_dwordx2 v[84:85], v6, s[52:55], s74 offen offset:1024 sc1
    s_mov_b64 exec, -1
    s_branch P2_fin_53
P2_slow_51:
    v_mov_b32 v15, 0xff800000
    s_mov_b32 s78, 0
P2_max_54:
    s_add_u32 s79, s77, s78
    buffer_load_dwordx2 v[88:89], v129, s[48:51], s79 offen sc1
    buffer_load_dwordx2 v[90:91], v129, s[48:51], s79 offen offset:512 sc1
    buffer_load_dwordx2 v[92:93], v4, s[48:51], s79 offen sc1
    s_waitcnt vmcnt(0)
    v_mfma_f32_32x32x16_bf16 v[32:47], v[88:91], v[8:11], 0
    v_mfma_f32_32x32x8bf16_1k v[32:47], v[92:93], v[12:13], v[32:47]
    s_nop 11
    v_max3_f32 v15, v15, v32, v33
    v_max_f32 v15, v15, v34
    v_max3_f32 v15, v15, v35, v36
    v_max3_f32 v15, v15, v37, v38
    v_max3_f32 v15, v15, v39, v40
    v_max3_f32 v15, v15, v41, v42
    v_max3_f32 v15, v15, v43, v44
    v_max3_f32 v15, v15, v45, v46
    v_max_f32 v15, v15, v47
    s_add_u32 s78, s78, 2560
    s_cmp_lt_u32 s78, 163840
    s_cbranch_scc1 P2_max_54
    v_mov_b32 v14, v15
    s_nop 1
    v_permlane32_swap_b32 v15, v14
    s_nop 1
    v_max_f32 v15, v15, v14
    v_sub_f32 v16, 0, v15
    v_sub_f32 v17, 0, v15
    v_sub_f32 v18, 0, v15
    v_sub_f32 v19, 0, v15
    v_sub_f32 v20, 0, v15
    v_sub_f32 v21, 0, v15
    v_sub_f32 v22, 0, v15
    v_sub_f32 v23, 0, v15
    v_sub_f32 v24, 0, v15
    v_sub_f32 v25, 0, v15
    v_sub_f32 v26, 0, v15
    v_sub_f32 v27, 0, v15
    v_sub_f32 v28, 0, v15
    v_sub_f32 v29, 0, v15
    v_sub_f32 v30, 0, v15
    v_sub_f32 v31, 0, v15
    v_mov_b32 v64, 0
    v_mov_b32 v65, 0
    v_mov_b32 v66, 0
    v_mov_b32 v67, 0
    v_mov_b32 v68, 0
    v_mov_b32 v69, 0
    v_mov_b32 v70, 0
    v_mov_b32 v71, 0
    v_mov_b32 v72, 0
    v_mov_b32 v73, 0
    v_mov_b32 v74, 0
    v_mov_b32 v75, 0
    v_mov_b32 v76, 0
    v_mov_b32 v77, 0
    v_mov_b32 v78, 0
    v_mov_b32 v79, 0
    v_mul_u32_u24 v6, 320, v3
    v_lshl_add_u32 v6, v2, 4, v6
    v_mov_b32 v104, 0x3f803f80
    v_mov_b32 v108, 0x3f803f80
    v_mov_b32 v105, 0x3f803f80
    v_mov_b32 v109, 0x3f803f80
    v_mov_b32 v106, 0x3f803f80
    v_mov_b32 v110, 0x3f803f80
    v_mov_b32 v107, 0x3f803f80
    v_mov_b32 v111, 0x3f803f80
    v_cmp_gt_u32 s[82:83], 20, v2
    s_mov_b32 s78, 0
P2_pv_55:
    s_add_u32 s79, s77, s78
    buffer_load_dwordx2 v[88:89], v129, s[48:51], s79 offen sc1
    buffer_load_dwordx2 v[90:91], v129, s[48:51], s79 offen offset:512 sc1
    buffer_load_dwordx2 v[92:93], v4, s[48:51], s79 offen sc1
    s_mov_b64 exec, s[82:83]
    buffer_load_dwordx4 v[104:107], v6, s[48:51], s79 offen offset:1280 sc1
    buffer_load_dwordx4 v[108:111], v6, s[48:51], s79 offen offset:1920 sc1
    s_mov_b64 exec, -1
    s_waitcnt vmcnt(0)
    v_mfma_f32_32x32x16_bf16 v[32:47], v[88:91], v[8:11], v[16:31]
    v_mfma_f32_32x32x8bf16_1k v[32:47], v[92:93], v[12:13], v[32:47]
    s_nop 11
    v_exp_f32 v32, v32
    v_exp_f32 v33, v33
    v_exp_f32 v34, v34
    v_exp_f32 v35, v35
    v_exp_f32 v36, v36
    v_exp_f32 v37, v37
    v_exp_f32 v38, v38
    v_exp_f32 v39, v39
    v_exp_f32 v40, v40
    v_exp_f32 v41, v41
    v_exp_f32 v42, v42
    v_exp_f32 v43, v43
    v_exp_f32 v44, v44
    v_exp_f32 v45, v45
    v_exp_f32 v46, v46
    v_exp_f32 v47, v47
    s_nop 0
    v_cvt_pk_bf16_f32 v80, v32, v33
    v_cvt_pk_bf16_f32 v81, v34, v35
    v_cvt_pk_bf16_f32 v82, v36, v37
    v_cvt_pk_bf16_f32 v83, v38, v39
    v_cvt_pk_bf16_f32 v84, v40, v41
    v_cvt_pk_bf16_f32 v85, v42, v43
    v_cvt_pk_bf16_f32 v86, v44, v45
    v_cvt_pk_bf16_f32 v87, v46, v47
    s_nop 1
    v_mfma_f32_32x32x16_bf16 v[64:79], v[104:107], v[80:83], v[64:79]
    v_mfma_f32_32x32x16_bf16 v[64:79], v[108:111], v[84:87], v[64:79]
    s_add_u32 s78, s78, 2560
    s_cmp_lt_u32 s78, 163840
    s_cbranch_scc1 P2_pv_55
    s_nop 11
    s_branch P2_epi_52
P2_fin_53:
    s_and_b32 s71, s2, 7
    s_lshr_b32 s72, s71, 1
    s_lshl_b32 s72, s72, 2
    s_lshr_b32 s74, s2, 6
    s_add_u32 s72, s72, s74
    s_lshr_b32 s71, s71, 2
    s_lshl_b32 s71, s71, 2
    s_add_u32 s71, s71, s74
    s_mov_b32 s75, s72
    s_mul_i32 s72, s72, 80
    v_add_u32 v240, s72, v0
    v_min_u32 v241, 15, v0
    v_add_u32 v241, 64, v241
    v_add_u32 v241, s72, v241
    s_mul_i32 s74, s71, 48
    v_min_u32 v243, 47, v0
    v_add_u32 v243, s74, v243
    s_mul_i32 s74, s71, 20
    s_add_u32 s74, s74, 128
    v_min_u32 v242, 19, v0
    v_add_u32 v242, s74, v242
    v_and_b32 v240, 255, v240
    v_and_b32 v241, 255, v241
    v_and_b32 v242, 255, v242
    v_and_b32 v243, 255, v243
    s_cmp_lg_u32 s40, 1
    s_cbranch_scc1 tt_58
    s_cmp_lg_u32 s40, 1
    s_cbranch_scc1 wf_59
    s_cmp_lg_u32 s42, 0
    s_cbranch_scc1 wf_59
    v_lshlrev_b32 v240, 6, v240
    v_add_u32 v240, 81984, v240
    v_lshlrev_b32 v241, 6, v241
    v_add_u32 v241, 81984, v241
    v_lshlrev_b32 v242, 6, v242
    v_add_u32 v242, 81984, v242
    s_mov_b32 s94, 30000
wf_poll_60:
    buffer_load_dword v250, v240, s[96:99], 0 offen sc1
    buffer_load_dword v251, v241, s[96:99], 0 offen sc1
    buffer_load_dword v252, v242, s[96:99], 0 offen sc1
    s_waitcnt vmcnt(0)
    v_cmp_ne_u32 vcc, s41, v250
    v_cmp_ne_u32 s[92:93], s41, v251
    s_nop 1
    s_or_b64 vcc, vcc, s[92:93]
    v_cmp_ne_u32 s[92:93], s41, v252
    s_nop 1
    s_or_b64 vcc, vcc, s[92:93]
    s_nop 1
    s_cbranch_vccz wf_59
    s_sleep 1
    s_sub_u32 s94, s94, 1
    s_cmp_lg_u32 s94, 0
    s_cbranch_scc1 wf_poll_60
wf_done_61:
    s_mov_b32 s42, 1
wf_59:
    s_branch tt_bar_57
tt_58:
    s_cmp_lg_u32 s40, 2
    s_cbranch_scc1 tt_62
    s_cmp_lg_u32 s40, 2
    s_cbranch_scc1 wf_63
    s_cmp_lg_u32 s42, 0
    s_cbranch_scc1 wf_63
    v_lshlrev_b32 v243, 6, v243
    v_add_u32 v243, 81984, v243
    s_mov_b32 s94, 30000
wf_poll_64:
    buffer_load_dword v250, v243, s[96:99], 0 offen sc1
    s_waitcnt vmcnt(0)
    v_cmp_ne_u32 vcc, s41, v250
    s_nop 1
    s_cbranch_vccz wf_63
    s_sleep 1
    s_sub_u32 s94, s94, 1
    s_cmp_lg_u32 s94, 0
    s_cbranch_scc1 wf_poll_64
wf_done_65:
    s_mov_b32 s42, 1
wf_63:
    s_mul_i32 s84, s71, 245760
    s_lshr_b32 s85, s2, 3
    s_and_b32 s85, s85, 7
    s_mul_i32 s85, s85, 30720
    s_add_u32 s84, s84, s85
    s_add_u32 s84, s84, 0
    s_add_u32 s88, s38, 0x2c00000
    s_addc_u32 s89, s39, 0
    s_mov_b32 s90, 0x1e0000
    s_mov_b32 s91, 0x20000
    v_min_u32 v30, 59, v0
    v_lshlrev_b32 v30, 7, v30
    buffer_load_dword v31, v30, s[88:91], s84 offen
    s_add_u32 s84, s84, 7680
    s_branch tt_bar_57
tt_62:
    s_cmp_lg_u32 s40, 3
    s_cbranch_scc1 tt_66
    s_cmp_lg_u32 s40, 3
    s_cbranch_scc1 wf_67
    s_cmp_lg_u32 s42, 0
    s_cbranch_scc1 wf_67
    v_lshlrev_b32 v243, 6, v243
    v_add_u32 v243, 81984, v243
    s_mov_b32 s94, 30000
wf_poll_68:
    buffer_load_dword v250, v243, s[96:99], 0 offen sc1
    s_waitcnt vmcnt(0)
    v_cmp_ne_u32 vcc, s41, v250
    s_nop 1
    s_cbranch_vccz wf_67
    s_sleep 1
    s_sub_u32 s94, s94, 1
    s_cmp_lg_u32 s94, 0
    s_cbranch_scc1 wf_poll_68
wf_done_69:
    s_mov_b32 s42, 1
wf_67:
    s_mul_i32 s84, s71, 245760
    s_lshr_b32 s85, s2, 3
    s_and_b32 s85, s85, 7
    s_mul_i32 s85, s85, 30720
    s_add_u32 s84, s84, s85
    s_add_u32 s84, s84, 15360
    s_add_u32 s88, s38, 0x2c00000
    s_addc_u32 s89, s39, 0
    s_mov_b32 s90, 0x1e0000
    s_mov_b32 s91, 0x20000
    v_min_u32 v30, 59, v0
    v_lshlrev_b32 v30, 7, v30
    buffer_load_dword v31, v30, s[88:91], s84 offen
    s_add_u32 s84, s84, 7680
    s_branch tt_bar_57
tt_66:
tt_drain_56:
    s_waitcnt vmcnt(0)
tt_bar_57:
    s_barrier
    s_lshr_b32 s71, s69, 3
    s_lshl_b32 s71, s71, 5
    s_add_u32 s71, s71, s68
    s_cmp_lg_u32 s40, 0
    s_cbranch_scc1 sig_70
    s_lshl_b32 s94, s71, 6
    s_add_u32 s94, s94, 32832
    v_mov_b32 v250, s41
    v_mov_b32 v251, 0
    s_mov_b64 exec, 1
    buffer_store_dword v250, v251, s[96:99], s94 offen sc1
    s_mov_b64 exec, -1
sig_70:
    s_and_b32 s71, s2, 7
    s_lshr_b32 s72, s2, 3
    s_and_b32 s73, s71, 3
    s_lshl_b32 s73, s73, 3
    s_and_b32 s74, s72, 7
    s_add_u32 s68, s73, s74
    s_lshr_b32 s73, s71, 2
    s_lshl_b32 s73, s73, 2
    s_lshr_b32 s74, s72, 3
    s_add_u32 s69, s73, s74
    s_add_u32 s44, s38, 0x1800000
    s_addc_u32 s45, s39, 0
    s_mov_b32 s46, 0xc8000
    s_mov_b32 s47, 0x20000
    s_add_u32 s48, s38, 0x1400000
    s_addc_u32 s49, s39, 0
    s_mov_b32 s50, 0x280000
    s_mov_b32 s51, 0x20000
    s_add_u32 s52, s38, 0x80000
    s_addc_u32 s53, s39, 0
    s_mov_b32 s54, 0x20000
    s_mov_b32 s55, 0x20000
    s_mov_b32 s60, s16
    s_mov_b32 s61, s17
    s_mov_b32 s62, 0x280000
    s_mov_b32 s63, 0x20000
    v_lshlrev_b32 v1, 4, v0
    v_and_b32 v2, 31, v0
    v_lshrrev_b32 v3, 5, v0
    s_cmp_lt_u32 s40, 4
    s_cbranch_scc1 P3_comp_71
    s_sub_u32 s70, s40, 4
    s_lshl_b32 s72, s70, 10
    v_add_u32 v7, s72, v1
    s_mul_i32 s77, s70, 5120
    v_add_u32 v8, 0, v0
    v_mul_u32_u24 v9, 104858, v8
    v_lshrrev_b32 v9, 20, v9
    v_mul_u32_u24 v10, 10, v9
    v_sub_u32 v10, v8, v10
    v_mul_u32_u24 v9, 1280, v9
    v_lshl_add_u32 v16, v10, 4, v9
    v_add_u32 v8, 64, v0
    v_mul_u32_u24 v9, 104858, v8
    v_lshrrev_b32 v9, 20, v9
    v_mul_u32_u24 v10, 10, v9
    v_sub_u32 v10, v8, v10
    v_mul_u32_u24 v9, 1280, v9
    v_lshl_add_u32 v17, v10, 4, v9
    v_add_u32 v8, 128, v0
    v_mul_u32_u24 v9, 104858, v8
    v_lshrrev_b32 v9, 20, v9
    v_mul_u32_u24 v10, 10, v9
    v_sub_u32 v10, v8, v10
    v_mul_u32_u24 v9, 1280, v9
    v_lshl_add_u32 v18, v10, 4, v9
    v_add_u32 v8, 192, v0
    v_mul_u32_u24 v9, 104858, v8
    v_lshrrev_b32 v9, 20, v9
    v_mul_u32_u24 v10, 10, v9
    v_sub_u32 v10, v8, v10
    v_mul_u32_u24 v9, 1280, v9
    v_lshl_add_u32 v19, v10, 4, v9
    v_add_u32 v8, 256, v0
    v_mul_u32_u24 v9, 104858, v8
    v_lshrrev_b32 v9, 20, v9
    v_mul_u32_u24 v10, 10, v9
    v_sub_u32 v10, v8, v10
    v_mul_u32_u24 v9, 1280, v9
    v_lshl_add_u32 v20, v10, 4, v9
    s_mul_i32 s73, s69, 102400
    s_add_u32 s73, s73, s77
    s_lshl_b32 s74, s68, 1
    s_mul_i32 s74, s74, 40960
    s_add_u32 m0, s77, 0
    s_add_u32 s75, s73, 0
    buffer_load_dwordx4 v1, s[44:47], s75 offen sc1 lds
    s_add_u32 m0, s77, 1024
    s_add_u32 s75, s73, 1024
    buffer_load_dwordx4 v1, s[44:47], s75 offen sc1 lds
    s_add_u32 m0, s77, 2048
    s_add_u32 s75, s73, 2048
    buffer_load_dwordx4 v1, s[44:47], s75 offen sc1 lds
    s_add_u32 m0, s77, 3072
    s_add_u32 s75, s73, 3072
    buffer_load_dwordx4 v1, s[44:47], s75 offen sc1 lds
    s_add_u32 m0, s77, 4096
    s_add_u32 s75, s73, 4096
    buffer_load_dwordx4 v1, s[44:47], s75 offen sc1 lds
    s_add_u32 m0, s77, 20480
    s_add_u32 s75, s73, 20480
    buffer_load_dwordx4 v1, s[44:47], s75 offen sc1 lds
    s_add_u32 m0, s77, 21504
    s_add_u32 s75, s73, 21504
    buffer_load_dwordx4 v1, s[44:47], s75 offen sc1 lds
    s_add_u32 m0, s77, 22528
    s_add_u32 s75, s73, 22528
    buffer_load_dwordx4 v1, s[44:47], s75 offen sc1 lds
    s_add_u32 m0, s77, 23552
    s_add_u32 s75, s73, 23552
    buffer_load_dwordx4 v1, s[44:47], s75 offen sc1 lds
    s_add_u32 m0, s77, 24576
    s_add_u32 s75, s73, 24576
    buffer_load_dwordx4 v1, s[44:47], s75 offen sc1 lds
    s_add_u32 m0, s77, 40960
    s_add_u32 s75, s73, 40960
    buffer_load_dwordx4 v1, s[44:47], s75 offen sc1 lds
    s_add_u32 m0, s77, 41984
    s_add_u32 s75, s73, 41984
    buffer_load_dwordx4 v1, s[44:47], s75 offen sc1 lds
    s_add_u32 m0, s77, 43008
    s_add_u32 s75, s73, 43008
    buffer_load_dwordx4 v1, s[44:47], s75 offen sc1 lds
    s_add_u32 m0, s77, 44032
    s_add_u32 s75, s73, 44032
    buffer_load_dwordx4 v1, s[44:47], s75 offen sc1 lds
    s_add_u32 m0, s77, 45056
    s_add_u32 s75, s73, 45056
    buffer_load_dwordx4 v1, s[44:47], s75 offen sc1 lds
    s_cmp_ge_u32 s70, 2
    s_cbranch_scc1 res_74
    s_lshl_b32 s78, s68, 6
    s_lshl_b32 s79, s70, 5
    s_add_u32 s78, s78, s79
    s_mul_i32 s78, s78, 1280
    s_mul_i32 s79, s69, 160
    s_add_u32 s78, s78, s79
    s_add_u32 m0, s77, 131072
    s_nop 0
    buffer_load_dwordx4 v16, s[60:63], s78 offen lds
    s_add_u32 m0, s77, 132096
    s_nop 0
    buffer_load_dwordx4 v17, s[60:63], s78 offen lds
    s_add_u32 m0, s77, 133120
    s_nop 0
    buffer_load_dwordx4 v18, s[60:63], s78 offen lds
    s_add_u32 m0, s77, 134144
    s_nop 0
    buffer_load_dwordx4 v19, s[60:63], s78 offen lds
    s_add_u32 m0, s77, 135168
    s_nop 0
    buffer_load_dwordx4 v20, s[60:63], s78 offen lds
res_74:
    s_barrier
    s_add_u32 m0, s72, 81920
    s_add_u32 s75, s74, 0
    buffer_load_dwordx4 v7, s[48:51], s75 offen sc1 lds
    s_add_u32 m0, s72, 86016
    s_add_u32 s75, s74, 4096
    buffer_load_dwordx4 v7, s[48:51], s75 offen sc1 lds
    s_add_u32 m0, s72, 90112
    s_add_u32 s75, s74, 40960
    buffer_load_dwordx4 v7, s[48:51], s75 offen sc1 lds
    s_add_u32 m0, s72, 94208
    s_add_u32 s75, s74, 45056
    buffer_load_dwordx4 v7, s[48:51], s75 offen sc1 lds
    s_add_u32 m0, s72, 98304
    s_add_u32 s75, s74, 8192
    buffer_load_dwordx4 v7, s[48:51], s75 offen sc1 lds
    s_add_u32 m0, s72, 102400
    s_add_u32 s75, s74, 12288
    buffer_load_dwordx4 v7, s[48:51], s75 offen sc1 lds
    s_add_u32 m0, s72, 106496
    s_add_u32 s75, s74, 49152
    buffer_load_dwordx4 v7, s[48:51], s75 offen sc1 lds
    s_add_u32 m0, s72, 110592
    s_add_u32 s75, s74, 53248
    buffer_load_dwordx4 v7, s[48:51], s75 offen sc1 lds
    s_waitcnt vmcnt(4)
    s_barrier
    s_add_u32 m0, s72, 114688
    s_add_u32 s75, s74, 16384
    buffer_load_dwordx4 v7, s[48:51], s75 offen sc1 lds
    s_add_u32 m0, s72, 118784
    s_add_u32 s75, s74, 20480
    buffer_load_dwordx4 v7, s[48:51], s75 offen sc1 lds
    s_add_u32 m0, s72, 122880
    s_add_u32 s75, s74, 57344
    buffer_load_dwordx4 v7, s[48:51], s75 offen sc1 lds
    s_add_u32 m0, s72, 126976
    s_add_u32 s75, s74, 61440
    buffer_load_dwordx4 v7, s[48:51], s75 offen sc1 lds
    s_add_u32 m0, s77, 61440
    s_add_u32 s75, s73, 61440
    buffer_load_dwordx4 v1, s[44:47], s75 offen sc1 lds
    s_add_u32 m0, s77, 62464
    s_add_u32 s75, s73, 62464
    buffer_load_dwordx4 v1, s[44:47], s75 offen sc1 lds
    s_add_u32 m0, s77, 63488
    s_add_u32 s75, s73, 63488
    buffer_load_dwordx4 v1, s[44:47], s75 offen sc1 lds
    s_add_u32 m0, s77, 64512
    s_add_u32 s75, s73, 64512
    buffer_load_dwordx4 v1, s[44:47], s75 offen sc1 lds
    s_add_u32 m0, s77, 65536
    s_add_u32 s75, s73, 65536
    buffer_load_dwordx4 v1, s[44:47], s75 offen sc1 lds
    s_waitcnt vmcnt(9)
    s_barrier
    s_add_u32 m0, s72, 81920
    s_add_u32 s75, s74, 24576
    buffer_load_dwordx4 v7, s[48:51], s75 offen sc1 lds
    s_add_u32 m0, s72, 86016
    s_add_u32 s75, s74, 28672
    buffer_load_dwordx4 v7, s[48:51], s75 offen sc1 lds
    s_add_u32 m0, s72, 90112
    s_add_u32 s75, s74, 65536
    buffer_load_dwordx4 v7, s[48:51], s75 offen sc1 lds
    s_add_u32 m0, s72, 94208
    s_add_u32 s75, s74, 69632
    buffer_load_dwordx4 v7, s[48:51], s75 offen sc1 lds
    s_add_u32 m0, s77, 0
    s_add_u32 s75, s73, 81920
    buffer_load_dwordx4 v1, s[44:47], s75 offen sc1 lds
    s_add_u32 m0, s77, 1024
    s_add_u32 s75, s73, 82944
    buffer_load_dwordx4 v1, s[44:47], s75 offen sc1 lds
    s_add_u32 m0, s77, 2048
    s_add_u32 s75, s73, 83968
    buffer_load_dwordx4 v1, s[44:47], s75 offen sc1 lds
    s_add_u32 m0, s77, 3072
    s_add_u32 s75, s73, 84992
    buffer_load_dwordx4 v1, s[44:47], s75 offen sc1 lds
    s_add_u32 m0, s77, 4096
    s_add_u32 s75, s73, 86016
    buffer_load_dwordx4 v1, s[44:47], s75 offen sc1 lds
    s_waitcnt vmcnt(14)
    s_barrier
    s_add_u32 m0, s72, 98304
    s_add_u32 s75, s74, 32768
    buffer_load_dwordx4 v7, s[48:51], s75 offen sc1 lds
    s_add_u32 m0, s72, 102400
    s_add_u32 s75, s74, 36864
    buffer_load_dwordx4 v7, s[48:51], s75 offen sc1 lds
    s_add_u32 m0, s72, 106496
    s_add_u32 s75, s74, 73728
    buffer_load_dwordx4 v7, s[48:51], s75 offen sc1 lds
    s_add_u32 m0, s72, 110592
    s_add_u32 s75, s74, 77824
    buffer_load_dwordx4 v7, s[48:51], s75 offen sc1 lds
    s_waitcnt vmcnt(9)
    s_barrier
    s_waitcnt vmcnt(0)
    s_barrier
    s_cmp_lg_u32 s40, 7
    s_cbranch_scc1 cp_75
    s_getpc_b64 s[92:93]
cp_here_76:
    s_sub_u32 s92, s92, cp_here_76-adaLN_cond__mha_block__glu_gated_glu__prompt_kernel
    s_subb_u32 s93, s93, 0
    s_lshr_b32 s94, s2, 3
    s_and_b32 s94, s94, 31
    s_mul_i32 s94, s94, (L_fin-adaLN_cond__mha_block__glu_gated_glu__prompt_kernel+4095)/4096*128
    v_min_u32 v252, (L_fin-adaLN_cond__mha_block__glu_gated_glu__prompt_kernel+4095)/4096-1, v0
    v_lshlrev_b32 v252, 7, v252
    v_add_u32 v252, s94, v252
    v_min_u32 v252, L_fin-adaLN_cond__mha_block__glu_gated_glu__prompt_kernel, v252
    v_mov_b32 v253, s93
    v_add_co_u32 v252, vcc, s92, v252
    s_nop 1
    v_addc_co_u32 v253, vcc, 0, v253, vcc
    global_load_dword v254, v[252:253], off
cp_75:
    s_barrier
    s_barrier
    s_branch P3_fin_73
P3_comp_71:
    s_cmp_eq_u32 s40, 3
    s_cbranch_scc1 P3_w3_72
    s_add_u32 s56, s38, 0x1a00000
    s_addc_u32 s57, s39, 0
    s_mov_b32 s58, 0x280000
    s_mov_b32 s59, 0x20000
    s_add_u32 s64, s38, 0x1e00000
    s_addc_u32 s65, s39, 0
    s_mov_b32 s66, 0x280000
    s_mov_b32 s67, 0x20000
    v_bfe_u32 v11, v0, 2, 2
    v_bfe_u32 v12, v0, 4, 1
    v_and_b32 v13, 3, v0
    v_lshl_add_u32 v11, v3, 2, v11
    v_mul_u32_u24 v11, 160, v11
    s_cmp_eq_u32 s40, 2
    s_cselect_b32 s71, 0, 32
    v_mul_u32_u24 v12, s71, v12
    v_add_u32 v11, v11, v12
    v_lshl_add_u32 v11, v13, 3, v11
    s_lshl_b32 s71, s40, 6
    v_add_u32 v11, s71, v11
    v_mov_b32 v4, v11
    v_add_u32 v5, 65536, v11
    s_lshr_b32 s71, s68, 2
    s_lshl_b32 s71, s71, 5
    v_add_u32 v240, s71, v2
    s_cmp_lg_u32 s40, 0
    s_cbranch_scc1 wf_77
    s_cmp_lg_u32 s42, 0
    s_cbranch_scc1 wf_77
    v_lshlrev_b32 v240, 6, v240
    v_add_u32 v240, 32832, v240
    s_mov_b32 s94, 30000
wf_poll_78:
    buffer_load_dword v250, v240, s[96:99], 0 offen sc1
    s_waitcnt vmcnt(0)
    v_cmp_ne_u32 vcc, s41, v250
    s_nop 1
    s_cbranch_vccz wf_77
    s_sleep 1
    s_sub_u32 s94, s94, 1
    s_cmp_lg_u32 s94, 0
    s_cbranch_scc1 wf_poll_78
wf_done_79:
    s_mov_b32 s42, 1
wf_77:
    s_barrier
    v_lshlrev_b32 v12, 3, v2
    v_lshl_add_u32 v12, v3, 8, v12
    v_add_u32 v12, 81920, v12
    v_mov_b32 v8, v12
    v_add_u32 v9, 65536, v12
    s_barrier
    ds_read_b64_tr_b16 v[32:33], v4 offset:0
    ds_read_b64_tr_b16 v[34:35], v4 offset:1280
    ds_read_b64 v[16:17], v8 offset:0
    ds_read_b64 v[18:19], v8 offset:512
    ds_read_b64 v[20:21], v8 offset:8192
    ds_read_b64 v[22:23], v8 offset:8704
    ds_read_b64_tr_b16 v[36:37], v4 offset:2560
    ds_read_b64_tr_b16 v[38:39], v4 offset:3840
    ds_read_b64 v[24:25], v8 offset:1024
    ds_read_b64 v[26:27], v8 offset:1536
    ds_read_b64 v[28:29], v8 offset:9216
    ds_read_b64 v[30:31], v8 offset:9728
    s_waitcnt lgkmcnt(8)
    v_mfma_f32_32x32x16_bf16 v[64:79], v[32:35], v[16:19], 0
    ds_read_b64_tr_b16 v[40:41], v4 offset:5120
    ds_read_b64_tr_b16 v[42:43], v4 offset:6400
    ds_read_b64 v[16:17], v8 offset:2048
    ds_read_b64 v[18:19], v8 offset:2560
    s_waitcnt lgkmcnt(10)
    v_mfma_f32_32x32x16_bf16 v[80:95], v[32:35], v[20:23], 0
    ds_read_b64 v[20:21], v8 offset:10240
    ds_read_b64 v[22:23], v8 offset:10752
    s_waitcnt lgkmcnt(8)
    v_mfma_f32_32x32x16_bf16 v[64:79], v[36:39], v[24:27], v[64:79]
    ds_read_b64_tr_b16 v[32:33], v4 offset:7680
    ds_read_b64_tr_b16 v[34:35], v4 offset:8960
    ds_read_b64 v[24:25], v8 offset:3072
    ds_read_b64 v[26:27], v8 offset:3584
    s_waitcnt lgkmcnt(10)
    v_mfma_f32_32x32x16_bf16 v[80:95], v[36:39], v[28:31], v[80:95]
    ds_read_b64 v[28:29], v8 offset:11264
    ds_read_b64 v[30:31], v8 offset:11776
    s_waitcnt lgkmcnt(8)
    v_mfma_f32_32x32x16_bf16 v[64:79], v[40:43], v[16:19], v[64:79]
    ds_read_b64_tr_b16 v[36:37], v4 offset:10240
    ds_read_b64_tr_b16 v[38:39], v4 offset:11520
    ds_read_b64 v[16:17], v8 offset:4096
    ds_read_b64 v[18:19], v8 offset:4608
    s_waitcnt lgkmcnt(10)
    v_mfma_f32_32x32x16_bf16 v[80:95], v[40:43], v[20:23], v[80:95]
    ds_read_b64 v[20:21], v8 offset:12288
    ds_read_b64 v[22:23], v8 offset:12800
    s_waitcnt lgkmcnt(8)
    v_mfma_f32_32x32x16_bf16 v[64:79], v[32:35], v[24:27], v[64:79]
    ds_read_b64_tr_b16 v[40:41], v4 offset:12800
    ds_read_b64_tr_b16 v[42:43], v4 offset:14080
    ds_read_b64 v[24:25], v8 offset:5120
    ds_read_b64 v[26:27], v8 offset:5632
    s_waitcnt lgkmcnt(10)
    v_mfma_f32_32x32x16_bf16 v[80:95], v[32:35], v[28:31], v[80:95]
    ds_read_b64 v[28:29], v8 offset:13312
    ds_read_b64 v[30:31], v8 offset:13824
    s_waitcnt lgkmcnt(8)
    v_mfma_f32_32x32x16_bf16 v[64:79], v[36:39], v[16:19], v[64:79]
    ds_read_b64_tr_b16 v[32:33], v4 offset:15360
    ds_read_b64_tr_b16 v[34:35], v4 offset:16640
    ds_read_b64 v[16:17], v8 offset:6144
    ds_read_b64 v[18:19], v8 offset:6656
    s_waitcnt lgkmcnt(10)
    v_mfma_f32_32x32x16_bf16 v[80:95], v[36:39], v[20:23], v[80:95]
    ds_read_b64 v[20:21], v8 offset:14336
    ds_read_b64 v[22:23], v8 offset:14848
    s_waitcnt lgkmcnt(8)
    v_mfma_f32_32x32x16_bf16 v[64:79], v[40:43], v[24:27], v[64:79]
    ds_read_b64_tr_b16 v[36:37], v4 offset:17920
    ds_read_b64_tr_b16 v[38:39], v4 offset:19200
    ds_read_b64 v[24:25], v8 offset:7168
    ds_read_b64 v[26:27], v8 offset:7680
    s_waitcnt lgkmcnt(10)
    v_mfma_f32_32x32x16_bf16 v[80:95], v[40:43], v[28:31], v[80:95]
    ds_read_b64 v[28:29], v8 offset:15360
    ds_read_b64 v[30:31], v8 offset:15872
    s_waitcnt lgkmcnt(8)
    v_mfma_f32_32x32x16_bf16 v[64:79], v[32:35], v[16:19], v[64:79]
    s_waitcnt lgkmcnt(6)
    v_mfma_f32_32x32x16_bf16 v[80:95], v[32:35], v[20:23], v[80:95]
    s_waitcnt lgkmcnt(0)
    s_barrier
    ds_read_b64_tr_b16 v[40:41], v4 offset:20480
    ds_read_b64_tr_b16 v[42:43], v4 offset:21760
    ds_read_b64 v[16:17], v8 offset:16384
    ds_read_b64 v[18:19], v8 offset:16896
    ds_read_b64 v[20:21], v8 offset:24576
    ds_read_b64 v[22:23], v8 offset:25088
    v_mfma_f32_32x32x16_bf16 v[64:79], v[36:39], v[24:27], v[64:79]
    ds_read_b64_tr_b16 v[32:33], v4 offset:23040
    ds_read_b64_tr_b16 v[34:35], v4 offset:24320
    ds_read_b64 v[24:25], v8 offset:17408
    ds_read_b64 v[26:27], v8 offset:17920
    v_mfma_f32_32x32x16_bf16 v[80:95], v[36:39], v[28:31], v[80:95]
    ds_read_b64 v[28:29], v8 offset:25600
    ds_read_b64 v[30:31], v8 offset:26112
    s_waitcnt lgkmcnt(8)
    v_mfma_f32_32x32x16_bf16 v[64:79], v[40:43], v[16:19], v[64:79]
    ds_read_b64_tr_b16 v[36:37], v4 offset:25600
    ds_read_b64_tr_b16 v[38:39], v4 offset:26880
    ds_read_b64 v[16:17], v8 offset:18432
    ds_read_b64 v[18:19], v8 offset:18944
    s_waitcnt lgkmcnt(10)
    v_mfma_f32_32x32x16_bf16 v[80:95], v[40:43], v[20:23], v[80:95]
    ds_read_b64 v[20:21], v8 offset:26624
    ds_read_b64 v[22:23], v8 offset:27136
    s_waitcnt lgkmcnt(8)
    v_mfma_f32_32x32x16_bf16 v[64:79], v[32:35], v[24:27], v[64:79]
    ds_read_b64_tr_b16 v[40:41], v4 offset:28160
    ds_read_b64_tr_b16 v[42:43], v4 offset:29440
    ds_read_b64 v[24:25], v8 offset:19456
    ds_read_b64 v[26:27], v8 offset:19968
    s_waitcnt lgkmcnt(10)
    v_mfma_f32_32x32x16_bf16 v[80:95], v[32:35], v[28:31], v[80:95]
    ds_read_b64 v[28:29], v8 offset:27648
    ds_read_b64 v[30:31], v8 offset:28160
    s_waitcnt lgkmcnt(8)
    v_mfma_f32_32x32x16_bf16 v[64:79], v[36:39], v[16:19], v[64:79]
    ds_read_b64_tr_b16 v[32:33], v4 offset:30720
    ds_read_b64_tr_b16 v[34:35], v4 offset:32000
    ds_read_b64 v[16:17], v8 offset:20480
    ds_read_b64 v[18:19], v8 offset:20992
    s_waitcnt lgkmcnt(10)
    v_mfma_f32_32x32x16_bf16 v[80:95], v[36:39], v[20:23], v[80:95]
    ds_read_b64 v[20:21], v8 offset:28672
    ds_read_b64 v[22:23], v8 offset:29184
    s_waitcnt lgkmcnt(8)
    v_mfma_f32_32x32x16_bf16 v[64:79], v[40:43], v[24:27], v[64:79]
    ds_read_b64_tr_b16 v[36:37], v4 offset:33280
    ds_read_b64_tr_b16 v[38:39], v4 offset:34560
    ds_read_b64 v[24:25], v8 offset:21504
    ds_read_b64 v[26:27], v8 offset:22016
    s_waitcnt lgkmcnt(10)
    v_mfma_f32_32x32x16_bf16 v[80:95], v[40:43], v[28:31], v[80:95]
    ds_read_b64 v[28:29], v8 offset:29696
    ds_read_b64 v[30:31], v8 offset:30208
    s_waitcnt lgkmcnt(8)
    v_mfma_f32_32x32x16_bf16 v[64:79], v[32:35], v[16:19], v[64:79]
    ds_read_b64_tr_b16 v[40:41], v4 offset:35840
    ds_read_b64_tr_b16 v[42:43], v4 offset:37120
    ds_read_b64 v[16:17], v8 offset:22528
    ds_read_b64 v[18:19], v8 offset:23040
    s_waitcnt lgkmcnt(10)
    v_mfma_f32_32x32x16_bf16 v[80:95], v[32:35], v[20:23], v[80:95]
    ds_read_b64 v[20:21], v8 offset:30720
    ds_read_b64 v[22:23], v8 offset:31232
    s_waitcnt lgkmcnt(8)
    v_mfma_f32_32x32x16_bf16 v[64:79], v[36:39], v[24:27], v[64:79]
    ds_read_b64_tr_b16 v[32:33], v4 offset:38400
    ds_read_b64_tr_b16 v[34:35], v4 offset:39680
    ds_read_b64 v[24:25], v8 offset:23552
    ds_read_b64 v[26:27], v8 offset:24064
    s_waitcnt lgkmcnt(10)
    v_mfma_f32_32x32x16_bf16 v[80:95], v[36:39], v[28:31], v[80:95]
    ds_read_b64 v[28:29], v8 offset:31744
    ds_read_b64 v[30:31], v8 offset:32256
    s_waitcnt lgkmcnt(8)
    v_mfma_f32_32x32x16_bf16 v[64:79], v[40:43], v[16:19], v[64:79]
    s_waitcnt lgkmcnt(6)
    v_mfma_f32_32x32x16_bf16 v[80:95], v[40:43], v[20:23], v[80:95]
    s_waitcnt lgkmcnt(0)
    s_barrier
    ds_read_b64_tr_b16 v[36:37], v4 offset:40960
    ds_read_b64_tr_b16 v[38:39], v4 offset:42240
    ds_read_b64 v[16:17], v8 offset:32768
    ds_read_b64 v[18:19], v8 offset:33280
    ds_read_b64 v[20:21], v8 offset:40960
    ds_read_b64 v[22:23], v8 offset:41472
    v_mfma_f32_32x32x16_bf16 v[64:79], v[32:35], v[24:27], v[64:79]
    ds_read_b64_tr_b16 v[40:41], v4 offset:43520
    ds_read_b64_tr_b16 v[42:43], v4 offset:44800
    ds_read_b64 v[24:25], v8 offset:33792
    ds_read_b64 v[26:27], v8 offset:34304
    v_mfma_f32_32x32x16_bf16 v[80:95], v[32:35], v[28:31], v[80:95]
    ds_read_b64 v[28:29], v8 offset:41984
    ds_read_b64 v[30:31], v8 offset:42496
    s_waitcnt lgkmcnt(8)
    v_mfma_f32_32x32x16_bf16 v[64:79], v[36:39], v[16:19], v[64:79]
    ds_read_b64_tr_b16 v[32:33], v4 offset:46080
    ds_read_b64_tr_b16 v[34:35], v4 offset:47360
    ds_read_b64 v[16:17], v8 offset:34816
    ds_read_b64 v[18:19], v8 offset:35328
    s_waitcnt lgkmcnt(10)
    v_mfma_f32_32x32x16_bf16 v[80:95], v[36:39], v[20:23], v[80:95]
    ds_read_b64 v[20:21], v8 offset:43008
    ds_read_b64 v[22:23], v8 offset:43520
    s_waitcnt lgkmcnt(8)
    v_mfma_f32_32x32x16_bf16 v[64:79], v[40:43], v[24:27], v[64:79]
    ds_read_b64_tr_b16 v[36:37], v4 offset:48640
    ds_read_b64_tr_b16 v[38:39], v4 offset:49920
    ds_read_b64 v[24:25], v8 offset:35840
    ds_read_b64 v[26:27], v8 offset:36352
    s_waitcnt lgkmcnt(10)
    v_mfma_f32_32x32x16_bf16 v[80:95], v[40:43], v[28:31], v[80:95]
    ds_read_b64 v[28:29], v8 offset:44032
    ds_read_b64 v[30:31], v8 offset:44544
    s_waitcnt lgkmcnt(8)
    v_mfma_f32_32x32x16_bf16 v[64:79], v[32:35], v[16:19], v[64:79]
    ds_read_b64_tr_b16 v[40:41], v4 offset:51200
    ds_read_b64_tr_b16 v[42:43], v4 offset:52480
    ds_read_b64 v[16:17], v8 offset:36864
    ds_read_b64 v[18:19], v8 offset:37376
    s_waitcnt lgkmcnt(10)
    v_mfma_f32_32x32x16_bf16 v[80:95], v[32:35], v[20:23], v[80:95]
    ds_read_b64 v[20:21], v8 offset:45056
    ds_read_b64 v[22:23], v8 offset:45568
    s_waitcnt lgkmcnt(8)
    v_mfma_f32_32x32x16_bf16 v[64:79], v[36:39], v[24:27], v[64:79]
    ds_read_b64_tr_b16 v[32:33], v4 offset:53760
    ds_read_b64_tr_b16 v[34:35], v4 offset:55040
    ds_read_b64 v[24:25], v8 offset:37888
    ds_read_b64 v[26:27], v8 offset:38400
    s_waitcnt lgkmcnt(10)
    v_mfma_f32_32x32x16_bf16 v[80:95], v[36:39], v[28:31], v[80:95]
    ds_read_b64 v[28:29], v8 offset:46080
    ds_read_b64 v[30:31], v8 offset:46592
    s_waitcnt lgkmcnt(8)
    v_mfma_f32_32x32x16_bf16 v[64:79], v[40:43], v[16:19], v[64:79]
    ds_read_b64_tr_b16 v[36:37], v4 offset:56320
    ds_read_b64_tr_b16 v[38:39], v4 offset:57600
    ds_read_b64 v[16:17], v8 offset:38912
    ds_read_b64 v[18:19], v8 offset:39424
    s_waitcnt lgkmcnt(10)
    v_mfma_f32_32x32x16_bf16 v[80:95], v[40:43], v[20:23], v[80:95]
    ds_read_b64 v[20:21], v8 offset:47104
    ds_read_b64 v[22:23], v8 offset:47616
    s_waitcnt lgkmcnt(8)
    v_mfma_f32_32x32x16_bf16 v[64:79], v[32:35], v[24:27], v[64:79]
    ds_read_b64_tr_b16 v[40:41], v4 offset:58880
    ds_read_b64_tr_b16 v[42:43], v4 offset:60160
    ds_read_b64 v[24:25], v8 offset:39936
    ds_read_b64 v[26:27], v8 offset:40448
    s_waitcnt lgkmcnt(10)
    v_mfma_f32_32x32x16_bf16 v[80:95], v[32:35], v[28:31], v[80:95]
    ds_read_b64 v[28:29], v8 offset:48128
    ds_read_b64 v[30:31], v8 offset:48640
    s_waitcnt lgkmcnt(8)
    v_mfma_f32_32x32x16_bf16 v[64:79], v[36:39], v[16:19], v[64:79]
    s_waitcnt lgkmcnt(6)
    v_mfma_f32_32x32x16_bf16 v[80:95], v[36:39], v[20:23], v[80:95]
    s_waitcnt lgkmcnt(0)
    s_barrier
    ds_read_b64_tr_b16 v[32:33], v4 offset:61440
    ds_read_b64_tr_b16 v[34:35], v4 offset:62720
    ds_read_b64 v[16:17], v8 offset:0
    ds_read_b64 v[18:19], v8 offset:512
    ds_read_b64 v[20:21], v8 offset:8192
    ds_read_b64 v[22:23], v8 offset:8704
    v_mfma_f32_32x32x16_bf16 v[64:79], v[40:43], v[24:27], v[64:79]
    ds_read_b64_tr_b16 v[36:37], v4 offset:64000
    ds_read_b64_tr_b16 v[38:39], v4 offset:65280
    ds_read_b64 v[24:25], v8 offset:1024
    ds_read_b64 v[26:27], v8 offset:1536
    v_mfma_f32_32x32x16_bf16 v[80:95], v[40:43], v[28:31], v[80:95]
    ds_read_b64 v[28:29], v8 offset:9216
    ds_read_b64 v[30:31], v8 offset:9728
    s_waitcnt lgkmcnt(8)
    v_mfma_f32_32x32x16_bf16 v[64:79], v[32:35], v[16:19], v[64:79]
    ds_read_b64_tr_b16 v[40:41], v5 offset:1024
    ds_read_b64_tr_b16 v[42:43], v5 offset:2304
    ds_read_b64 v[16:17], v8 offset:2048
    ds_read_b64 v[18:19], v8 offset:2560
    s_waitcnt lgkmcnt(10)
    v_mfma_f32_32x32x16_bf16 v[80:95], v[32:35], v[20:23], v[80:95]
    ds_read_b64 v[20:21], v8 offset:10240
    ds_read_b64 v[22:23], v8 offset:10752
    s_waitcnt lgkmcnt(8)
    v_mfma_f32_32x32x16_bf16 v[64:79], v[36:39], v[24:27], v[64:79]
    ds_read_b64_tr_b16 v[32:33], v5 offset:3584
    ds_read_b64_tr_b16 v[34:35], v5 offset:4864
    ds_read_b64 v[24:25], v8 offset:3072
    ds_read_b64 v[26:27], v8 offset:3584
    s_waitcnt lgkmcnt(10)
    v_mfma_f32_32x32x16_bf16 v[80:95], v[36:39], v[28:31], v[80:95]
    ds_read_b64 v[28:29], v8 offset:11264
    ds_read_b64 v[30:31], v8 offset:11776
    s_waitcnt lgkmcnt(8)
    v_mfma_f32_32x32x16_bf16 v[64:79], v[40:43], v[16:19], v[64:79]
    ds_read_b64_tr_b16 v[36:37], v5 offset:6144
    ds_read_b64_tr_b16 v[38:39], v5 offset:7424
    ds_read_b64 v[16:17], v8 offset:4096
    ds_read_b64 v[18:19], v8 offset:4608
    s_waitcnt lgkmcnt(10)
    v_mfma_f32_32x32x16_bf16 v[80:95], v[40:43], v[20:23], v[80:95]
    ds_read_b64 v[20:21], v8 offset:12288
    ds_read_b64 v[22:23], v8 offset:12800
    s_waitcnt lgkmcnt(8)
    v_mfma_f32_32x32x16_bf16 v[64:79], v[32:35], v[24:27], v[64:79]
    ds_read_b64_tr_b16 v[40:41], v5 offset:8704
    ds_read_b64_tr_b16 v[42:43], v5 offset:9984
    ds_read_b64 v[24:25], v8 offset:5120
    ds_read_b64 v[26:27], v8 offset:5632
    s_waitcnt lgkmcnt(10)
    v_mfma_f32_32x32x16_bf16 v[80:95], v[32:35], v[28:31], v[80:95]
    ds_read_b64 v[28:29], v8 offset:13312
    ds_read_b64 v[30:31], v8 offset:13824
    s_waitcnt lgkmcnt(8)
    v_mfma_f32_32x32x16_bf16 v[64:79], v[36:39], v[16:19], v[64:79]
    ds_read_b64_tr_b16 v[32:33], v5 offset:11264
    ds_read_b64_tr_b16 v[34:35], v5 offset:12544
    ds_read_b64 v[16:17], v8 offset:6144
    ds_read_b64 v[18:19], v8 offset:6656
    s_waitcnt lgkmcnt(10)
    v_mfma_f32_32x32x16_bf16 v[80:95], v[36:39], v[20:23], v[80:95]
    ds_read_b64 v[20:21], v8 offset:14336
    ds_read_b64 v[22:23], v8 offset:14848
    s_waitcnt lgkmcnt(8)
    v_mfma_f32_32x32x16_bf16 v[64:79], v[40:43], v[24:27], v[64:79]
    ds_read_b64_tr_b16 v[36:37], v5 offset:13824
    ds_read_b64_tr_b16 v[38:39], v5 offset:15104
    ds_read_b64 v[24:25], v8 offset:7168
    ds_read_b64 v[26:27], v8 offset:7680
    s_waitcnt lgkmcnt(10)
    v_mfma_f32_32x32x16_bf16 v[80:95], v[40:43], v[28:31], v[80:95]
    ds_read_b64 v[28:29], v8 offset:15360
    ds_read_b64 v[30:31], v8 offset:15872
    s_waitcnt lgkmcnt(8)
    v_mfma_f32_32x32x16_bf16 v[64:79], v[32:35], v[16:19], v[64:79]
    s_waitcnt lgkmcnt(6)
    v_mfma_f32_32x32x16_bf16 v[80:95], v[32:35], v[20:23], v[80:95]
    s_waitcnt lgkmcnt(0)
    s_barrier
    ds_read_b64_tr_b16 v[40:41], v4 offset:0
    ds_read_b64_tr_b16 v[42:43], v4 offset:1280
    ds_read_b64 v[16:17], v8 offset:16384
    ds_read_b64 v[18:19], v8 offset:16896
    ds_read_b64 v[20:21], v8 offset:24576
    ds_read_b64 v[22:23], v8 offset:25088
    v_mfma_f32_32x32x16_bf16 v[64:79], v[36:39], v[24:27], v[64:79]
    ds_read_b64_tr_b16 v[32:33], v4 offset:2560
    ds_read_b64_tr_b16 v[34:35], v4 offset:3840
    ds_read_b64 v[24:25], v8 offset:17408
    ds_read_b64 v[26:27], v8 offset:17920
    v_mfma_f32_32x32x16_bf16 v[80:95], v[36:39], v[28:31], v[80:95]
    ds_read_b64 v[28:29], v8 offset:25600
    ds_read_b64 v[30:31], v8 offset:26112
    s_waitcnt lgkmcnt(8)
    v_mfma_f32_32x32x16_bf16 v[64:79], v[40:43], v[16:19], v[64:79]
    ds_read_b64_tr_b16 v[36:37], v4 offset:5120
    ds_read_b64_tr_b16 v[38:39], v4 offset:6400
    ds_read_b64 v[16:17], v8 offset:18432
    ds_read_b64 v[18:19], v8 offset:18944
    s_waitcnt lgkmcnt(10)
    v_mfma_f32_32x32x16_bf16 v[80:95], v[40:43], v[20:23], v[80:95]
    ds_read_b64 v[20:21], v8 offset:26624
    ds_read_b64 v[22:23], v8 offset:27136
    s_waitcnt lgkmcnt(8)
    v_mfma_f32_32x32x16_bf16 v[64:79], v[32:35], v[24:27], v[64:79]
    ds_read_b64_tr_b16 v[40:41], v4 offset:7680
    ds_read_b64_tr_b16 v[42:43], v4 offset:8960
    ds_read_b64 v[24:25], v8 offset:19456
    ds_read_b64 v[26:27], v8 offset:19968
    s_waitcnt lgkmcnt(10)
    v_mfma_f32_32x32x16_bf16 v[80:95], v[32:35], v[28:31], v[80:95]
    ds_read_b64 v[28:29], v8 offset:27648
    ds_read_b64 v[30:31], v8 offset:28160
    s_waitcnt lgkmcnt(8)
    v_mfma_f32_32x32x16_bf16 v[64:79], v[36:39], v[16:19], v[64:79]
    ds_read_b64_tr_b16 v[32:33], v4 offset:10240
    ds_read_b64_tr_b16 v[34:35], v4 offset:11520
    ds_read_b64 v[16:17], v8 offset:20480
    ds_read_b64 v[18:19], v8 offset:20992
    s_waitcnt lgkmcnt(10)
    v_mfma_f32_32x32x16_bf16 v[80:95], v[36:39], v[20:23], v[80:95]
    ds_read_b64 v[20:21], v8 offset:28672
    ds_read_b64 v[22:23], v8 offset:29184
    s_waitcnt lgkmcnt(8)
    v_mfma_f32_32x32x16_bf16 v[64:79], v[40:43], v[24:27], v[64:79]
    ds_read_b64_tr_b16 v[36:37], v4 offset:12800
    ds_read_b64_tr_b16 v[38:39], v4 offset:14080
    ds_read_b64 v[24:25], v8 offset:21504
    ds_read_b64 v[26:27], v8 offset:22016
    s_waitcnt lgkmcnt(10)
    v_mfma_f32_32x32x16_bf16 v[80:95], v[40:43], v[28:31], v[80:95]
    ds_read_b64 v[28:29], v8 offset:29696
    ds_read_b64 v[30:31], v8 offset:30208
    s_waitcnt lgkmcnt(8)
    v_mfma_f32_32x32x16_bf16 v[64:79], v[32:35], v[16:19], v[64:79]
    ds_read_b64_tr_b16 v[40:41], v4 offset:15360
    ds_read_b64_tr_b16 v[42:43], v4 offset:16640
    ds_read_b64 v[16:17], v8 offset:22528
    ds_read_b64 v[18:19], v8 offset:23040
    s_waitcnt lgkmcnt(10)
    v_mfma_f32_32x32x16_bf16 v[80:95], v[32:35], v[20:23], v[80:95]
    ds_read_b64 v[20:21], v8 offset:30720
    ds_read_b64 v[22:23], v8 offset:31232
    s_waitcnt lgkmcnt(8)
    v_mfma_f32_32x32x16_bf16 v[64:79], v[36:39], v[24:27], v[64:79]
    ds_read_b64_tr_b16 v[32:33], v4 offset:17920
    ds_read_b64_tr_b16 v[34:35], v4 offset:19200
    ds_read_b64 v[24:25], v8 offset:23552
    ds_read_b64 v[26:27], v8 offset:24064
    s_waitcnt lgkmcnt(10)
    v_mfma_f32_32x32x16_bf16 v[80:95], v[36:39], v[28:31], v[80:95]
    ds_read_b64 v[28:29], v8 offset:31744
    ds_read_b64 v[30:31], v8 offset:32256
    s_waitcnt lgkmcnt(8)
    v_mfma_f32_32x32x16_bf16 v[64:79], v[40:43], v[16:19], v[64:79]
    s_waitcnt lgkmcnt(6)
    v_mfma_f32_32x32x16_bf16 v[80:95], v[40:43], v[20:23], v[80:95]
    s_waitcnt lgkmcnt(2)
    v_mfma_f32_32x32x16_bf16 v[64:79], v[32:35], v[24:27], v[64:79]
    s_waitcnt lgkmcnt(0)
    v_mfma_f32_32x32x16_bf16 v[80:95], v[32:35], v[28:31], v[80:95]
    s_lshl_b32 s71, s40, 7
    s_add_u32 s71, s71, 141312
    v_lshl_add_u32 v13, v3, 4, s71
    s_lshl_b32 s71, s40, 11
    s_add_u32 s71, s71, 131072
    v_add_u32 v14, s71, v1
    ds_read_b128 v[112:115], v13 offset:0
    ds_read_b128 v[116:119], v13 offset:32
    ds_read_b128 v[120:123], v13 offset:64
    ds_read_b128 v[124:127], v13 offset:96
    v_mul_u32_u24 v14, 160, v2
    v_lshl_add_u32 v14, v3, 3, v14
    s_lshl_b32 s71, s40, 6
    s_add_u32 s71, s71, 131072
    v_add_u32 v14, s71, v14
    ds_read_b64 v[96:97], v14 offset:0
    ds_read_b64 v[98:99], v14 offset:16
    ds_read_b64 v[100:101], v14 offset:32
    ds_read_b64 v[102:103], v14 offset:48
    ds_read_b64 v[104:105], v14 offset:5120
    ds_read_b64 v[106:107], v14 offset:5136
    ds_read_b64 v[108:109], v14 offset:5152
    ds_read_b64 v[110:111], v14 offset:5168
    s_mul_i32 s73, s69, 5
    s_lshl_b32 s74, s40, 1
    s_add_u32 s73, s73, s74
    s_lshl_b32 s73, s73, 10
    s_lshl_b32 s74, s68, 1
    s_mul_i32 s74, s74, 40960
    s_add_u32 s73, s73, s74
    s_waitcnt lgkmcnt(0)
    s_nop 1
    v_mov_b32 v44, 0
    v_mov_b32 v45, 0
    v_lshlrev_b32 v48, 16, v96
    v_and_b32 v49, 0xffff0000, v96
    v_fma_f32 v64, v112, v64, v48
    v_fma_f32 v65, v113, v65, v49
    v_lshlrev_b32 v48, 16, v97
    v_and_b32 v49, 0xffff0000, v97
    v_fma_f32 v66, v114, v66, v48
    v_fma_f32 v67, v115, v67, v49
    v_lshlrev_b32 v48, 16, v98
    v_and_b32 v49, 0xffff0000, v98
    v_fma_f32 v68, v116, v68, v48
    v_fma_f32 v69, v117, v69, v49
    v_lshlrev_b32 v48, 16, v99
    v_and_b32 v49, 0xffff0000, v99
    v_fma_f32 v70, v118, v70, v48
    v_fma_f32 v71, v119, v71, v49
    v_cvt_pk_bf16_f32 v160, v64, v65
    v_cvt_pk_bf16_f32 v161, v66, v67
    v_cvt_pk_bf16_f32 v162, v68, v69
    v_cvt_pk_bf16_f32 v163, v70, v71
    v_lshlrev_b32 v64, 16, v160
    v_and_b32 v65, 0xffff0000, v160
    v_lshlrev_b32 v66, 16, v161
    v_and_b32 v67, 0xffff0000, v161
    v_lshlrev_b32 v68, 16, v162
    v_and_b32 v69, 0xffff0000, v162
    v_lshlrev_b32 v70, 16, v163
    v_and_b32 v71, 0xffff0000, v163
    v_add_f32 v44, v44, v64
    v_fmac_f32 v45, v64, v64
    v_add_f32 v44, v44, v65
    v_fmac_f32 v45, v65, v65
    v_add_f32 v44, v44, v66
    v_fmac_f32 v45, v66, v66
    v_add_f32 v44, v44, v67
    v_fmac_f32 v45, v67, v67
    v_add_f32 v44, v44, v68
    v_fmac_f32 v45, v68, v68
    v_add_f32 v44, v44, v69
    v_fmac_f32 v45, v69, v69
    v_add_f32 v44, v44, v70
    v_fmac_f32 v45, v70, v70
    v_add_f32 v44, v44, v71
    v_fmac_f32 v45, v71, v71
    s_cmp_eq_u32 s40, 2
    s_cbranch_scc1 P3_e_80
    v_lshlrev_b32 v48, 16, v100
    v_and_b32 v49, 0xffff0000, v100
    v_fma_f32 v72, v120, v72, v48
    v_fma_f32 v73, v121, v73, v49
    v_lshlrev_b32 v48, 16, v101
    v_and_b32 v49, 0xffff0000, v101
    v_fma_f32 v74, v122, v74, v48
    v_fma_f32 v75, v123, v75, v49
    v_lshlrev_b32 v48, 16, v102
    v_and_b32 v49, 0xffff0000, v102
    v_fma_f32 v76, v124, v76, v48
    v_fma_f32 v77, v125, v77, v49
    v_lshlrev_b32 v48, 16, v103
    v_and_b32 v49, 0xffff0000, v103
    v_fma_f32 v78, v126, v78, v48
    v_fma_f32 v79, v127, v79, v49
    v_cvt_pk_bf16_f32 v164, v72, v73
    v_cvt_pk_bf16_f32 v165, v74, v75
    v_cvt_pk_bf16_f32 v166, v76, v77
    v_cvt_pk_bf16_f32 v167, v78, v79
    v_lshlrev_b32 v72, 16, v164
    v_and_b32 v73, 0xffff0000, v164
    v_lshlrev_b32 v74, 16, v165
    v_and_b32 v75, 0xffff0000, v165
    v_lshlrev_b32 v76, 16, v166
    v_and_b32 v77, 0xffff0000, v166
    v_lshlrev_b32 v78, 16, v167
    v_and_b32 v79, 0xffff0000, v167
    v_add_f32 v44, v44, v72
    v_fmac_f32 v45, v72, v72
    v_add_f32 v44, v44, v73
    v_fmac_f32 v45, v73, v73
    v_add_f32 v44, v44, v74
    v_fmac_f32 v45, v74, v74
    v_add_f32 v44, v44, v75
    v_fmac_f32 v45, v75, v75
    v_add_f32 v44, v44, v76
    v_fmac_f32 v45, v76, v76
    v_add_f32 v44, v44, v77
    v_fmac_f32 v45, v77, v77
    v_add_f32 v44, v44, v78
    v_fmac_f32 v45, v78, v78
    v_add_f32 v44, v44, v79
    v_fmac_f32 v45, v79, v79
P3_e_80:
    v_mov_b32 v46, 0
    v_mov_b32 v47, 0
    v_lshlrev_b32 v48, 16, v104
    v_and_b32 v49, 0xffff0000, v104
    v_fma_f32 v80, v112, v80, v48
    v_fma_f32 v81, v113, v81, v49
    v_lshlrev_b32 v48, 16, v105
    v_and_b32 v49, 0xffff0000, v105
    v_fma_f32 v82, v114, v82, v48
    v_fma_f32 v83, v115, v83, v49
    v_lshlrev_b32 v48, 16, v106
    v_and_b32 v49, 0xffff0000, v106
    v_fma_f32 v84, v116, v84, v48
    v_fma_f32 v85, v117, v85, v49
    v_lshlrev_b32 v48, 16, v107
    v_and_b32 v49, 0xffff0000, v107
    v_fma_f32 v86, v118, v86, v48
    v_fma_f32 v87, v119, v87, v49
    v_cvt_pk_bf16_f32 v168, v80, v81
    v_cvt_pk_bf16_f32 v169, v82, v83
    v_cvt_pk_bf16_f32 v170, v84, v85
    v_cvt_pk_bf16_f32 v171, v86, v87
    v_lshlrev_b32 v80, 16, v168
    v_and_b32 v81, 0xffff0000, v168
    v_lshlrev_b32 v82, 16, v169
    v_and_b32 v83, 0xffff0000, v169
    v_lshlrev_b32 v84, 16, v170
    v_and_b32 v85, 0xffff0000, v170
    v_lshlrev_b32 v86, 16, v171
    v_and_b32 v87, 0xffff0000, v171
    v_add_f32 v46, v46, v80
    v_fmac_f32 v47, v80, v80
    v_add_f32 v46, v46, v81
    v_fmac_f32 v47, v81, v81
    v_add_f32 v46, v46, v82
    v_fmac_f32 v47, v82, v82
    v_add_f32 v46, v46, v83
    v_fmac_f32 v47, v83, v83
    v_add_f32 v46, v46, v84
    v_fmac_f32 v47, v84, v84
    v_add_f32 v46, v46, v85
    v_fmac_f32 v47, v85, v85
    v_add_f32 v46, v46, v86
    v_fmac_f32 v47, v86, v86
    v_add_f32 v46, v46, v87
    v_fmac_f32 v47, v87, v87
    s_cmp_eq_u32 s40, 2
    s_cbranch_scc1 P3_e_81
    v_lshlrev_b32 v48, 16, v108
    v_and_b32 v49, 0xffff0000, v108
    v_fma_f32 v88, v120, v88, v48
    v_fma_f32 v89, v121, v89, v49
    v_lshlrev_b32 v48, 16, v109
    v_and_b32 v49, 0xffff0000, v109
    v_fma_f32 v90, v122, v90, v48
    v_fma_f32 v91, v123, v91, v49
    v_lshlrev_b32 v48, 16, v110
    v_and_b32 v49, 0xffff0000, v110
    v_fma_f32 v92, v124, v92, v48
    v_fma_f32 v93, v125, v93, v49
    v_lshlrev_b32 v48, 16, v111
    v_and_b32 v49, 0xffff0000, v111
    v_fma_f32 v94, v126, v94, v48
    v_fma_f32 v95, v127, v95, v49
    v_cvt_pk_bf16_f32 v172, v88, v89
    v_cvt_pk_bf16_f32 v173, v90, v91
    v_cvt_pk_bf16_f32 v174, v92, v93
    v_cvt_pk_bf16_f32 v175, v94, v95
    v_lshlrev_b32 v88, 16, v172
    v_and_b32 v89, 0xffff0000, v172
    v_lshlrev_b32 v90, 16, v173
    v_and_b32 v91, 0xffff0000, v173
    v_lshlrev_b32 v92, 16, v174
    v_and_b32 v93, 0xffff0000, v174
    v_lshlrev_b32 v94, 16, v175
    v_and_b32 v95, 0xffff0000, v175
    v_add_f32 v46, v46, v88
    v_fmac_f32 v47, v88, v88
    v_add_f32 v46, v46, v89
    v_fmac_f32 v47, v89, v89
    v_add_f32 v46, v46, v90
    v_fmac_f32 v47, v90, v90
    v_add_f32 v46, v46, v91
    v_fmac_f32 v47, v91, v91
    v_add_f32 v46, v46, v92
    v_fmac_f32 v47, v92, v92
    v_add_f32 v46, v46, v93
    v_fmac_f32 v47, v93, v93
    v_add_f32 v46, v46, v94
    v_fmac_f32 v47, v94, v94
    v_add_f32 v46, v46, v95
    v_fmac_f32 v47, v95, v95
P3_e_81:
    s_lshl_b32 s75, s40, 9
    s_add_u32 s75, s75, 142336
    v_lshl_add_u32 v15, v0, 3, s75
    ds_write_b64 v15, v[44:45]
    ds_write_b64 v15, v[46:47] offset:1536
    ds_read_b128 v[144:147], v13 offset:320
    ds_read_b128 v[148:151], v13 offset:352
    ds_read_b128 v[152:155], v13 offset:384
    ds_read_b128 v[156:159], v13 offset:416
    ds_read_b128 v[128:131], v13 offset:640
    ds_read_b128 v[132:135], v13 offset:672
    ds_read_b128 v[136:139], v13 offset:704
    ds_read_b128 v[140:143], v13 offset:736
    s_waitcnt lgkmcnt(0)
    s_barrier
    s_barrier
    v_lshlrev_b32 v15, 3, v2
    v_add_u32 v15, 145408, v15
    ds_read_b64 v[44:45], v15
    ds_read_b64 v[46:47], v15 offset:256
    s_waitcnt lgkmcnt(0)
    s_add_u32 s75, s73, 0
    v_fma_f32 v64, v64, v44, v45
    v_fma_f32 v65, v65, v44, v45
    v_fma_f32 v66, v66, v44, v45
    v_fma_f32 v67, v67, v44, v45
    v_fma_f32 v68, v68, v44, v45
    v_fma_f32 v69, v69, v44, v45
    v_fma_f32 v70, v70, v44, v45
    v_fma_f32 v71, v71, v44, v45
    v_fma_f32 v64, v64, v128, v144
    v_fma_f32 v65, v65, v129, v145
    v_fma_f32 v66, v66, v130, v146
    v_fma_f32 v67, v67, v131, v147
    v_fma_f32 v68, v68, v132, v148
    v_fma_f32 v69, v69, v133, v149
    v_fma_f32 v70, v70, v134, v150
    v_fma_f32 v71, v71, v135, v151
    v_cvt_pk_bf16_f32 v16, v64, v65
    v_cvt_pk_bf16_f32 v17, v66, v67
    v_cvt_pk_bf16_f32 v18, v68, v69
    v_cvt_pk_bf16_f32 v19, v70, v71
    buffer_store_dwordx4 v[16:19], v1, s[64:67], s75 offen offset:0 sc1
    buffer_store_dwordx4 v[160:163], v1, s[56:59], s75 offen offset:0 sc1
    s_cmp_eq_u32 s40, 2
    s_cbranch_scc1 P3_e_82
    v_fma_f32 v72, v72, v44, v45
    v_fma_f32 v73, v73, v44, v45
    v_fma_f32 v74, v74, v44, v45
    v_fma_f32 v75, v75, v44, v45
    v_fma_f32 v76, v76, v44, v45
    v_fma_f32 v77, v77, v44, v45
    v_fma_f32 v78, v78, v44, v45
    v_fma_f32 v79, v79, v44, v45
    v_fma_f32 v72, v72, v136, v152
    v_fma_f32 v73, v73, v137, v153
    v_fma_f32 v74, v74, v138, v154
    v_fma_f32 v75, v75, v139, v155
    v_fma_f32 v76, v76, v140, v156
    v_fma_f32 v77, v77, v141, v157
    v_fma_f32 v78, v78, v142, v158
    v_fma_f32 v79, v79, v143, v159
    v_cvt_pk_bf16_f32 v20, v72, v73
    v_cvt_pk_bf16_f32 v21, v74, v75
    v_cvt_pk_bf16_f32 v22, v76, v77
    v_cvt_pk_bf16_f32 v23, v78, v79
    buffer_store_dwordx4 v[20:23], v1, s[64:67], s75 offen offset:1024 sc1
    buffer_store_dwordx4 v[164:167], v1, s[56:59], s75 offen offset:1024 sc1
P3_e_82:
    s_add_u32 s75, s73, 40960
    v_fma_f32 v80, v80, v46, v47
    v_fma_f32 v81, v81, v46, v47
    v_fma_f32 v82, v82, v46, v47
    v_fma_f32 v83, v83, v46, v47
    v_fma_f32 v84, v84, v46, v47
    v_fma_f32 v85, v85, v46, v47
    v_fma_f32 v86, v86, v46, v47
    v_fma_f32 v87, v87, v46, v47
    v_fma_f32 v80, v80, v128, v144
    v_fma_f32 v81, v81, v129, v145
    v_fma_f32 v82, v82, v130, v146
    v_fma_f32 v83, v83, v131, v147
    v_fma_f32 v84, v84, v132, v148
    v_fma_f32 v85, v85, v133, v149
    v_fma_f32 v86, v86, v134, v150
    v_fma_f32 v87, v87, v135, v151
    v_cvt_pk_bf16_f32 v24, v80, v81
    v_cvt_pk_bf16_f32 v25, v82, v83
    v_cvt_pk_bf16_f32 v26, v84, v85
    v_cvt_pk_bf16_f32 v27, v86, v87
    buffer_store_dwordx4 v[24:27], v1, s[64:67], s75 offen offset:0 sc1
    buffer_store_dwordx4 v[168:171], v1, s[56:59], s75 offen offset:0 sc1
    s_cmp_eq_u32 s40, 2
    s_cbranch_scc1 P3_e_83
    v_fma_f32 v88, v88, v46, v47
    v_fma_f32 v89, v89, v46, v47
    v_fma_f32 v90, v90, v46, v47
    v_fma_f32 v91, v91, v46, v47
    v_fma_f32 v92, v92, v46, v47
    v_fma_f32 v93, v93, v46, v47
    v_fma_f32 v94, v94, v46, v47
    v_fma_f32 v95, v95, v46, v47
    v_fma_f32 v88, v88, v136, v152
    v_fma_f32 v89, v89, v137, v153
    v_fma_f32 v90, v90, v138, v154
    v_fma_f32 v91, v91, v139, v155
    v_fma_f32 v92, v92, v140, v156
    v_fma_f32 v93, v93, v141, v157
    v_fma_f32 v94, v94, v142, v158
    v_fma_f32 v95, v95, v143, v159
    v_cvt_pk_bf16_f32 v28, v88, v89
    v_cvt_pk_bf16_f32 v29, v90, v91
    v_cvt_pk_bf16_f32 v30, v92, v93
    v_cvt_pk_bf16_f32 v31, v94, v95
    buffer_store_dwordx4 v[28:31], v1, s[64:67], s75 offen offset:1024 sc1
    buffer_store_dwordx4 v[172:175], v1, s[56:59], s75 offen offset:1024 sc1
P3_e_83:
    s_branch P3_fin_73
P3_w3_72:
    v_min_u32 v4, 59, v0
    v_mul_u32_u24 v5, 52429, v4
    v_lshrrev_b32 v5, 20, v5
    v_mul_u32_u24 v6, 20, v5
    v_sub_u32 v6, v4, v6
    v_add_u32 v7, 2, v5
    v_mul_u32_u24 v7, 160, v7
    v_add_u32 v7, v7, v6
    s_mul_i32 s71, s69, 20
    v_add_u32 v7, s71, v7
    v_lshlrev_b32 v7, 4, v7
    v_mov_b32 v15, v7
    v_mul_u32_u24 v7, 320, v5
    v_lshl_add_u32 v7, v6, 4, v7
    v_add_u32 v7, 141312, v7
    s_barrier
    s_barrier
    s_mov_b32 s94, 30000
    s_cmp_lg_u32 s42, 0
    s_cselect_b32 s94, 1, s94
tab_poll_84:
    buffer_load_dwordx4 v[8:11], v15, s[52:55], 0 offen sc1
    s_waitcnt vmcnt(0)
    v_cmp_ne_u32 vcc, s41, v10
    s_nop 1
    s_cbranch_vccz tab_ok_86
    s_sleep 2
    s_sub_u32 s94, s94, 1
    s_cmp_lg_u32 s94, 0
    s_cbranch_scc1 tab_poll_84
    s_mov_b32 s42, 1
tab_ok_86:
    v_lshlrev_b32 v12, 16, v8
    v_and_b32 v13, 0xffff0000, v8
    v_lshlrev_b32 v14, 16, v9
    v_and_b32 v15, 0xffff0000, v9
    v_mov_b32 v16, v12
    v_mov_b32 v17, v13
    v_mov_b32 v18, v14
    v_mov_b32 v19, v15
    v_cmp_eq_u32 vcc, 2, v5
    v_add_f32 v16, 1.0, v16
    v_add_f32 v17, 1.0, v17
    v_add_f32 v18, 1.0, v18
    v_add_f32 v19, 1.0, v19
    v_cvt_pk_bf16_f32 v16, v16, v17
    v_cvt_pk_bf16_f32 v18, v18, v19
    v_and_b32 v17, 0xffff0000, v16
    v_and_b32 v19, 0xffff0000, v18
    v_lshlrev_b32 v16, 16, v16
    v_lshlrev_b32 v18, 16, v18
    v_cndmask_b32 v12, v12, v16, vcc
    v_cndmask_b32 v13, v13, v17, vcc
    v_cndmask_b32 v14, v14, v18, vcc
    v_cndmask_b32 v15, v15, v19, vcc
    ds_write_b128 v7, v[12:15]
    s_waitcnt lgkmcnt(0)
    s_barrier
    s_barrier
    s_barrier
    s_barrier
    s_barrier
    s_add_u32 s56, s38, 0x1d00000
    s_addc_u32 s57, s39, 0
    s_mov_b32 s58, 0x40000
    s_mov_b32 s59, 0x20000
    v_mul_u32_u24 v13, 1536, v3
    v_lshl_add_u32 v13, v2, 3, v13
    v_add_u32 v13, 142336, v13
    ds_read_b64 v[48:49], v13 offset:0
    ds_read_b64 v[50:51], v13 offset:256
    ds_read_b64 v[52:53], v13 offset:512
    ds_read_b64 v[54:55], v13 offset:768
    ds_read_b64 v[56:57], v13 offset:1024
    ds_read_b64 v[58:59], v13 offset:1280
    s_waitcnt lgkmcnt(0)
    v_add_f32 v48, v48, v50
    v_add_f32 v49, v49, v51
    v_add_f32 v48, v48, v52
    v_add_f32 v49, v49, v53
    v_add_f32 v48, v48, v54
    v_add_f32 v49, v49, v55
    v_add_f32 v48, v48, v56
    v_add_f32 v49, v49, v57
    v_add_f32 v48, v48, v58
    v_add_f32 v49, v49, v59
    v_mov_b32 v50, s41
    v_mov_b32 v51, 0
    s_lshl_b32 s75, s68, 13
    s_lshl_b32 s76, s69, 10
    s_add_u32 s76, s76, s75
    buffer_store_dwordx4 v[48:51], v1, s[56:59], s76 offen sc1
    s_add_u32 s76, s75, 4096
    s_sleep 6
    s_mov_b32 s94, 30000
    s_cmp_lg_u32 s42, 0
    s_cselect_b32 s94, 1, s94
P3_stat_poll_87:
    buffer_load_dwordx4 v[64:67], v1, s[56:59], s75 offen offset:0 sc1
    buffer_load_dwordx4 v[68:71], v1, s[56:59], s75 offen offset:1024 sc1
    buffer_load_dwordx4 v[72:75], v1, s[56:59], s75 offen offset:2048 sc1
    buffer_load_dwordx4 v[76:79], v1, s[56:59], s75 offen offset:3072 sc1
    buffer_load_dwordx4 v[80:83], v1, s[56:59], s76 offen offset:0 sc1
    buffer_load_dwordx4 v[84:87], v1, s[56:59], s76 offen offset:1024 sc1
    buffer_load_dwordx4 v[88:91], v1, s[56:59], s76 offen offset:2048 sc1
    buffer_load_dwordx4 v[92:95], v1, s[56:59], s76 offen offset:3072 sc1
    s_waitcnt vmcnt(0)
    v_cmp_ne_u32 vcc, s41, v66
    v_cmp_ne_u32 s[92:93], s41, v70
    s_nop 1
    s_or_b64 vcc, vcc, s[92:93]
    v_cmp_ne_u32 s[92:93], s41, v74
    s_nop 1
    s_or_b64 vcc, vcc, s[92:93]
    v_cmp_ne_u32 s[92:93], s41, v78
    s_nop 1
    s_or_b64 vcc, vcc, s[92:93]
    v_cmp_ne_u32 s[92:93], s41, v82
    s_nop 1
    s_or_b64 vcc, vcc, s[92:93]
    v_cmp_ne_u32 s[92:93], s41, v86
    s_nop 1
    s_or_b64 vcc, vcc, s[92:93]
    v_cmp_ne_u32 s[92:93], s41, v90
    s_nop 1
    s_or_b64 vcc, vcc, s[92:93]
    v_cmp_ne_u32 s[92:93], s41, v94
    s_nop 1
    s_or_b64 vcc, vcc, s[92:93]
    s_nop 1
    s_cbranch_vccz P3_stat_ok_89
    s_sleep 1
    s_sub_u32 s94, s94, 1
    s_cmp_lg_u32 s94, 0
    s_cbranch_scc1 P3_stat_poll_87
    s_mov_b32 s42, 1
P3_stat_ok_89:
    v_add_f32 v64, v64, v68
    v_add_f32 v65, v65, v69
    v_add_f32 v64, v64, v72
    v_add_f32 v65, v65, v73
    v_add_f32 v64, v64, v76
    v_add_f32 v65, v65, v77
    v_add_f32 v64, v64, v80
    v_add_f32 v65, v65, v81
    v_add_f32 v64, v64, v84
    v_add_f32 v65, v65, v85
    v_add_f32 v64, v64, v88
    v_add_f32 v65, v65, v89
    v_add_f32 v64, v64, v92
    v_add_f32 v65, v65, v93
    v_mul_f32 v64, 0x3acccccd, v64
    v_mul_f32 v65, 0x3acccccd, v65
    v_fma_f32 v65, -v64, v64, v65
    v_max_f32 v65, 0, v65
    v_add_f32 v65, 0x3727c5ac, v65
    v_rsq_f32 v66, v65
    s_nop 0
    v_mul_f32 v67, v64, v66
    v_sub_f32 v67, 0, v67
    v_lshlrev_b32 v13, 3, v0
    v_add_u32 v13, 145408, v13
    ds_write_b64 v13, v[66:67]
    s_waitcnt lgkmcnt(0)
    s_barrier
P3_fin_73:
    s_waitcnt vmcnt(0)
    s_barrier
    s_lshl_b32 s71, s68, 3
    s_add_u32 s71, s71, s69
    s_cmp_lg_u32 s40, 0
    s_cbranch_scc1 sig_90
    s_lshl_b32 s94, s71, 6
    s_add_u32 s94, s94, 49216
    v_mov_b32 v250, s41
    v_mov_b32 v251, 0
    s_mov_b64 exec, 1
    buffer_store_dword v250, v251, s[96:99], s94 offen sc1
    s_mov_b64 exec, -1
sig_90:
    s_and_b32 s71, s2, 7
    s_lshr_b32 s72, s2, 3
    s_and_b32 s73, s71, 1
    s_lshl_b32 s73, s73, 3
    s_and_b32 s74, s72, 7
    s_add_u32 s68, s73, s74
    s_lshr_b32 s73, s71, 1
    s_lshl_b32 s73, s73, 2
    s_lshr_b32 s74, s72, 3
    s_add_u32 s69, s73, s74
    s_add_u32 s44, s38, 0x2100000
    s_addc_u32 s45, s39, 0
    s_mov_b32 s46, 0x3c0000
    s_mov_b32 s47, 0x20000
    s_add_u32 s48, s38, 0x1e00000
    s_addc_u32 s49, s39, 0
    s_mov_b32 s50, 0x280000
    s_mov_b32 s51, 0x20000
    v_lshlrev_b32 v1, 4, v0
    v_and_b32 v2, 31, v0
    v_lshrrev_b32 v3, 5, v0
    s_cmp_lt_u32 s40, 4
    s_cbranch_scc1 P4_comp_91
    s_sub_u32 s70, s40, 4
    s_lshl_b32 s72, s70, 10
    v_add_u32 v7, s72, v1
    s_mul_i32 s77, s70, 3072
    s_mul_i32 s73, s69, 245760
    s_add_u32 s73, s73, s77
    s_lshl_b32 s74, s68, 2
    s_mul_i32 s74, s74, 40960
    s_add_u32 m0, s77, 0
    s_add_u32 s75, s73, 0
    buffer_load_dwordx4 v1, s[44:47], s75 offen sc1 lds
    s_add_u32 m0, s77, 1024
    s_add_u32 s75, s73, 1024
    buffer_load_dwordx4 v1, s[44:47], s75 offen sc1 lds
    s_add_u32 m0, s77, 2048
    s_add_u32 s75, s73, 2048
    buffer_load_dwordx4 v1, s[44:47], s75 offen sc1 lds
    s_add_u32 m0, s77, 12320
    s_add_u32 s75, s73, 12288
    buffer_load_dwordx4 v1, s[44:47], s75 offen sc1 lds
    s_add_u32 m0, s77, 13344
    s_add_u32 s75, s73, 13312
    buffer_load_dwordx4 v1, s[44:47], s75 offen sc1 lds
    s_add_u32 m0, s77, 14368
    s_add_u32 s75, s73, 14336
    buffer_load_dwordx4 v1, s[44:47], s75 offen sc1 lds
    s_add_u32 m0, s77, 24640
    s_add_u32 s75, s73, 24576
    buffer_load_dwordx4 v1, s[44:47], s75 offen sc1 lds
    s_add_u32 m0, s77, 25664
    s_add_u32 s75, s73, 25600
    buffer_load_dwordx4 v1, s[44:47], s75 offen sc1 lds
    s_add_u32 m0, s77, 26688
    s_add_u32 s75, s73, 26624
    buffer_load_dwordx4 v1, s[44:47], s75 offen sc1 lds
    s_add_u32 m0, s77, 36960
    s_add_u32 s75, s73, 36864
    buffer_load_dwordx4 v1, s[44:47], s75 offen sc1 lds
    s_add_u32 m0, s77, 37984
    s_add_u32 s75, s73, 37888
    buffer_load_dwordx4 v1, s[44:47], s75 offen sc1 lds
    s_add_u32 m0, s77, 39008
    s_add_u32 s75, s73, 38912
    buffer_load_dwordx4 v1, s[44:47], s75 offen sc1 lds
    s_add_u32 m0, s77, 49280
    s_add_u32 s75, s73, 49152
    buffer_load_dwordx4 v1, s[44:47], s75 offen sc1 lds
    s_add_u32 m0, s77, 50304
    s_add_u32 s75, s73, 50176
    buffer_load_dwordx4 v1, s[44:47], s75 offen sc1 lds
    s_add_u32 m0, s77, 51328
    s_add_u32 s75, s73, 51200
    buffer_load_dwordx4 v1, s[44:47], s75 offen sc1 lds
    s_add_u32 m0, s77, 61600
    s_add_u32 s75, s73, 61440
    buffer_load_dwordx4 v1, s[44:47], s75 offen sc1 lds
    s_add_u32 m0, s77, 62624
    s_add_u32 s75, s73, 62464
    buffer_load_dwordx4 v1, s[44:47], s75 offen sc1 lds
    s_add_u32 m0, s77, 63648
    s_add_u32 s75, s73, 63488
    buffer_load_dwordx4 v1, s[44:47], s75 offen sc1 lds
    s_barrier
    s_add_u32 m0, s72, 98560
    s_add_u32 s75, s74, 0
    buffer_load_dwordx4 v7, s[48:51], s75 offen sc1 lds
    s_add_u32 m0, s72, 102656
    s_add_u32 s75, s74, 40960
    buffer_load_dwordx4 v7, s[48:51], s75 offen sc1 lds
    s_add_u32 m0, s72, 106752
    s_add_u32 s75, s74, 81920
    buffer_load_dwordx4 v7, s[48:51], s75 offen sc1 lds
    s_add_u32 m0, s72, 110848
    s_add_u32 s75, s74, 122880
    buffer_load_dwordx4 v7, s[48:51], s75 offen sc1 lds
    s_add_u32 m0, s72, 114944
    s_add_u32 s75, s74, 4096
    buffer_load_dwordx4 v7, s[48:51], s75 offen sc1 lds
    s_add_u32 m0, s72, 119040
    s_add_u32 s75, s74, 45056
    buffer_load_dwordx4 v7, s[48:51], s75 offen sc1 lds
    s_add_u32 m0, s72, 123136
    s_add_u32 s75, s74, 86016
    buffer_load_dwordx4 v7, s[48:51], s75 offen sc1 lds
    s_add_u32 m0, s72, 127232
    s_add_u32 s75, s74, 126976
    buffer_load_dwordx4 v7, s[48:51], s75 offen sc1 lds
    s_waitcnt vmcnt(4)
    s_barrier
    s_add_u32 m0, s72, 131328
    s_add_u32 s75, s74, 8192
    buffer_load_dwordx4 v7, s[48:51], s75 offen sc1 lds
    s_add_u32 m0, s72, 135424
    s_add_u32 s75, s74, 49152
    buffer_load_dwordx4 v7, s[48:51], s75 offen sc1 lds
    s_add_u32 m0, s72, 139520
    s_add_u32 s75, s74, 90112
    buffer_load_dwordx4 v7, s[48:51], s75 offen sc1 lds
    s_add_u32 m0, s72, 143616
    s_add_u32 s75, s74, 131072
    buffer_load_dwordx4 v7, s[48:51], s75 offen sc1 lds
    s_add_u32 m0, s77, 73920
    s_add_u32 s75, s73, 73728
    buffer_load_dwordx4 v1, s[44:47], s75 offen sc1 lds
    s_add_u32 m0, s77, 74944
    s_add_u32 s75, s73, 74752
    buffer_load_dwordx4 v1, s[44:47], s75 offen sc1 lds
    s_add_u32 m0, s77, 75968
    s_add_u32 s75, s73, 75776
    buffer_load_dwordx4 v1, s[44:47], s75 offen sc1 lds
    s_add_u32 m0, s77, 86240
    s_add_u32 s75, s73, 86016
    buffer_load_dwordx4 v1, s[44:47], s75 offen sc1 lds
    s_add_u32 m0, s77, 87264
    s_add_u32 s75, s73, 87040
    buffer_load_dwordx4 v1, s[44:47], s75 offen sc1 lds
    s_add_u32 m0, s77, 88288
    s_add_u32 s75, s73, 88064
    buffer_load_dwordx4 v1, s[44:47], s75 offen sc1 lds
    s_waitcnt vmcnt(10)
    s_barrier
    s_add_u32 m0, s72, 98560
    s_add_u32 s75, s74, 12288
    buffer_load_dwordx4 v7, s[48:51], s75 offen sc1 lds
    s_add_u32 m0, s72, 102656
    s_add_u32 s75, s74, 53248
    buffer_load_dwordx4 v7, s[48:51], s75 offen sc1 lds
    s_add_u32 m0, s72, 106752
    s_add_u32 s75, s74, 94208
    buffer_load_dwordx4 v7, s[48:51], s75 offen sc1 lds
    s_add_u32 m0, s72, 110848
    s_add_u32 s75, s74, 135168
    buffer_load_dwordx4 v7, s[48:51], s75 offen sc1 lds
    s_add_u32 m0, s77, 0
    s_add_u32 s75, s73, 98304
    buffer_load_dwordx4 v1, s[44:47], s75 offen sc1 lds
    s_add_u32 m0, s77, 1024
    s_add_u32 s75, s73, 99328
    buffer_load_dwordx4 v1, s[44:47], s75 offen sc1 lds
    s_add_u32 m0, s77, 2048
    s_add_u32 s75, s73, 100352
    buffer_load_dwordx4 v1, s[44:47], s75 offen sc1 lds
    s_add_u32 m0, s77, 12320
    s_add_u32 s75, s73, 110592
    buffer_load_dwordx4 v1, s[44:47], s75 offen sc1 lds
    s_add_u32 m0, s77, 13344
    s_add_u32 s75, s73, 111616
    buffer_load_dwordx4 v1, s[44:47], s75 offen sc1 lds
    s_add_u32 m0, s77, 14368
    s_add_u32 s75, s73, 112640
    buffer_load_dwordx4 v1, s[44:47], s75 offen sc1 lds
    s_waitcnt vmcnt(16)
    s_barrier
    s_add_u32 m0, s72, 114944
    s_add_u32 s75, s74, 16384
    buffer_load_dwordx4 v7, s[48:51], s75 offen sc1 lds
    s_add_u32 m0, s72, 119040
    s_add_u32 s75, s74, 57344
    buffer_load_dwordx4 v7, s[48:51], s75 offen sc1 lds
    s_add_u32 m0, s72, 123136
    s_add_u32 s75, s74, 98304
    buffer_load_dwordx4 v7, s[48:51], s75 offen sc1 lds
    s_add_u32 m0, s72, 127232
    s_add_u32 s75, s74, 139264
    buffer_load_dwordx4 v7, s[48:51], s75 offen sc1 lds
    s_add_u32 m0, s77, 24640
    s_add_u32 s75, s73, 122880
    buffer_load_dwordx4 v1, s[44:47], s75 offen sc1 lds
    s_add_u32 m0, s77, 25664
    s_add_u32 s75, s73, 123904
    buffer_load_dwordx4 v1, s[44:47], s75 offen sc1 lds
    s_add_u32 m0, s77, 26688
    s_add_u32 s75, s73, 124928
    buffer_load_dwordx4 v1, s[44:47], s75 offen sc1 lds
    s_add_u32 m0, s77, 36960
    s_add_u32 s75, s73, 135168
    buffer_load_dwordx4 v1, s[44:47], s75 offen sc1 lds
    s_add_u32 m0, s77, 37984
    s_add_u32 s75, s73, 136192
    buffer_load_dwordx4 v1, s[44:47], s75 offen sc1 lds
    s_add_u32 m0, s77, 39008
    s_add_u32 s75, s73, 137216
    buffer_load_dwordx4 v1, s[44:47], s75 offen sc1 lds
    s_waitcnt vmcnt(16)
    s_barrier
    s_add_u32 m0, s72, 131328
    s_add_u32 s75, s74, 20480
    buffer_load_dwordx4 v7, s[48:51], s75 offen sc1 lds
    s_add_u32 m0, s72, 135424
    s_add_u32 s75, s74, 61440
    buffer_load_dwordx4 v7, s[48:51], s75 offen sc1 lds
    s_add_u32 m0, s72, 139520
    s_add_u32 s75, s74, 102400
    buffer_load_dwordx4 v7, s[48:51], s75 offen sc1 lds
    s_add_u32 m0, s72, 143616
    s_add_u32 s75, s74, 143360
    buffer_load_dwordx4 v7, s[48:51], s75 offen sc1 lds
    s_add_u32 m0, s77, 49280
    s_add_u32 s75, s73, 147456
    buffer_load_dwordx4 v1, s[44:47], s75 offen sc1 lds
    s_add_u32 m0, s77, 50304
    s_add_u32 s75, s73, 148480
    buffer_load_dwordx4 v1, s[44:47], s75 offen sc1 lds
    s_add_u32 m0, s77, 51328
    s_add_u32 s75, s73, 149504
    buffer_load_dwordx4 v1, s[44:47], s75 offen sc1 lds
    s_add_u32 m0, s77, 61600
    s_add_u32 s75, s73, 159744
    buffer_load_dwordx4 v1, s[44:47], s75 offen sc1 lds
    s_add_u32 m0, s77, 62624
    s_add_u32 s75, s73, 160768
    buffer_load_dwordx4 v1, s[44:47], s75 offen sc1 lds
    s_add_u32 m0, s77, 63648
    s_add_u32 s75, s73, 161792
    buffer_load_dwordx4 v1, s[44:47], s75 offen sc1 lds
    s_waitcnt vmcnt(16)
    s_barrier
    s_add_u32 m0, s72, 98560
    s_add_u32 s75, s74, 24576
    buffer_load_dwordx4 v7, s[48:51], s75 offen sc1 lds
    s_add_u32 m0, s72, 102656
    s_add_u32 s75, s74, 65536
    buffer_load_dwordx4 v7, s[48:51], s75 offen sc1 lds
    s_add_u32 m0, s72, 106752
    s_add_u32 s75, s74, 106496
    buffer_load_dwordx4 v7, s[48:51], s75 offen sc1 lds
    s_add_u32 m0, s72, 110848
    s_add_u32 s75, s74, 147456
    buffer_load_dwordx4 v7, s[48:51], s75 offen sc1 lds
    s_add_u32 m0, s77, 73920
    s_add_u32 s75, s73, 172032
    buffer_load_dwordx4 v1, s[44:47], s75 offen sc1 lds
    s_add_u32 m0, s77, 74944
    s_add_u32 s75, s73, 173056
    buffer_load_dwordx4 v1, s[44:47], s75 offen sc1 lds
    s_add_u32 m0, s77, 75968
    s_add_u32 s75, s73, 174080
    buffer_load_dwordx4 v1, s[44:47], s75 offen sc1 lds
    s_add_u32 m0, s77, 86240
    s_add_u32 s75, s73, 184320
    buffer_load_dwordx4 v1, s[44:47], s75 offen sc1 lds
    s_add_u32 m0, s77, 87264
    s_add_u32 s75, s73, 185344
    buffer_load_dwordx4 v1, s[44:47], s75 offen sc1 lds
    s_add_u32 m0, s77, 88288
    s_add_u32 s75, s73, 186368
    buffer_load_dwordx4 v1, s[44:47], s75 offen sc1 lds
    s_waitcnt vmcnt(16)
    s_barrier
    s_add_u32 m0, s72, 114944
    s_add_u32 s75, s74, 28672
    buffer_load_dwordx4 v7, s[48:51], s75 offen sc1 lds
    s_add_u32 m0, s72, 119040
    s_add_u32 s75, s74, 69632
    buffer_load_dwordx4 v7, s[48:51], s75 offen sc1 lds
    s_add_u32 m0, s72, 123136
    s_add_u32 s75, s74, 110592
    buffer_load_dwordx4 v7, s[48:51], s75 offen sc1 lds
    s_add_u32 m0, s72, 127232
    s_add_u32 s75, s74, 151552
    buffer_load_dwordx4 v7, s[48:51], s75 offen sc1 lds
    s_add_u32 m0, s77, 0
    s_add_u32 s75, s73, 196608
    buffer_load_dwordx4 v1, s[44:47], s75 offen sc1 lds
    s_add_u32 m0, s77, 1024
    s_add_u32 s75, s73, 197632
    buffer_load_dwordx4 v1, s[44:47], s75 offen sc1 lds
    s_add_u32 m0, s77, 2048
    s_add_u32 s75, s73, 198656
    buffer_load_dwordx4 v1, s[44:47], s75 offen sc1 lds
    s_add_u32 m0, s77, 12320
    s_add_u32 s75, s73, 208896
    buffer_load_dwordx4 v1, s[44:47], s75 offen sc1 lds
    s_add_u32 m0, s77, 13344
    s_add_u32 s75, s73, 209920
    buffer_load_dwordx4 v1, s[44:47], s75 offen sc1 lds
    s_add_u32 m0, s77, 14368
    s_add_u32 s75, s73, 210944
    buffer_load_dwordx4 v1, s[44:47], s75 offen sc1 lds
    s_waitcnt vmcnt(16)
    s_barrier
    s_add_u32 m0, s72, 131328
    s_add_u32 s75, s74, 32768
    buffer_load_dwordx4 v7, s[48:51], s75 offen sc1 lds
    s_add_u32 m0, s72, 135424
    s_add_u32 s75, s74, 73728
    buffer_load_dwordx4 v7, s[48:51], s75 offen sc1 lds
    s_add_u32 m0, s72, 139520
    s_add_u32 s75, s74, 114688
    buffer_load_dwordx4 v7, s[48:51], s75 offen sc1 lds
    s_add_u32 m0, s72, 143616
    s_add_u32 s75, s74, 155648
    buffer_load_dwordx4 v7, s[48:51], s75 offen sc1 lds
    s_add_u32 m0, s77, 24640
    s_add_u32 s75, s73, 221184
    buffer_load_dwordx4 v1, s[44:47], s75 offen sc1 lds
    s_add_u32 m0, s77, 25664
    s_add_u32 s75, s73, 222208
    buffer_load_dwordx4 v1, s[44:47], s75 offen sc1 lds
    s_add_u32 m0, s77, 26688
    s_add_u32 s75, s73, 223232
    buffer_load_dwordx4 v1, s[44:47], s75 offen sc1 lds
    s_add_u32 m0, s77, 36960
    s_add_u32 s75, s73, 233472
    buffer_load_dwordx4 v1, s[44:47], s75 offen sc1 lds
    s_add_u32 m0, s77, 37984
    s_add_u32 s75, s73, 234496
    buffer_load_dwordx4 v1, s[44:47], s75 offen sc1 lds
    s_add_u32 m0, s77, 39008
    s_add_u32 s75, s73, 235520
    buffer_load_dwordx4 v1, s[44:47], s75 offen sc1 lds
    s_waitcnt vmcnt(16)
    s_barrier
    s_add_u32 m0, s72, 98560
    s_add_u32 s75, s74, 36864
    buffer_load_dwordx4 v7, s[48:51], s75 offen sc1 lds
    s_add_u32 m0, s72, 102656
    s_add_u32 s75, s74, 77824
    buffer_load_dwordx4 v7, s[48:51], s75 offen sc1 lds
    s_add_u32 m0, s72, 106752
    s_add_u32 s75, s74, 118784
    buffer_load_dwordx4 v7, s[48:51], s75 offen sc1 lds
    s_add_u32 m0, s72, 110848
    s_add_u32 s75, s74, 159744
    buffer_load_dwordx4 v7, s[48:51], s75 offen sc1 lds
    s_waitcnt vmcnt(10)
    s_barrier
    s_waitcnt vmcnt(0)
    s_barrier
    s_branch P4_fin_92
P4_comp_91:
    s_add_u32 s60, s38, 0x2500000
    s_addc_u32 s61, s39, 0
    s_mov_b32 s62, 0x600000
    s_mov_b32 s63, 0x20000
    v_bfe_u32 v8, v0, 2, 2
    v_bfe_u32 v9, v0, 4, 1
    v_and_b32 v10, 3, v0
    v_lshl_add_u32 v8, v3, 2, v8
    v_mul_u32_u24 v8, 192, v8
    v_mul_u32_u24 v9, 12320, v9
    v_add_u32 v8, v8, v9
    v_lshl_add_u32 v8, v10, 3, v8
    v_mov_b32 v4, v8
    v_add_u32 v5, 65536, v8
    s_lshl_b32 s71, s40, 12
    s_add_u32 s71, s71, 98560
    v_add_u32 v6, s71, v1
    s_lshl_b32 s71, s68, 4
    v_and_b32 v240, 15, v0
    v_add_u32 v240, s71, v240
    s_cmp_lg_u32 s40, 0
    s_cbranch_scc1 wf_93
    s_cmp_lg_u32 s42, 0
    s_cbranch_scc1 wf_93
    v_lshlrev_b32 v240, 6, v240
    v_add_u32 v240, 49216, v240
    s_mov_b32 s94, 30000
wf_poll_94:
    buffer_load_dword v250, v240, s[96:99], 0 offen sc1
    s_waitcnt vmcnt(0)
    v_cmp_ne_u32 vcc, s41, v250
    s_nop 1
    s_cbranch_vccz wf_93
    s_sleep 1
    s_sub_u32 s94, s94, 1
    s_cmp_lg_u32 s94, 0
    s_cbranch_scc1 wf_poll_94
wf_done_95:
    s_mov_b32 s42, 1
wf_93:
    s_barrier
    s_barrier
    ds_read_b128 v[40:43], v6 offset:0
    ds_read_b64_tr_b16 v[16:17], v4 offset:0
    ds_read_b64_tr_b16 v[18:19], v4 offset:1536
    ds_read_b64_tr_b16 v[20:21], v4 offset:32
    ds_read_b64_tr_b16 v[22:23], v4 offset:1568
    ds_read_b64_tr_b16 v[24:25], v4 offset:64
    ds_read_b64_tr_b16 v[26:27], v4 offset:1600
    ds_read_b64_tr_b16 v[28:29], v4 offset:96
    ds_read_b64_tr_b16 v[30:31], v4 offset:1632
    ds_read_b64_tr_b16 v[32:33], v4 offset:128
    ds_read_b64_tr_b16 v[34:35], v4 offset:1664
    ds_read_b64_tr_b16 v[36:37], v4 offset:160
    ds_read_b64_tr_b16 v[38:39], v4 offset:1696
    s_waitcnt lgkmcnt(10)
    v_mfma_f32_32x32x16_bf16 v[64:79], v[16:19], v[40:43], 0
    ds_read_b128 v[44:47], v6 offset:1024
    ds_read_b64_tr_b16 v[16:17], v4 offset:3072
    ds_read_b64_tr_b16 v[18:19], v4 offset:4608
    s_waitcnt lgkmcnt(11)
    v_mfma_f32_32x32x16_bf16 v[80:95], v[20:23], v[40:43], 0
    ds_read_b64_tr_b16 v[20:21], v4 offset:3104
    ds_read_b64_tr_b16 v[22:23], v4 offset:4640
    s_waitcnt lgkmcnt(11)
    v_mfma_f32_32x32x16_bf16 v[96:111], v[24:27], v[40:43], 0
    ds_read_b64_tr_b16 v[24:25], v4 offset:3136
    ds_read_b64_tr_b16 v[26:27], v4 offset:4672
    s_waitcnt lgkmcnt(11)
    v_mfma_f32_32x32x16_bf16 v[112:127], v[28:31], v[40:43], 0
    ds_read_b64_tr_b16 v[28:29], v4 offset:3168
    ds_read_b64_tr_b16 v[30:31], v4 offset:4704
    s_waitcnt lgkmcnt(11)
    v_mfma_f32_32x32x16_bf16 v[128:143], v[32:35], v[40:43], 0
    ds_read_b64_tr_b16 v[32:33], v4 offset:3200
    ds_read_b64_tr_b16 v[34:35], v4 offset:4736
    s_waitcnt lgkmcnt(11)
    v_mfma_f32_32x32x16_bf16 v[144:159], v[36:39], v[40:43], 0
    ds_read_b64_tr_b16 v[36:37], v4 offset:3232
    ds_read_b64_tr_b16 v[38:39], v4 offset:4768
    s_waitcnt lgkmcnt(10)
    v_mfma_f32_32x32x16_bf16 v[64:79], v[16:19], v[44:47], v[64:79]
    ds_read_b128 v[40:43], v6 offset:2048
    ds_read_b64_tr_b16 v[16:17], v4 offset:6144
    ds_read_b64_tr_b16 v[18:19], v4 offset:7680
    s_waitcnt lgkmcnt(11)
    v_mfma_f32_32x32x16_bf16 v[80:95], v[20:23], v[44:47], v[80:95]
    ds_read_b64_tr_b16 v[20:21], v4 offset:6176
    ds_read_b64_tr_b16 v[22:23], v4 offset:7712
    s_waitcnt lgkmcnt(11)
    v_mfma_f32_32x32x16_bf16 v[96:111], v[24:27], v[44:47], v[96:111]
    ds_read_b64_tr_b16 v[24:25], v4 offset:6208
    ds_read_b64_tr_b16 v[26:27], v4 offset:7744
    s_waitcnt lgkmcnt(11)
    v_mfma_f32_32x32x16_bf16 v[112:127], v[28:31], v[44:47], v[112:127]
    ds_read_b64_tr_b16 v[28:29], v4 offset:6240
    ds_read_b64_tr_b16 v[30:31], v4 offset:7776
    s_waitcnt lgkmcnt(11)
    v_mfma_f32_32x32x16_bf16 v[128:143], v[32:35], v[44:47], v[128:143]
    ds_read_b64_tr_b16 v[32:33], v4 offset:6272
    ds_read_b64_tr_b16 v[34:35], v4 offset:7808
    s_waitcnt lgkmcnt(11)
    v_mfma_f32_32x32x16_bf16 v[144:159], v[36:39], v[44:47], v[144:159]
    ds_read_b64_tr_b16 v[36:37], v4 offset:6304
    ds_read_b64_tr_b16 v[38:39], v4 offset:7840
    s_waitcnt lgkmcnt(10)
    v_mfma_f32_32x32x16_bf16 v[64:79], v[16:19], v[40:43], v[64:79]
    ds_read_b128 v[44:47], v6 offset:3072
    ds_read_b64_tr_b16 v[16:17], v4 offset:9216
    ds_read_b64_tr_b16 v[18:19], v4 offset:10752
    s_waitcnt lgkmcnt(11)
    v_mfma_f32_32x32x16_bf16 v[80:95], v[20:23], v[40:43], v[80:95]
    ds_read_b64_tr_b16 v[20:21], v4 offset:9248
    ds_read_b64_tr_b16 v[22:23], v4 offset:10784
    s_waitcnt lgkmcnt(11)
    v_mfma_f32_32x32x16_bf16 v[96:111], v[24:27], v[40:43], v[96:111]
    ds_read_b64_tr_b16 v[24:25], v4 offset:9280
    ds_read_b64_tr_b16 v[26:27], v4 offset:10816
    s_waitcnt lgkmcnt(11)
    v_mfma_f32_32x32x16_bf16 v[112:127], v[28:31], v[40:43], v[112:127]
    ds_read_b64_tr_b16 v[28:29], v4 offset:9312
    ds_read_b64_tr_b16 v[30:31], v4 offset:10848
    s_waitcnt lgkmcnt(11)
    v_mfma_f32_32x32x16_bf16 v[128:143], v[32:35], v[40:43], v[128:143]
    ds_read_b64_tr_b16 v[32:33], v4 offset:9344
    ds_read_b64_tr_b16 v[34:35], v4 offset:10880
    s_waitcnt lgkmcnt(11)
    v_mfma_f32_32x32x16_bf16 v[144:159], v[36:39], v[40:43], v[144:159]
    ds_read_b64_tr_b16 v[36:37], v4 offset:9376
    ds_read_b64_tr_b16 v[38:39], v4 offset:10912
    s_waitcnt lgkmcnt(10)
    v_mfma_f32_32x32x16_bf16 v[64:79], v[16:19], v[44:47], v[64:79]
    s_waitcnt lgkmcnt(8)
    v_mfma_f32_32x32x16_bf16 v[80:95], v[20:23], v[44:47], v[80:95]
    s_waitcnt lgkmcnt(0)
    s_barrier
    ds_read_b128 v[40:43], v6 offset:16384
    ds_read_b64_tr_b16 v[16:17], v4 offset:24640
    ds_read_b64_tr_b16 v[18:19], v4 offset:26176
    ds_read_b64_tr_b16 v[20:21], v4 offset:24672
    ds_read_b64_tr_b16 v[22:23], v4 offset:26208
    v_mfma_f32_32x32x16_bf16 v[96:111], v[24:27], v[44:47], v[96:111]
    ds_read_b64_tr_b16 v[24:25], v4 offset:24704
    ds_read_b64_tr_b16 v[26:27], v4 offset:26240
    v_mfma_f32_32x32x16_bf16 v[112:127], v[28:31], v[44:47], v[112:127]
    ds_read_b64_tr_b16 v[28:29], v4 offset:24736
    ds_read_b64_tr_b16 v[30:31], v4 offset:26272
    v_mfma_f32_32x32x16_bf16 v[128:143], v[32:35], v[44:47], v[128:143]
    ds_read_b64_tr_b16 v[32:33], v4 offset:24768
    ds_read_b64_tr_b16 v[34:35], v4 offset:26304
    v_mfma_f32_32x32x16_bf16 v[144:159], v[36:39], v[44:47], v[144:159]
    ds_read_b64_tr_b16 v[36:37], v4 offset:24800
    ds_read_b64_tr_b16 v[38:39], v4 offset:26336
    s_waitcnt lgkmcnt(10)
    v_mfma_f32_32x32x16_bf16 v[64:79], v[16:19], v[40:43], v[64:79]
    ds_read_b128 v[44:47], v6 offset:17408
    ds_read_b64_tr_b16 v[16:17], v4 offset:27712
    ds_read_b64_tr_b16 v[18:19], v4 offset:29248
    s_waitcnt lgkmcnt(11)
    v_mfma_f32_32x32x16_bf16 v[80:95], v[20:23], v[40:43], v[80:95]
    ds_read_b64_tr_b16 v[20:21], v4 offset:27744
    ds_read_b64_tr_b16 v[22:23], v4 offset:29280
    s_waitcnt lgkmcnt(11)
    v_mfma_f32_32x32x16_bf16 v[96:111], v[24:27], v[40:43], v[96:111]
    ds_read_b64_tr_b16 v[24:25], v4 offset:27776
    ds_read_b64_tr_b16 v[26:27], v4 offset:29312
    s_waitcnt lgkmcnt(11)
    v_mfma_f32_32x32x16_bf16 v[112:127], v[28:31], v[40:43], v[112:127]
    ds_read_b64_tr_b16 v[28:29], v4 offset:27808
    ds_read_b64_tr_b16 v[30:31], v4 offset:29344
    s_waitcnt lgkmcnt(11)
    v_mfma_f32_32x32x16_bf16 v[128:143], v[32:35], v[40:43], v[128:143]
    ds_read_b64_tr_b16 v[32:33], v4 offset:27840
    ds_read_b64_tr_b16 v[34:35], v4 offset:29376
    s_waitcnt lgkmcnt(11)
    v_mfma_f32_32x32x16_bf16 v[144:159], v[36:39], v[40:43], v[144:159]
    ds_read_b64_tr_b16 v[36:37], v4 offset:27872
    ds_read_b64_tr_b16 v[38:39], v4 offset:29408
    s_waitcnt lgkmcnt(10)
    v_mfma_f32_32x32x16_bf16 v[64:79], v[16:19], v[44:47], v[64:79]
    ds_read_b128 v[40:43], v6 offset:18432
    ds_read_b64_tr_b16 v[16:17], v4 offset:30784
    ds_read_b64_tr_b16 v[18:19], v4 offset:32320
    s_waitcnt lgkmcnt(11)
    v_mfma_f32_32x32x16_bf16 v[80:95], v[20:23], v[44:47], v[80:95]
    ds_read_b64_tr_b16 v[20:21], v4 offset:30816
    ds_read_b64_tr_b16 v[22:23], v4 offset:32352
    s_waitcnt lgkmcnt(11)
    v_mfma_f32_32x32x16_bf16 v[96:111], v[24:27], v[44:47], v[96:111]
    ds_read_b64_tr_b16 v[24:25], v4 offset:30848
    ds_read_b64_tr_b16 v[26:27], v4 offset:32384
    s_waitcnt lgkmcnt(11)
    v_mfma_f32_32x32x16_bf16 v[112:127], v[28:31], v[44:47], v[112:127]
    ds_read_b64_tr_b16 v[28:29], v4 offset:30880
    ds_read_b64_tr_b16 v[30:31], v4 offset:32416
    s_waitcnt lgkmcnt(11)
    v_mfma_f32_32x32x16_bf16 v[128:143], v[32:35], v[44:47], v[128:143]
    ds_read_b64_tr_b16 v[32:33], v4 offset:30912
    ds_read_b64_tr_b16 v[34:35], v4 offset:32448
    s_waitcnt lgkmcnt(11)
    v_mfma_f32_32x32x16_bf16 v[144:159], v[36:39], v[44:47], v[144:159]
    ds_read_b64_tr_b16 v[36:37], v4 offset:30944
    ds_read_b64_tr_b16 v[38:39], v4 offset:32480
    s_waitcnt lgkmcnt(10)
    v_mfma_f32_32x32x16_bf16 v[64:79], v[16:19], v[40:43], v[64:79]
    ds_read_b128 v[44:47], v6 offset:19456
    ds_read_b64_tr_b16 v[16:17], v4 offset:33856
    ds_read_b64_tr_b16 v[18:19], v4 offset:35392
    s_waitcnt lgkmcnt(11)
    v_mfma_f32_32x32x16_bf16 v[80:95], v[20:23], v[40:43], v[80:95]
    ds_read_b64_tr_b16 v[20:21], v4 offset:33888
    ds_read_b64_tr_b16 v[22:23], v4 offset:35424
    s_waitcnt lgkmcnt(11)
    v_mfma_f32_32x32x16_bf16 v[96:111], v[24:27], v[40:43], v[96:111]
    ds_read_b64_tr_b16 v[24:25], v4 offset:33920
    ds_read_b64_tr_b16 v[26:27], v4 offset:35456
    s_waitcnt lgkmcnt(11)
    v_mfma_f32_32x32x16_bf16 v[112:127], v[28:31], v[40:43], v[112:127]
    ds_read_b64_tr_b16 v[28:29], v4 offset:33952
    ds_read_b64_tr_b16 v[30:31], v4 offset:35488
    s_waitcnt lgkmcnt(11)
    v_mfma_f32_32x32x16_bf16 v[128:143], v[32:35], v[40:43], v[128:143]
    ds_read_b64_tr_b16 v[32:33], v4 offset:33984
    ds_read_b64_tr_b16 v[34:35], v4 offset:35520
    s_waitcnt lgkmcnt(11)
    v_mfma_f32_32x32x16_bf16 v[144:159], v[36:39], v[40:43], v[144:159]
    ds_read_b64_tr_b16 v[36:37], v4 offset:34016
    ds_read_b64_tr_b16 v[38:39], v4 offset:35552
    s_waitcnt lgkmcnt(10)
    v_mfma_f32_32x32x16_bf16 v[64:79], v[16:19], v[44:47], v[64:79]
    s_waitcnt lgkmcnt(8)
    v_mfma_f32_32x32x16_bf16 v[80:95], v[20:23], v[44:47], v[80:95]
    s_waitcnt lgkmcnt(0)
    s_barrier
    ds_read_b128 v[40:43], v6 offset:32768
    ds_read_b64_tr_b16 v[16:17], v4 offset:49280
    ds_read_b64_tr_b16 v[18:19], v4 offset:50816
    ds_read_b64_tr_b16 v[20:21], v4 offset:49312
    ds_read_b64_tr_b16 v[22:23], v4 offset:50848
    v_mfma_f32_32x32x16_bf16 v[96:111], v[24:27], v[44:47], v[96:111]
    ds_read_b64_tr_b16 v[24:25], v4 offset:49344
    ds_read_b64_tr_b16 v[26:27], v4 offset:50880
    v_mfma_f32_32x32x16_bf16 v[112:127], v[28:31], v[44:47], v[112:127]
    ds_read_b64_tr_b16 v[28:29], v4 offset:49376
    ds_read_b64_tr_b16 v[30:31], v4 offset:50912
    v_mfma_f32_32x32x16_bf16 v[128:143], v[32:35], v[44:47], v[128:143]
    ds_read_b64_tr_b16 v[32:33], v4 offset:49408
    ds_read_b64_tr_b16 v[34:35], v4 offset:50944
    v_mfma_f32_32x32x16_bf16 v[144:159], v[36:39], v[44:47], v[144:159]
    ds_read_b64_tr_b16 v[36:37], v4 offset:49440
    ds_read_b64_tr_b16 v[38:39], v4 offset:50976
    s_waitcnt lgkmcnt(10)
    v_mfma_f32_32x32x16_bf16 v[64:79], v[16:19], v[40:43], v[64:79]
    ds_read_b128 v[44:47], v6 offset:33792
    ds_read_b64_tr_b16 v[16:17], v4 offset:52352
    ds_read_b64_tr_b16 v[18:19], v4 offset:53888
    s_waitcnt lgkmcnt(11)
    v_mfma_f32_32x32x16_bf16 v[80:95], v[20:23], v[40:43], v[80:95]
    ds_read_b64_tr_b16 v[20:21], v4 offset:52384
    ds_read_b64_tr_b16 v[22:23], v4 offset:53920
    s_waitcnt lgkmcnt(11)
    v_mfma_f32_32x32x16_bf16 v[96:111], v[24:27], v[40:43], v[96:111]
    ds_read_b64_tr_b16 v[24:25], v4 offset:52416
    ds_read_b64_tr_b16 v[26:27], v4 offset:53952
    s_waitcnt lgkmcnt(11)
    v_mfma_f32_32x32x16_bf16 v[112:127], v[28:31], v[40:43], v[112:127]
    ds_read_b64_tr_b16 v[28:29], v4 offset:52448
    ds_read_b64_tr_b16 v[30:31], v4 offset:53984
    s_waitcnt lgkmcnt(11)
    v_mfma_f32_32x32x16_bf16 v[128:143], v[32:35], v[40:43], v[128:143]
    ds_read_b64_tr_b16 v[32:33], v4 offset:52480
    ds_read_b64_tr_b16 v[34:35], v4 offset:54016
    s_waitcnt lgkmcnt(11)
    v_mfma_f32_32x32x16_bf16 v[144:159], v[36:39], v[40:43], v[144:159]
    ds_read_b64_tr_b16 v[36:37], v4 offset:52512
    ds_read_b64_tr_b16 v[38:39], v4 offset:54048
    s_waitcnt lgkmcnt(10)
    v_mfma_f32_32x32x16_bf16 v[64:79], v[16:19], v[44:47], v[64:79]
    ds_read_b128 v[40:43], v6 offset:34816
    ds_read_b64_tr_b16 v[16:17], v4 offset:55424
    ds_read_b64_tr_b16 v[18:19], v4 offset:56960
    s_waitcnt lgkmcnt(11)
    v_mfma_f32_32x32x16_bf16 v[80:95], v[20:23], v[44:47], v[80:95]
    ds_read_b64_tr_b16 v[20:21], v4 offset:55456
    ds_read_b64_tr_b16 v[22:23], v4 offset:56992
    s_waitcnt lgkmcnt(11)
    v_mfma_f32_32x32x16_bf16 v[96:111], v[24:27], v[44:47], v[96:111]
    ds_read_b64_tr_b16 v[24:25], v4 offset:55488
    ds_read_b64_tr_b16 v[26:27], v4 offset:57024
    s_waitcnt lgkmcnt(11)
    v_mfma_f32_32x32x16_bf16 v[112:127], v[28:31], v[44:47], v[112:127]
    ds_read_b64_tr_b16 v[28:29], v4 offset:55520
    ds_read_b64_tr_b16 v[30:31], v4 offset:57056
    s_waitcnt lgkmcnt(11)
    v_mfma_f32_32x32x16_bf16 v[128:143], v[32:35], v[44:47], v[128:143]
    ds_read_b64_tr_b16 v[32:33], v4 offset:55552
    ds_read_b64_tr_b16 v[34:35], v4 offset:57088
    s_waitcnt lgkmcnt(11)
    v_mfma_f32_32x32x16_bf16 v[144:159], v[36:39], v[44:47], v[144:159]
    ds_read_b64_tr_b16 v[36:37], v4 offset:55584
    ds_read_b64_tr_b16 v[38:39], v4 offset:57120
    s_waitcnt lgkmcnt(10)
    v_mfma_f32_32x32x16_bf16 v[64:79], v[16:19], v[40:43], v[64:79]
    ds_read_b128 v[44:47], v6 offset:35840
    ds_read_b64_tr_b16 v[16:17], v4 offset:58496
    ds_read_b64_tr_b16 v[18:19], v4 offset:60032
    s_waitcnt lgkmcnt(11)
    v_mfma_f32_32x32x16_bf16 v[80:95], v[20:23], v[40:43], v[80:95]
    ds_read_b64_tr_b16 v[20:21], v4 offset:58528
    ds_read_b64_tr_b16 v[22:23], v4 offset:60064
    s_waitcnt lgkmcnt(11)
    v_mfma_f32_32x32x16_bf16 v[96:111], v[24:27], v[40:43], v[96:111]
    ds_read_b64_tr_b16 v[24:25], v4 offset:58560
    ds_read_b64_tr_b16 v[26:27], v4 offset:60096
    s_waitcnt lgkmcnt(11)
    v_mfma_f32_32x32x16_bf16 v[112:127], v[28:31], v[40:43], v[112:127]
    ds_read_b64_tr_b16 v[28:29], v4 offset:58592
    ds_read_b64_tr_b16 v[30:31], v4 offset:60128
    s_waitcnt lgkmcnt(11)
    v_mfma_f32_32x32x16_bf16 v[128:143], v[32:35], v[40:43], v[128:143]
    ds_read_b64_tr_b16 v[32:33], v4 offset:58624
    ds_read_b64_tr_b16 v[34:35], v4 offset:60160
    s_waitcnt lgkmcnt(11)
    v_mfma_f32_32x32x16_bf16 v[144:159], v[36:39], v[40:43], v[144:159]
    ds_read_b64_tr_b16 v[36:37], v4 offset:58656
    ds_read_b64_tr_b16 v[38:39], v4 offset:60192
    s_waitcnt lgkmcnt(10)
    v_mfma_f32_32x32x16_bf16 v[64:79], v[16:19], v[44:47], v[64:79]
    s_waitcnt lgkmcnt(8)
    v_mfma_f32_32x32x16_bf16 v[80:95], v[20:23], v[44:47], v[80:95]
    s_waitcnt lgkmcnt(0)
    s_barrier
    ds_read_b128 v[40:43], v6 offset:0
    ds_read_b64_tr_b16 v[16:17], v5 offset:8384
    ds_read_b64_tr_b16 v[18:19], v5 offset:9920
    ds_read_b64_tr_b16 v[20:21], v5 offset:8416
    ds_read_b64_tr_b16 v[22:23], v5 offset:9952
    v_mfma_f32_32x32x16_bf16 v[96:111], v[24:27], v[44:47], v[96:111]
    ds_read_b64_tr_b16 v[24:25], v5 offset:8448
    ds_read_b64_tr_b16 v[26:27], v5 offset:9984
    v_mfma_f32_32x32x16_bf16 v[112:127], v[28:31], v[44:47], v[112:127]
    ds_read_b64_tr_b16 v[28:29], v5 offset:8480
    ds_read_b64_tr_b16 v[30:31], v5 offset:10016
    v_mfma_f32_32x32x16_bf16 v[128:143], v[32:35], v[44:47], v[128:143]
    ds_read_b64_tr_b16 v[32:33], v5 offset:8512
    ds_read_b64_tr_b16 v[34:35], v5 offset:10048
    v_mfma_f32_32x32x16_bf16 v[144:159], v[36:39], v[44:47], v[144:159]
    ds_read_b64_tr_b16 v[36:37], v5 offset:8544
    ds_read_b64_tr_b16 v[38:39], v5 offset:10080
    s_waitcnt lgkmcnt(10)
    v_mfma_f32_32x32x16_bf16 v[64:79], v[16:19], v[40:43], v[64:79]
    ds_read_b128 v[44:47], v6 offset:1024
    ds_read_b64_tr_b16 v[16:17], v5 offset:11456
    ds_read_b64_tr_b16 v[18:19], v5 offset:12992
    s_waitcnt lgkmcnt(11)
    v_mfma_f32_32x32x16_bf16 v[80:95], v[20:23], v[40:43], v[80:95]
    ds_read_b64_tr_b16 v[20:21], v5 offset:11488
    ds_read_b64_tr_b16 v[22:23], v5 offset:13024
    s_waitcnt lgkmcnt(11)
    v_mfma_f32_32x32x16_bf16 v[96:111], v[24:27], v[40:43], v[96:111]
    ds_read_b64_tr_b16 v[24:25], v5 offset:11520
    ds_read_b64_tr_b16 v[26:27], v5 offset:13056
    s_waitcnt lgkmcnt(11)
    v_mfma_f32_32x32x16_bf16 v[112:127], v[28:31], v[40:43], v[112:127]
    ds_read_b64_tr_b16 v[28:29], v5 offset:11552
    ds_read_b64_tr_b16 v[30:31], v5 offset:13088
    s_waitcnt lgkmcnt(11)
    v_mfma_f32_32x32x16_bf16 v[128:143], v[32:35], v[40:43], v[128:143]
    ds_read_b64_tr_b16 v[32:33], v5 offset:11584
    ds_read_b64_tr_b16 v[34:35], v5 offset:13120
    s_waitcnt lgkmcnt(11)
    v_mfma_f32_32x32x16_bf16 v[144:159], v[36:39], v[40:43], v[144:159]
    ds_read_b64_tr_b16 v[36:37], v5 offset:11616
    ds_read_b64_tr_b16 v[38:39], v5 offset:13152
    s_waitcnt lgkmcnt(10)
    v_mfma_f32_32x32x16_bf16 v[64:79], v[16:19], v[44:47], v[64:79]
    ds_read_b128 v[40:43], v6 offset:2048
    ds_read_b64_tr_b16 v[16:17], v5 offset:14528
    ds_read_b64_tr_b16 v[18:19], v5 offset:16064
    s_waitcnt lgkmcnt(11)
    v_mfma_f32_32x32x16_bf16 v[80:95], v[20:23], v[44:47], v[80:95]
    ds_read_b64_tr_b16 v[20:21], v5 offset:14560
    ds_read_b64_tr_b16 v[22:23], v5 offset:16096
    s_waitcnt lgkmcnt(11)
    v_mfma_f32_32x32x16_bf16 v[96:111], v[24:27], v[44:47], v[96:111]
    ds_read_b64_tr_b16 v[24:25], v5 offset:14592
    ds_read_b64_tr_b16 v[26:27], v5 offset:16128
    s_waitcnt lgkmcnt(11)
    v_mfma_f32_32x32x16_bf16 v[112:127], v[28:31], v[44:47], v[112:127]
    ds_read_b64_tr_b16 v[28:29], v5 offset:14624
    ds_read_b64_tr_b16 v[30:31], v5 offset:16160
    s_waitcnt lgkmcnt(11)
    v_mfma_f32_32x32x16_bf16 v[128:143], v[32:35], v[44:47], v[128:143]
    ds_read_b64_tr_b16 v[32:33], v5 offset:14656
    ds_read_b64_tr_b16 v[34:35], v5 offset:16192
    s_waitcnt lgkmcnt(11)
    v_mfma_f32_32x32x16_bf16 v[144:159], v[36:39], v[44:47], v[144:159]
    ds_read_b64_tr_b16 v[36:37], v5 offset:14688
    ds_read_b64_tr_b16 v[38:39], v5 offset:16224
    s_waitcnt lgkmcnt(10)
    v_mfma_f32_32x32x16_bf16 v[64:79], v[16:19], v[40:43], v[64:79]
    ds_read_b128 v[44:47], v6 offset:3072
    ds_read_b64_tr_b16 v[16:17], v5 offset:17600
    ds_read_b64_tr_b16 v[18:19], v5 offset:19136
    s_waitcnt lgkmcnt(11)
    v_mfma_f32_32x32x16_bf16 v[80:95], v[20:23], v[40:43], v[80:95]
    ds_read_b64_tr_b16 v[20:21], v5 offset:17632
    ds_read_b64_tr_b16 v[22:23], v5 offset:19168
    s_waitcnt lgkmcnt(11)
    v_mfma_f32_32x32x16_bf16 v[96:111], v[24:27], v[40:43], v[96:111]
    ds_read_b64_tr_b16 v[24:25], v5 offset:17664
    ds_read_b64_tr_b16 v[26:27], v5 offset:19200
    s_waitcnt lgkmcnt(11)
    v_mfma_f32_32x32x16_bf16 v[112:127], v[28:31], v[40:43], v[112:127]
    ds_read_b64_tr_b16 v[28:29], v5 offset:17696
    ds_read_b64_tr_b16 v[30:31], v5 offset:19232
    s_waitcnt lgkmcnt(11)
    v_mfma_f32_32x32x16_bf16 v[128:143], v[32:35], v[40:43], v[128:143]
    ds_read_b64_tr_b16 v[32:33], v5 offset:17728
    ds_read_b64_tr_b16 v[34:35], v5 offset:19264
    s_waitcnt lgkmcnt(11)
    v_mfma_f32_32x32x16_bf16 v[144:159], v[36:39], v[40:43], v[144:159]
    ds_read_b64_tr_b16 v[36:37], v5 offset:17760
    ds_read_b64_tr_b16 v[38:39], v5 offset:19296
    s_waitcnt lgkmcnt(10)
    v_mfma_f32_32x32x16_bf16 v[64:79], v[16:19], v[44:47], v[64:79]
    s_waitcnt lgkmcnt(8)
    v_mfma_f32_32x32x16_bf16 v[80:95], v[20:23], v[44:47], v[80:95]
    s_waitcnt lgkmcnt(0)
    s_barrier
    ds_read_b128 v[40:43], v6 offset:16384
    ds_read_b64_tr_b16 v[16:17], v4 offset:0
    ds_read_b64_tr_b16 v[18:19], v4 offset:1536
    ds_read_b64_tr_b16 v[20:21], v4 offset:32
    ds_read_b64_tr_b16 v[22:23], v4 offset:1568
    v_mfma_f32_32x32x16_bf16 v[96:111], v[24:27], v[44:47], v[96:111]
    ds_read_b64_tr_b16 v[24:25], v4 offset:64
    ds_read_b64_tr_b16 v[26:27], v4 offset:1600
    v_mfma_f32_32x32x16_bf16 v[112:127], v[28:31], v[44:47], v[112:127]
    ds_read_b64_tr_b16 v[28:29], v4 offset:96
    ds_read_b64_tr_b16 v[30:31], v4 offset:1632
    v_mfma_f32_32x32x16_bf16 v[128:143], v[32:35], v[44:47], v[128:143]
    ds_read_b64_tr_b16 v[32:33], v4 offset:128
    ds_read_b64_tr_b16 v[34:35], v4 offset:1664
    v_mfma_f32_32x32x16_bf16 v[144:159], v[36:39], v[44:47], v[144:159]
    ds_read_b64_tr_b16 v[36:37], v4 offset:160
    ds_read_b64_tr_b16 v[38:39], v4 offset:1696
    s_waitcnt lgkmcnt(10)
    v_mfma_f32_32x32x16_bf16 v[64:79], v[16:19], v[40:43], v[64:79]
    ds_read_b128 v[44:47], v6 offset:17408
    ds_read_b64_tr_b16 v[16:17], v4 offset:3072
    ds_read_b64_tr_b16 v[18:19], v4 offset:4608
    s_waitcnt lgkmcnt(11)
    v_mfma_f32_32x32x16_bf16 v[80:95], v[20:23], v[40:43], v[80:95]
    ds_read_b64_tr_b16 v[20:21], v4 offset:3104
    ds_read_b64_tr_b16 v[22:23], v4 offset:4640
    s_waitcnt lgkmcnt(11)
    v_mfma_f32_32x32x16_bf16 v[96:111], v[24:27], v[40:43], v[96:111]
    ds_read_b64_tr_b16 v[24:25], v4 offset:3136
    ds_read_b64_tr_b16 v[26:27], v4 offset:4672
    s_waitcnt lgkmcnt(11)
    v_mfma_f32_32x32x16_bf16 v[112:127], v[28:31], v[40:43], v[112:127]
    ds_read_b64_tr_b16 v[28:29], v4 offset:3168
    ds_read_b64_tr_b16 v[30:31], v4 offset:4704
    s_waitcnt lgkmcnt(11)
    v_mfma_f32_32x32x16_bf16 v[128:143], v[32:35], v[40:43], v[128:143]
    ds_read_b64_tr_b16 v[32:33], v4 offset:3200
    ds_read_b64_tr_b16 v[34:35], v4 offset:4736
    s_waitcnt lgkmcnt(11)
    v_mfma_f32_32x32x16_bf16 v[144:159], v[36:39], v[40:43], v[144:159]
    ds_read_b64_tr_b16 v[36:37], v4 offset:3232
    ds_read_b64_tr_b16 v[38:39], v4 offset:4768
    s_waitcnt lgkmcnt(10)
    v_mfma_f32_32x32x16_bf16 v[64:79], v[16:19], v[44:47], v[64:79]
    ds_read_b128 v[40:43], v6 offset:18432
    ds_read_b64_tr_b16 v[16:17], v4 offset:6144
    ds_read_b64_tr_b16 v[18:19], v4 offset:7680
    s_waitcnt lgkmcnt(11)
    v_mfma_f32_32x32x16_bf16 v[80:95], v[20:23], v[44:47], v[80:95]
    ds_read_b64_tr_b16 v[20:21], v4 offset:6176
    ds_read_b64_tr_b16 v[22:23], v4 offset:7712
    s_waitcnt lgkmcnt(11)
    v_mfma_f32_32x32x16_bf16 v[96:111], v[24:27], v[44:47], v[96:111]
    ds_read_b64_tr_b16 v[24:25], v4 offset:6208
    ds_read_b64_tr_b16 v[26:27], v4 offset:7744
    s_waitcnt lgkmcnt(11)
    v_mfma_f32_32x32x16_bf16 v[112:127], v[28:31], v[44:47], v[112:127]
    ds_read_b64_tr_b16 v[28:29], v4 offset:6240
    ds_read_b64_tr_b16 v[30:31], v4 offset:7776
    s_waitcnt lgkmcnt(11)
    v_mfma_f32_32x32x16_bf16 v[128:143], v[32:35], v[44:47], v[128:143]
    ds_read_b64_tr_b16 v[32:33], v4 offset:6272
    ds_read_b64_tr_b16 v[34:35], v4 offset:7808
    s_waitcnt lgkmcnt(11)
    v_mfma_f32_32x32x16_bf16 v[144:159], v[36:39], v[44:47], v[144:159]
    ds_read_b64_tr_b16 v[36:37], v4 offset:6304
    ds_read_b64_tr_b16 v[38:39], v4 offset:7840
    s_waitcnt lgkmcnt(10)
    v_mfma_f32_32x32x16_bf16 v[64:79], v[16:19], v[40:43], v[64:79]
    ds_read_b128 v[44:47], v6 offset:19456
    ds_read_b64_tr_b16 v[16:17], v4 offset:9216
    ds_read_b64_tr_b16 v[18:19], v4 offset:10752
    s_waitcnt lgkmcnt(11)
    v_mfma_f32_32x32x16_bf16 v[80:95], v[20:23], v[40:43], v[80:95]
    ds_read_b64_tr_b16 v[20:21], v4 offset:9248
    ds_read_b64_tr_b16 v[22:23], v4 offset:10784
    s_waitcnt lgkmcnt(11)
    v_mfma_f32_32x32x16_bf16 v[96:111], v[24:27], v[40:43], v[96:111]
    ds_read_b64_tr_b16 v[24:25], v4 offset:9280
    ds_read_b64_tr_b16 v[26:27], v4 offset:10816
    s_waitcnt lgkmcnt(11)
    v_mfma_f32_32x32x16_bf16 v[112:127], v[28:31], v[40:43], v[112:127]
    ds_read_b64_tr_b16 v[28:29], v4 offset:9312
    ds_read_b64_tr_b16 v[30:31], v4 offset:10848
    s_waitcnt lgkmcnt(11)
    v_mfma_f32_32x32x16_bf16 v[128:143], v[32:35], v[40:43], v[128:143]
    ds_read_b64_tr_b16 v[32:33], v4 offset:9344
    ds_read_b64_tr_b16 v[34:35], v4 offset:10880
    s_waitcnt lgkmcnt(11)
    v_mfma_f32_32x32x16_bf16 v[144:159], v[36:39], v[40:43], v[144:159]
    ds_read_b64_tr_b16 v[36:37], v4 offset:9376
    ds_read_b64_tr_b16 v[38:39], v4 offset:10912
    s_waitcnt lgkmcnt(10)
    v_mfma_f32_32x32x16_bf16 v[64:79], v[16:19], v[44:47], v[64:79]
    s_waitcnt lgkmcnt(8)
    v_mfma_f32_32x32x16_bf16 v[80:95], v[20:23], v[44:47], v[80:95]
    s_waitcnt lgkmcnt(0)
    s_barrier
    ds_read_b128 v[40:43], v6 offset:32768
    ds_read_b64_tr_b16 v[16:17], v4 offset:24640
    ds_read_b64_tr_b16 v[18:19], v4 offset:26176
    ds_read_b64_tr_b16 v[20:21], v4 offset:24672
    ds_read_b64_tr_b16 v[22:23], v4 offset:26208
    v_mfma_f32_32x32x16_bf16 v[96:111], v[24:27], v[44:47], v[96:111]
    ds_read_b64_tr_b16 v[24:25], v4 offset:24704
    ds_read_b64_tr_b16 v[26:27], v4 offset:26240
    v_mfma_f32_32x32x16_bf16 v[112:127], v[28:31], v[44:47], v[112:127]
    ds_read_b64_tr_b16 v[28:29], v4 offset:24736
    ds_read_b64_tr_b16 v[30:31], v4 offset:26272
    v_mfma_f32_32x32x16_bf16 v[128:143], v[32:35], v[44:47], v[128:143]
    ds_read_b64_tr_b16 v[32:33], v4 offset:24768
    ds_read_b64_tr_b16 v[34:35], v4 offset:26304
    v_mfma_f32_32x32x16_bf16 v[144:159], v[36:39], v[44:47], v[144:159]
    ds_read_b64_tr_b16 v[36:37], v4 offset:24800
    ds_read_b64_tr_b16 v[38:39], v4 offset:26336
    s_waitcnt lgkmcnt(10)
    v_mfma_f32_32x32x16_bf16 v[64:79], v[16:19], v[40:43], v[64:79]
    ds_read_b128 v[44:47], v6 offset:33792
    ds_read_b64_tr_b16 v[16:17], v4 offset:27712
    ds_read_b64_tr_b16 v[18:19], v4 offset:29248
    s_waitcnt lgkmcnt(11)
    v_mfma_f32_32x32x16_bf16 v[80:95], v[20:23], v[40:43], v[80:95]
    ds_read_b64_tr_b16 v[20:21], v4 offset:27744
    ds_read_b64_tr_b16 v[22:23], v4 offset:29280
    s_waitcnt lgkmcnt(11)
    v_mfma_f32_32x32x16_bf16 v[96:111], v[24:27], v[40:43], v[96:111]
    ds_read_b64_tr_b16 v[24:25], v4 offset:27776
    ds_read_b64_tr_b16 v[26:27], v4 offset:29312
    s_waitcnt lgkmcnt(11)
    v_mfma_f32_32x32x16_bf16 v[112:127], v[28:31], v[40:43], v[112:127]
    ds_read_b64_tr_b16 v[28:29], v4 offset:27808
    ds_read_b64_tr_b16 v[30:31], v4 offset:29344
    s_waitcnt lgkmcnt(11)
    v_mfma_f32_32x32x16_bf16 v[128:143], v[32:35], v[40:43], v[128:143]
    ds_read_b64_tr_b16 v[32:33], v4 offset:27840
    ds_read_b64_tr_b16 v[34:35], v4 offset:29376
    s_waitcnt lgkmcnt(11)
    v_mfma_f32_32x32x16_bf16 v[144:159], v[36:39], v[40:43], v[144:159]
    ds_read_b64_tr_b16 v[36:37], v4 offset:27872
    ds_read_b64_tr_b16 v[38:39], v4 offset:29408
    s_waitcnt lgkmcnt(10)
    v_mfma_f32_32x32x16_bf16 v[64:79], v[16:19], v[44:47], v[64:79]
    ds_read_b128 v[40:43], v6 offset:34816
    ds_read_b64_tr_b16 v[16:17], v4 offset:30784
    ds_read_b64_tr_b16 v[18:19], v4 offset:32320
    s_waitcnt lgkmcnt(11)
    v_mfma_f32_32x32x16_bf16 v[80:95], v[20:23], v[44:47], v[80:95]
    ds_read_b64_tr_b16 v[20:21], v4 offset:30816
    ds_read_b64_tr_b16 v[22:23], v4 offset:32352
    s_waitcnt lgkmcnt(11)
    v_mfma_f32_32x32x16_bf16 v[96:111], v[24:27], v[44:47], v[96:111]
    ds_read_b64_tr_b16 v[24:25], v4 offset:30848
    ds_read_b64_tr_b16 v[26:27], v4 offset:32384
    s_waitcnt lgkmcnt(11)
    v_mfma_f32_32x32x16_bf16 v[112:127], v[28:31], v[44:47], v[112:127]
    ds_read_b64_tr_b16 v[28:29], v4 offset:30880
    ds_read_b64_tr_b16 v[30:31], v4 offset:32416
    s_waitcnt lgkmcnt(11)
    v_mfma_f32_32x32x16_bf16 v[128:143], v[32:35], v[44:47], v[128:143]
    ds_read_b64_tr_b16 v[32:33], v4 offset:30912
    ds_read_b64_tr_b16 v[34:35], v4 offset:32448
    s_waitcnt lgkmcnt(11)
    v_mfma_f32_32x32x16_bf16 v[144:159], v[36:39], v[44:47], v[144:159]
    ds_read_b64_tr_b16 v[36:37], v4 offset:30944
    ds_read_b64_tr_b16 v[38:39], v4 offset:32480
    s_waitcnt lgkmcnt(10)
    v_mfma_f32_32x32x16_bf16 v[64:79], v[16:19], v[40:43], v[64:79]
    ds_read_b128 v[44:47], v6 offset:35840
    ds_read_b64_tr_b16 v[16:17], v4 offset:33856
    ds_read_b64_tr_b16 v[18:19], v4 offset:35392
    s_waitcnt lgkmcnt(11)
    v_mfma_f32_32x32x16_bf16 v[80:95], v[20:23], v[40:43], v[80:95]
    ds_read_b64_tr_b16 v[20:21], v4 offset:33888
    ds_read_b64_tr_b16 v[22:23], v4 offset:35424
    s_waitcnt lgkmcnt(11)
    v_mfma_f32_32x32x16_bf16 v[96:111], v[24:27], v[40:43], v[96:111]
    ds_read_b64_tr_b16 v[24:25], v4 offset:33920
    ds_read_b64_tr_b16 v[26:27], v4 offset:35456
    s_waitcnt lgkmcnt(11)
    v_mfma_f32_32x32x16_bf16 v[112:127], v[28:31], v[40:43], v[112:127]
    ds_read_b64_tr_b16 v[28:29], v4 offset:33952
    ds_read_b64_tr_b16 v[30:31], v4 offset:35488
    s_waitcnt lgkmcnt(11)
    v_mfma_f32_32x32x16_bf16 v[128:143], v[32:35], v[40:43], v[128:143]
    ds_read_b64_tr_b16 v[32:33], v4 offset:33984
    ds_read_b64_tr_b16 v[34:35], v4 offset:35520
    s_waitcnt lgkmcnt(11)
    v_mfma_f32_32x32x16_bf16 v[144:159], v[36:39], v[40:43], v[144:159]
    ds_read_b64_tr_b16 v[36:37], v4 offset:34016
    ds_read_b64_tr_b16 v[38:39], v4 offset:35552
    s_waitcnt lgkmcnt(10)
    v_mfma_f32_32x32x16_bf16 v[64:79], v[16:19], v[44:47], v[64:79]
    s_waitcnt lgkmcnt(8)
    v_mfma_f32_32x32x16_bf16 v[80:95], v[20:23], v[44:47], v[80:95]
    s_waitcnt lgkmcnt(0)
    s_barrier
    ds_read_b128 v[40:43], v6 offset:0
    ds_read_b64_tr_b16 v[16:17], v4 offset:49280
    ds_read_b64_tr_b16 v[18:19], v4 offset:50816
    ds_read_b64_tr_b16 v[20:21], v4 offset:49312
    ds_read_b64_tr_b16 v[22:23], v4 offset:50848
    v_mfma_f32_32x32x16_bf16 v[96:111], v[24:27], v[44:47], v[96:111]
    ds_read_b64_tr_b16 v[24:25], v4 offset:49344
    ds_read_b64_tr_b16 v[26:27], v4 offset:50880
    v_mfma_f32_32x32x16_bf16 v[112:127], v[28:31], v[44:47], v[112:127]
    ds_read_b64_tr_b16 v[28:29], v4 offset:49376
    ds_read_b64_tr_b16 v[30:31], v4 offset:50912
    v_mfma_f32_32x32x16_bf16 v[128:143], v[32:35], v[44:47], v[128:143]
    ds_read_b64_tr_b16 v[32:33], v4 offset:49408
    ds_read_b64_tr_b16 v[34:35], v4 offset:50944
    v_mfma_f32_32x32x16_bf16 v[144:159], v[36:39], v[44:47], v[144:159]
    ds_read_b64_tr_b16 v[36:37], v4 offset:49440
    ds_read_b64_tr_b16 v[38:39], v4 offset:50976
    s_waitcnt lgkmcnt(10)
    v_mfma_f32_32x32x16_bf16 v[64:79], v[16:19], v[40:43], v[64:79]
    ds_read_b128 v[44:47], v6 offset:1024
    ds_read_b64_tr_b16 v[16:17], v4 offset:52352
    ds_read_b64_tr_b16 v[18:19], v4 offset:53888
    s_waitcnt lgkmcnt(11)
    v_mfma_f32_32x32x16_bf16 v[80:95], v[20:23], v[40:43], v[80:95]
    ds_read_b64_tr_b16 v[20:21], v4 offset:52384
    ds_read_b64_tr_b16 v[22:23], v4 offset:53920
    s_waitcnt lgkmcnt(11)
    v_mfma_f32_32x32x16_bf16 v[96:111], v[24:27], v[40:43], v[96:111]
    ds_read_b64_tr_b16 v[24:25], v4 offset:52416
    ds_read_b64_tr_b16 v[26:27], v4 offset:53952
    s_waitcnt lgkmcnt(11)
    v_mfma_f32_32x32x16_bf16 v[112:127], v[28:31], v[40:43], v[112:127]
    ds_read_b64_tr_b16 v[28:29], v4 offset:52448
    ds_read_b64_tr_b16 v[30:31], v4 offset:53984
    s_waitcnt lgkmcnt(11)
    v_mfma_f32_32x32x16_bf16 v[128:143], v[32:35], v[40:43], v[128:143]
    ds_read_b64_tr_b16 v[32:33], v4 offset:52480
    ds_read_b64_tr_b16 v[34:35], v4 offset:54016
    s_waitcnt lgkmcnt(11)
    v_mfma_f32_32x32x16_bf16 v[144:159], v[36:39], v[40:43], v[144:159]
    ds_read_b64_tr_b16 v[36:37], v4 offset:52512
    ds_read_b64_tr_b16 v[38:39], v4 offset:54048
    s_waitcnt lgkmcnt(10)
    v_mfma_f32_32x32x16_bf16 v[64:79], v[16:19], v[44:47], v[64:79]
    ds_read_b128 v[40:43], v6 offset:2048
    ds_read_b64_tr_b16 v[16:17], v4 offset:55424
    ds_read_b64_tr_b16 v[18:19], v4 offset:56960
    s_waitcnt lgkmcnt(11)
    v_mfma_f32_32x32x16_bf16 v[80:95], v[20:23], v[44:47], v[80:95]
    ds_read_b64_tr_b16 v[20:21], v4 offset:55456
    ds_read_b64_tr_b16 v[22:23], v4 offset:56992
    s_waitcnt lgkmcnt(11)
    v_mfma_f32_32x32x16_bf16 v[96:111], v[24:27], v[44:47], v[96:111]
    ds_read_b64_tr_b16 v[24:25], v4 offset:55488
    ds_read_b64_tr_b16 v[26:27], v4 offset:57024
    s_waitcnt lgkmcnt(11)
    v_mfma_f32_32x32x16_bf16 v[112:127], v[28:31], v[44:47], v[112:127]
    ds_read_b64_tr_b16 v[28:29], v4 offset:55520
    ds_read_b64_tr_b16 v[30:31], v4 offset:57056
    s_waitcnt lgkmcnt(11)
    v_mfma_f32_32x32x16_bf16 v[128:143], v[32:35], v[44:47], v[128:143]
    ds_read_b64_tr_b16 v[32:33], v4 offset:55552
    ds_read_b64_tr_b16 v[34:35], v4 offset:57088
    s_waitcnt lgkmcnt(11)
    v_mfma_f32_32x32x16_bf16 v[144:159], v[36:39], v[44:47], v[144:159]
    ds_read_b64_tr_b16 v[36:37], v4 offset:55584
    ds_read_b64_tr_b16 v[38:39], v4 offset:57120
    s_waitcnt lgkmcnt(10)
    v_mfma_f32_32x32x16_bf16 v[64:79], v[16:19], v[40:43], v[64:79]
    ds_read_b128 v[44:47], v6 offset:3072
    ds_read_b64_tr_b16 v[16:17], v4 offset:58496
    ds_read_b64_tr_b16 v[18:19], v4 offset:60032
    s_waitcnt lgkmcnt(11)
    v_mfma_f32_32x32x16_bf16 v[80:95], v[20:23], v[40:43], v[80:95]
    ds_read_b64_tr_b16 v[20:21], v4 offset:58528
    ds_read_b64_tr_b16 v[22:23], v4 offset:60064
    s_waitcnt lgkmcnt(11)
    v_mfma_f32_32x32x16_bf16 v[96:111], v[24:27], v[40:43], v[96:111]
    ds_read_b64_tr_b16 v[24:25], v4 offset:58560
    ds_read_b64_tr_b16 v[26:27], v4 offset:60096
    s_waitcnt lgkmcnt(11)
    v_mfma_f32_32x32x16_bf16 v[112:127], v[28:31], v[40:43], v[112:127]
    ds_read_b64_tr_b16 v[28:29], v4 offset:58592
    ds_read_b64_tr_b16 v[30:31], v4 offset:60128
    s_waitcnt lgkmcnt(11)
    v_mfma_f32_32x32x16_bf16 v[128:143], v[32:35], v[40:43], v[128:143]
    ds_read_b64_tr_b16 v[32:33], v4 offset:58624
    ds_read_b64_tr_b16 v[34:35], v4 offset:60160
    s_waitcnt lgkmcnt(11)
    v_mfma_f32_32x32x16_bf16 v[144:159], v[36:39], v[40:43], v[144:159]
    ds_read_b64_tr_b16 v[36:37], v4 offset:58656
    ds_read_b64_tr_b16 v[38:39], v4 offset:60192
    s_waitcnt lgkmcnt(10)
    v_mfma_f32_32x32x16_bf16 v[64:79], v[16:19], v[44:47], v[64:79]
    s_waitcnt lgkmcnt(8)
    v_mfma_f32_32x32x16_bf16 v[80:95], v[20:23], v[44:47], v[80:95]
    s_waitcnt lgkmcnt(0)
    s_barrier
    ds_read_b128 v[40:43], v6 offset:16384
    ds_read_b64_tr_b16 v[16:17], v5 offset:8384
    ds_read_b64_tr_b16 v[18:19], v5 offset:9920
    ds_read_b64_tr_b16 v[20:21], v5 offset:8416
    ds_read_b64_tr_b16 v[22:23], v5 offset:9952
    v_mfma_f32_32x32x16_bf16 v[96:111], v[24:27], v[44:47], v[96:111]
    ds_read_b64_tr_b16 v[24:25], v5 offset:8448
    ds_read_b64_tr_b16 v[26:27], v5 offset:9984
    v_mfma_f32_32x32x16_bf16 v[112:127], v[28:31], v[44:47], v[112:127]
    ds_read_b64_tr_b16 v[28:29], v5 offset:8480
    ds_read_b64_tr_b16 v[30:31], v5 offset:10016
    v_mfma_f32_32x32x16_bf16 v[128:143], v[32:35], v[44:47], v[128:143]
    ds_read_b64_tr_b16 v[32:33], v5 offset:8512
    ds_read_b64_tr_b16 v[34:35], v5 offset:10048
    v_mfma_f32_32x32x16_bf16 v[144:159], v[36:39], v[44:47], v[144:159]
    ds_read_b64_tr_b16 v[36:37], v5 offset:8544
    ds_read_b64_tr_b16 v[38:39], v5 offset:10080
    s_waitcnt lgkmcnt(10)
    v_mfma_f32_32x32x16_bf16 v[64:79], v[16:19], v[40:43], v[64:79]
    ds_read_b128 v[44:47], v6 offset:17408
    ds_read_b64_tr_b16 v[16:17], v5 offset:11456
    ds_read_b64_tr_b16 v[18:19], v5 offset:12992
    s_waitcnt lgkmcnt(11)
    v_mfma_f32_32x32x16_bf16 v[80:95], v[20:23], v[40:43], v[80:95]
    ds_read_b64_tr_b16 v[20:21], v5 offset:11488
    ds_read_b64_tr_b16 v[22:23], v5 offset:13024
    s_waitcnt lgkmcnt(11)
    v_mfma_f32_32x32x16_bf16 v[96:111], v[24:27], v[40:43], v[96:111]
    ds_read_b64_tr_b16 v[24:25], v5 offset:11520
    ds_read_b64_tr_b16 v[26:27], v5 offset:13056
    s_waitcnt lgkmcnt(11)
    v_mfma_f32_32x32x16_bf16 v[112:127], v[28:31], v[40:43], v[112:127]
    ds_read_b64_tr_b16 v[28:29], v5 offset:11552
    ds_read_b64_tr_b16 v[30:31], v5 offset:13088
    s_waitcnt lgkmcnt(11)
    v_mfma_f32_32x32x16_bf16 v[128:143], v[32:35], v[40:43], v[128:143]
    ds_read_b64_tr_b16 v[32:33], v5 offset:11584
    ds_read_b64_tr_b16 v[34:35], v5 offset:13120
    s_waitcnt lgkmcnt(11)
    v_mfma_f32_32x32x16_bf16 v[144:159], v[36:39], v[40:43], v[144:159]
    ds_read_b64_tr_b16 v[36:37], v5 offset:11616
    ds_read_b64_tr_b16 v[38:39], v5 offset:13152
    s_waitcnt lgkmcnt(10)
    v_mfma_f32_32x32x16_bf16 v[64:79], v[16:19], v[44:47], v[64:79]
    ds_read_b128 v[40:43], v6 offset:18432
    ds_read_b64_tr_b16 v[16:17], v5 offset:14528
    ds_read_b64_tr_b16 v[18:19], v5 offset:16064
    s_waitcnt lgkmcnt(11)
    v_mfma_f32_32x32x16_bf16 v[80:95], v[20:23], v[44:47], v[80:95]
    ds_read_b64_tr_b16 v[20:21], v5 offset:14560
    ds_read_b64_tr_b16 v[22:23], v5 offset:16096
    s_waitcnt lgkmcnt(11)
    v_mfma_f32_32x32x16_bf16 v[96:111], v[24:27], v[44:47], v[96:111]
    ds_read_b64_tr_b16 v[24:25], v5 offset:14592
    ds_read_b64_tr_b16 v[26:27], v5 offset:16128
    s_waitcnt lgkmcnt(11)
    v_mfma_f32_32x32x16_bf16 v[112:127], v[28:31], v[44:47], v[112:127]
    ds_read_b64_tr_b16 v[28:29], v5 offset:14624
    ds_read_b64_tr_b16 v[30:31], v5 offset:16160
    s_waitcnt lgkmcnt(11)
    v_mfma_f32_32x32x16_bf16 v[128:143], v[32:35], v[44:47], v[128:143]
    ds_read_b64_tr_b16 v[32:33], v5 offset:14656
    ds_read_b64_tr_b16 v[34:35], v5 offset:16192
    s_waitcnt lgkmcnt(11)
    v_mfma_f32_32x32x16_bf16 v[144:159], v[36:39], v[44:47], v[144:159]
    ds_read_b64_tr_b16 v[36:37], v5 offset:14688
    ds_read_b64_tr_b16 v[38:39], v5 offset:16224
    s_waitcnt lgkmcnt(10)
    v_mfma_f32_32x32x16_bf16 v[64:79], v[16:19], v[40:43], v[64:79]
    ds_read_b128 v[44:47], v6 offset:19456
    ds_read_b64_tr_b16 v[16:17], v5 offset:17600
    ds_read_b64_tr_b16 v[18:19], v5 offset:19136
    s_waitcnt lgkmcnt(11)
    v_mfma_f32_32x32x16_bf16 v[80:95], v[20:23], v[40:43], v[80:95]
    ds_read_b64_tr_b16 v[20:21], v5 offset:17632
    ds_read_b64_tr_b16 v[22:23], v5 offset:19168
    s_waitcnt lgkmcnt(11)
    v_mfma_f32_32x32x16_bf16 v[96:111], v[24:27], v[40:43], v[96:111]
    ds_read_b64_tr_b16 v[24:25], v5 offset:17664
    ds_read_b64_tr_b16 v[26:27], v5 offset:19200
    s_waitcnt lgkmcnt(11)
    v_mfma_f32_32x32x16_bf16 v[112:127], v[28:31], v[40:43], v[112:127]
    ds_read_b64_tr_b16 v[28:29], v5 offset:17696
    ds_read_b64_tr_b16 v[30:31], v5 offset:19232
    s_waitcnt lgkmcnt(11)
    v_mfma_f32_32x32x16_bf16 v[128:143], v[32:35], v[40:43], v[128:143]
    ds_read_b64_tr_b16 v[32:33], v5 offset:17728
    ds_read_b64_tr_b16 v[34:35], v5 offset:19264
    s_waitcnt lgkmcnt(11)
    v_mfma_f32_32x32x16_bf16 v[144:159], v[36:39], v[40:43], v[144:159]
    ds_read_b64_tr_b16 v[36:37], v5 offset:17760
    ds_read_b64_tr_b16 v[38:39], v5 offset:19296
    s_waitcnt lgkmcnt(10)
    v_mfma_f32_32x32x16_bf16 v[64:79], v[16:19], v[44:47], v[64:79]
    s_waitcnt lgkmcnt(8)
    v_mfma_f32_32x32x16_bf16 v[80:95], v[20:23], v[44:47], v[80:95]
    s_waitcnt lgkmcnt(0)
    s_barrier
    ds_read_b128 v[40:43], v6 offset:32768
    ds_read_b64_tr_b16 v[16:17], v4 offset:0
    ds_read_b64_tr_b16 v[18:19], v4 offset:1536
    ds_read_b64_tr_b16 v[20:21], v4 offset:32
    ds_read_b64_tr_b16 v[22:23], v4 offset:1568
    v_mfma_f32_32x32x16_bf16 v[96:111], v[24:27], v[44:47], v[96:111]
    ds_read_b64_tr_b16 v[24:25], v4 offset:64
    ds_read_b64_tr_b16 v[26:27], v4 offset:1600
    v_mfma_f32_32x32x16_bf16 v[112:127], v[28:31], v[44:47], v[112:127]
    ds_read_b64_tr_b16 v[28:29], v4 offset:96
    ds_read_b64_tr_b16 v[30:31], v4 offset:1632
    v_mfma_f32_32x32x16_bf16 v[128:143], v[32:35], v[44:47], v[128:143]
    ds_read_b64_tr_b16 v[32:33], v4 offset:128
    ds_read_b64_tr_b16 v[34:35], v4 offset:1664
    v_mfma_f32_32x32x16_bf16 v[144:159], v[36:39], v[44:47], v[144:159]
    ds_read_b64_tr_b16 v[36:37], v4 offset:160
    ds_read_b64_tr_b16 v[38:39], v4 offset:1696
    s_waitcnt lgkmcnt(10)
    v_mfma_f32_32x32x16_bf16 v[64:79], v[16:19], v[40:43], v[64:79]
    ds_read_b128 v[44:47], v6 offset:33792
    ds_read_b64_tr_b16 v[16:17], v4 offset:3072
    ds_read_b64_tr_b16 v[18:19], v4 offset:4608
    s_waitcnt lgkmcnt(11)
    v_mfma_f32_32x32x16_bf16 v[80:95], v[20:23], v[40:43], v[80:95]
    ds_read_b64_tr_b16 v[20:21], v4 offset:3104
    ds_read_b64_tr_b16 v[22:23], v4 offset:4640
    s_waitcnt lgkmcnt(11)
    v_mfma_f32_32x32x16_bf16 v[96:111], v[24:27], v[40:43], v[96:111]
    ds_read_b64_tr_b16 v[24:25], v4 offset:3136
    ds_read_b64_tr_b16 v[26:27], v4 offset:4672
    s_waitcnt lgkmcnt(11)
    v_mfma_f32_32x32x16_bf16 v[112:127], v[28:31], v[40:43], v[112:127]
    ds_read_b64_tr_b16 v[28:29], v4 offset:3168
    ds_read_b64_tr_b16 v[30:31], v4 offset:4704
    s_waitcnt lgkmcnt(11)
    v_mfma_f32_32x32x16_bf16 v[128:143], v[32:35], v[40:43], v[128:143]
    ds_read_b64_tr_b16 v[32:33], v4 offset:3200
    ds_read_b64_tr_b16 v[34:35], v4 offset:4736
    s_waitcnt lgkmcnt(11)
    v_mfma_f32_32x32x16_bf16 v[144:159], v[36:39], v[40:43], v[144:159]
    ds_read_b64_tr_b16 v[36:37], v4 offset:3232
    ds_read_b64_tr_b16 v[38:39], v4 offset:4768
    s_waitcnt lgkmcnt(10)
    v_mfma_f32_32x32x16_bf16 v[64:79], v[16:19], v[44:47], v[64:79]
    ds_read_b128 v[40:43], v6 offset:34816
    ds_read_b64_tr_b16 v[16:17], v4 offset:6144
    ds_read_b64_tr_b16 v[18:19], v4 offset:7680
    s_waitcnt lgkmcnt(11)
    v_mfma_f32_32x32x16_bf16 v[80:95], v[20:23], v[44:47], v[80:95]
    ds_read_b64_tr_b16 v[20:21], v4 offset:6176
    ds_read_b64_tr_b16 v[22:23], v4 offset:7712
    s_waitcnt lgkmcnt(11)
    v_mfma_f32_32x32x16_bf16 v[96:111], v[24:27], v[44:47], v[96:111]
    ds_read_b64_tr_b16 v[24:25], v4 offset:6208
    ds_read_b64_tr_b16 v[26:27], v4 offset:7744
    s_waitcnt lgkmcnt(11)
    v_mfma_f32_32x32x16_bf16 v[112:127], v[28:31], v[44:47], v[112:127]
    ds_read_b64_tr_b16 v[28:29], v4 offset:6240
    ds_read_b64_tr_b16 v[30:31], v4 offset:7776
    s_waitcnt lgkmcnt(11)
    v_mfma_f32_32x32x16_bf16 v[128:143], v[32:35], v[44:47], v[128:143]
    ds_read_b64_tr_b16 v[32:33], v4 offset:6272
    ds_read_b64_tr_b16 v[34:35], v4 offset:7808
    s_waitcnt lgkmcnt(11)
    v_mfma_f32_32x32x16_bf16 v[144:159], v[36:39], v[44:47], v[144:159]
    ds_read_b64_tr_b16 v[36:37], v4 offset:6304
    ds_read_b64_tr_b16 v[38:39], v4 offset:7840
    s_waitcnt lgkmcnt(10)
    v_mfma_f32_32x32x16_bf16 v[64:79], v[16:19], v[40:43], v[64:79]
    ds_read_b128 v[44:47], v6 offset:35840
    ds_read_b64_tr_b16 v[16:17], v4 offset:9216
    ds_read_b64_tr_b16 v[18:19], v4 offset:10752
    s_waitcnt lgkmcnt(11)
    v_mfma_f32_32x32x16_bf16 v[80:95], v[20:23], v[40:43], v[80:95]
    ds_read_b64_tr_b16 v[20:21], v4 offset:9248
    ds_read_b64_tr_b16 v[22:23], v4 offset:10784
    s_waitcnt lgkmcnt(11)
    v_mfma_f32_32x32x16_bf16 v[96:111], v[24:27], v[40:43], v[96:111]
    ds_read_b64_tr_b16 v[24:25], v4 offset:9280
    ds_read_b64_tr_b16 v[26:27], v4 offset:10816
    s_waitcnt lgkmcnt(11)
    v_mfma_f32_32x32x16_bf16 v[112:127], v[28:31], v[40:43], v[112:127]
    ds_read_b64_tr_b16 v[28:29], v4 offset:9312
    ds_read_b64_tr_b16 v[30:31], v4 offset:10848
    s_waitcnt lgkmcnt(11)
    v_mfma_f32_32x32x16_bf16 v[128:143], v[32:35], v[40:43], v[128:143]
    ds_read_b64_tr_b16 v[32:33], v4 offset:9344
    ds_read_b64_tr_b16 v[34:35], v4 offset:10880
    s_waitcnt lgkmcnt(11)
    v_mfma_f32_32x32x16_bf16 v[144:159], v[36:39], v[40:43], v[144:159]
    ds_read_b64_tr_b16 v[36:37], v4 offset:9376
    ds_read_b64_tr_b16 v[38:39], v4 offset:10912
    s_waitcnt lgkmcnt(10)
    v_mfma_f32_32x32x16_bf16 v[64:79], v[16:19], v[44:47], v[64:79]
    s_waitcnt lgkmcnt(8)
    v_mfma_f32_32x32x16_bf16 v[80:95], v[20:23], v[44:47], v[80:95]
    s_waitcnt lgkmcnt(0)
    s_barrier
    ds_read_b128 v[40:43], v6 offset:0
    ds_read_b64_tr_b16 v[16:17], v4 offset:24640
    ds_read_b64_tr_b16 v[18:19], v4 offset:26176
    ds_read_b64_tr_b16 v[20:21], v4 offset:24672
    ds_read_b64_tr_b16 v[22:23], v4 offset:26208
    v_mfma_f32_32x32x16_bf16 v[96:111], v[24:27], v[44:47], v[96:111]
    ds_read_b64_tr_b16 v[24:25], v4 offset:24704
    ds_read_b64_tr_b16 v[26:27], v4 offset:26240
    v_mfma_f32_32x32x16_bf16 v[112:127], v[28:31], v[44:47], v[112:127]
    ds_read_b64_tr_b16 v[28:29], v4 offset:24736
    ds_read_b64_tr_b16 v[30:31], v4 offset:26272
    v_mfma_f32_32x32x16_bf16 v[128:143], v[32:35], v[44:47], v[128:143]
    ds_read_b64_tr_b16 v[32:33], v4 offset:24768
    ds_read_b64_tr_b16 v[34:35], v4 offset:26304
    v_mfma_f32_32x32x16_bf16 v[144:159], v[36:39], v[44:47], v[144:159]
    ds_read_b64_tr_b16 v[36:37], v4 offset:24800
    ds_read_b64_tr_b16 v[38:39], v4 offset:26336
    s_waitcnt lgkmcnt(10)
    v_mfma_f32_32x32x16_bf16 v[64:79], v[16:19], v[40:43], v[64:79]
    ds_read_b128 v[44:47], v6 offset:1024
    ds_read_b64_tr_b16 v[16:17], v4 offset:27712
    ds_read_b64_tr_b16 v[18:19], v4 offset:29248
    s_waitcnt lgkmcnt(11)
    v_mfma_f32_32x32x16_bf16 v[80:95], v[20:23], v[40:43], v[80:95]
    ds_read_b64_tr_b16 v[20:21], v4 offset:27744
    ds_read_b64_tr_b16 v[22:23], v4 offset:29280
    s_waitcnt lgkmcnt(11)
    v_mfma_f32_32x32x16_bf16 v[96:111], v[24:27], v[40:43], v[96:111]
    ds_read_b64_tr_b16 v[24:25], v4 offset:27776
    ds_read_b64_tr_b16 v[26:27], v4 offset:29312
    s_waitcnt lgkmcnt(11)
    v_mfma_f32_32x32x16_bf16 v[112:127], v[28:31], v[40:43], v[112:127]
    ds_read_b64_tr_b16 v[28:29], v4 offset:27808
    ds_read_b64_tr_b16 v[30:31], v4 offset:29344
    s_waitcnt lgkmcnt(11)
    v_mfma_f32_32x32x16_bf16 v[128:143], v[32:35], v[40:43], v[128:143]
    ds_read_b64_tr_b16 v[32:33], v4 offset:27840
    ds_read_b64_tr_b16 v[34:35], v4 offset:29376
    s_waitcnt lgkmcnt(11)
    v_mfma_f32_32x32x16_bf16 v[144:159], v[36:39], v[40:43], v[144:159]
    ds_read_b64_tr_b16 v[36:37], v4 offset:27872
    ds_read_b64_tr_b16 v[38:39], v4 offset:29408
    s_waitcnt lgkmcnt(10)
    v_mfma_f32_32x32x16_bf16 v[64:79], v[16:19], v[44:47], v[64:79]
    ds_read_b128 v[40:43], v6 offset:2048
    ds_read_b64_tr_b16 v[16:17], v4 offset:30784
    ds_read_b64_tr_b16 v[18:19], v4 offset:32320
    s_waitcnt lgkmcnt(11)
    v_mfma_f32_32x32x16_bf16 v[80:95], v[20:23], v[44:47], v[80:95]
    ds_read_b64_tr_b16 v[20:21], v4 offset:30816
    ds_read_b64_tr_b16 v[22:23], v4 offset:32352
    s_waitcnt lgkmcnt(11)
    v_mfma_f32_32x32x16_bf16 v[96:111], v[24:27], v[44:47], v[96:111]
    ds_read_b64_tr_b16 v[24:25], v4 offset:30848
    ds_read_b64_tr_b16 v[26:27], v4 offset:32384
    s_waitcnt lgkmcnt(11)
    v_mfma_f32_32x32x16_bf16 v[112:127], v[28:31], v[44:47], v[112:127]
    ds_read_b64_tr_b16 v[28:29], v4 offset:30880
    ds_read_b64_tr_b16 v[30:31], v4 offset:32416
    s_waitcnt lgkmcnt(11)
    v_mfma_f32_32x32x16_bf16 v[128:143], v[32:35], v[44:47], v[128:143]
    ds_read_b64_tr_b16 v[32:33], v4 offset:30912
    ds_read_b64_tr_b16 v[34:35], v4 offset:32448
    s_waitcnt lgkmcnt(11)
    v_mfma_f32_32x32x16_bf16 v[144:159], v[36:39], v[44:47], v[144:159]
    ds_read_b64_tr_b16 v[36:37], v4 offset:30944
    ds_read_b64_tr_b16 v[38:39], v4 offset:32480
    s_waitcnt lgkmcnt(10)
    v_mfma_f32_32x32x16_bf16 v[64:79], v[16:19], v[40:43], v[64:79]
    ds_read_b128 v[44:47], v6 offset:3072
    ds_read_b64_tr_b16 v[16:17], v4 offset:33856
    ds_read_b64_tr_b16 v[18:19], v4 offset:35392
    s_waitcnt lgkmcnt(11)
    v_mfma_f32_32x32x16_bf16 v[80:95], v[20:23], v[40:43], v[80:95]
    ds_read_b64_tr_b16 v[20:21], v4 offset:33888
    ds_read_b64_tr_b16 v[22:23], v4 offset:35424
    s_waitcnt lgkmcnt(11)
    v_mfma_f32_32x32x16_bf16 v[96:111], v[24:27], v[40:43], v[96:111]
    ds_read_b64_tr_b16 v[24:25], v4 offset:33920
    ds_read_b64_tr_b16 v[26:27], v4 offset:35456
    s_waitcnt lgkmcnt(11)
    v_mfma_f32_32x32x16_bf16 v[112:127], v[28:31], v[40:43], v[112:127]
    ds_read_b64_tr_b16 v[28:29], v4 offset:33952
    ds_read_b64_tr_b16 v[30:31], v4 offset:35488
    s_waitcnt lgkmcnt(11)
    v_mfma_f32_32x32x16_bf16 v[128:143], v[32:35], v[40:43], v[128:143]
    ds_read_b64_tr_b16 v[32:33], v4 offset:33984
    ds_read_b64_tr_b16 v[34:35], v4 offset:35520
    s_waitcnt lgkmcnt(11)
    v_mfma_f32_32x32x16_bf16 v[144:159], v[36:39], v[40:43], v[144:159]
    ds_read_b64_tr_b16 v[36:37], v4 offset:34016
    ds_read_b64_tr_b16 v[38:39], v4 offset:35552
    s_waitcnt lgkmcnt(10)
    v_mfma_f32_32x32x16_bf16 v[64:79], v[16:19], v[44:47], v[64:79]
    s_waitcnt lgkmcnt(8)
    v_mfma_f32_32x32x16_bf16 v[80:95], v[20:23], v[44:47], v[80:95]
    s_waitcnt lgkmcnt(6)
    v_mfma_f32_32x32x16_bf16 v[96:111], v[24:27], v[44:47], v[96:111]
    s_waitcnt lgkmcnt(4)
    v_mfma_f32_32x32x16_bf16 v[112:127], v[28:31], v[44:47], v[112:127]
    s_waitcnt lgkmcnt(2)
    v_mfma_f32_32x32x16_bf16 v[128:143], v[32:35], v[44:47], v[128:143]
    s_waitcnt lgkmcnt(0)
    v_mfma_f32_32x32x16_bf16 v[144:159], v[36:39], v[44:47], v[144:159]
    s_lshl_b32 s72, s68, 2
    s_add_u32 s72, s72, s40
    s_mul_i32 s72, s72, 98304
    s_mul_i32 s73, s69, 6144
    s_add_u32 s72, s72, s73
    s_nop 7
    v_mul_f32 v64, 0xbfb8aa3b, v64
    v_mul_f32 v65, 0xbfb8aa3b, v65
    v_mul_f32 v66, 0xbfb8aa3b, v66
    v_mul_f32 v67, 0xbfb8aa3b, v67
    v_mul_f32 v68, 0xbfb8aa3b, v68
    v_mul_f32 v69, 0xbfb8aa3b, v69
    v_mul_f32 v70, 0xbfb8aa3b, v70
    v_mul_f32 v71, 0xbfb8aa3b, v71
    v_exp_f32 v64, v64
    v_exp_f32 v65, v65
    v_exp_f32 v66, v66
    v_exp_f32 v67, v67
    v_exp_f32 v68, v68
    v_exp_f32 v69, v69
    v_exp_f32 v70, v70
    v_exp_f32 v71, v71
    v_add_f32 v64, 1.0, v64
    v_add_f32 v65, 1.0, v65
    v_add_f32 v66, 1.0, v66
    v_add_f32 v67, 1.0, v67
    v_add_f32 v68, 1.0, v68
    v_add_f32 v69, 1.0, v69
    v_add_f32 v70, 1.0, v70
    v_add_f32 v71, 1.0, v71
    v_rcp_f32 v64, v64
    v_rcp_f32 v65, v65
    v_rcp_f32 v66, v66
    v_rcp_f32 v67, v67
    v_rcp_f32 v68, v68
    v_rcp_f32 v69, v69
    v_rcp_f32 v70, v70
    v_rcp_f32 v71, v71
    v_mul_f32 v64, v64, v72
    v_mul_f32 v65, v65, v73
    v_mul_f32 v66, v66, v74
    v_mul_f32 v67, v67, v75
    v_mul_f32 v68, v68, v76
    v_mul_f32 v69, v69, v77
    v_mul_f32 v70, v70, v78
    v_mul_f32 v71, v71, v79
    v_cvt_pk_bf16_f32 v16, v64, v65
    v_cvt_pk_bf16_f32 v17, v66, v67
    v_cvt_pk_bf16_f32 v18, v68, v69
    v_cvt_pk_bf16_f32 v19, v70, v71
    s_add_u32 s73, s72, 0
    buffer_store_dwordx4 v[16:19], v1, s[60:63], s73 offen sc1
    v_mul_f32 v80, 0xbfb8aa3b, v80
    v_mul_f32 v81, 0xbfb8aa3b, v81
    v_mul_f32 v82, 0xbfb8aa3b, v82
    v_mul_f32 v83, 0xbfb8aa3b, v83
    v_mul_f32 v84, 0xbfb8aa3b, v84
    v_mul_f32 v85, 0xbfb8aa3b, v85
    v_mul_f32 v86, 0xbfb8aa3b, v86
    v_mul_f32 v87, 0xbfb8aa3b, v87
    v_exp_f32 v80, v80
    v_exp_f32 v81, v81
    v_exp_f32 v82, v82
    v_exp_f32 v83, v83
    v_exp_f32 v84, v84
    v_exp_f32 v85, v85
    v_exp_f32 v86, v86
    v_exp_f32 v87, v87
    v_add_f32 v80, 1.0, v80
    v_add_f32 v81, 1.0, v81
    v_add_f32 v82, 1.0, v82
    v_add_f32 v83, 1.0, v83
    v_add_f32 v84, 1.0, v84
    v_add_f32 v85, 1.0, v85
    v_add_f32 v86, 1.0, v86
    v_add_f32 v87, 1.0, v87
    v_rcp_f32 v80, v80
    v_rcp_f32 v81, v81
    v_rcp_f32 v82, v82
    v_rcp_f32 v83, v83
    v_rcp_f32 v84, v84
    v_rcp_f32 v85, v85
    v_rcp_f32 v86, v86
    v_rcp_f32 v87, v87
    v_mul_f32 v80, v80, v88
    v_mul_f32 v81, v81, v89
    v_mul_f32 v82, v82, v90
    v_mul_f32 v83, v83, v91
    v_mul_f32 v84, v84, v92
    v_mul_f32 v85, v85, v93
    v_mul_f32 v86, v86, v94
    v_mul_f32 v87, v87, v95
    v_cvt_pk_bf16_f32 v20, v80, v81
    v_cvt_pk_bf16_f32 v21, v82, v83
    v_cvt_pk_bf16_f32 v22, v84, v85
    v_cvt_pk_bf16_f32 v23, v86, v87
    s_add_u32 s73, s72, 1024
    buffer_store_dwordx4 v[20:23], v1, s[60:63], s73 offen sc1
    v_mul_f32 v96, 0xbfb8aa3b, v96
    v_mul_f32 v97, 0xbfb8aa3b, v97
    v_mul_f32 v98, 0xbfb8aa3b, v98
    v_mul_f32 v99, 0xbfb8aa3b, v99
    v_mul_f32 v100, 0xbfb8aa3b, v100
    v_mul_f32 v101, 0xbfb8aa3b, v101
    v_mul_f32 v102, 0xbfb8aa3b, v102
    v_mul_f32 v103, 0xbfb8aa3b, v103
    v_exp_f32 v96, v96
    v_exp_f32 v97, v97
    v_exp_f32 v98, v98
    v_exp_f32 v99, v99
    v_exp_f32 v100, v100
    v_exp_f32 v101, v101
    v_exp_f32 v102, v102
    v_exp_f32 v103, v103
    v_add_f32 v96, 1.0, v96
    v_add_f32 v97, 1.0, v97
    v_add_f32 v98, 1.0, v98
    v_add_f32 v99, 1.0, v99
    v_add_f32 v100, 1.0, v100
    v_add_f32 v101, 1.0, v101
    v_add_f32 v102, 1.0, v102
    v_add_f32 v103, 1.0, v103
    v_rcp_f32 v96, v96
    v_rcp_f32 v97, v97
    v_rcp_f32 v98, v98
    v_rcp_f32 v99, v99
    v_rcp_f32 v100, v100
    v_rcp_f32 v101, v101
    v_rcp_f32 v102, v102
    v_rcp_f32 v103, v103
    v_mul_f32 v96, v96, v104
    v_mul_f32 v97, v97, v105
    v_mul_f32 v98, v98, v106
    v_mul_f32 v99, v99, v107
    v_mul_f32 v100, v100, v108
    v_mul_f32 v101, v101, v109
    v_mul_f32 v102, v102, v110
    v_mul_f32 v103, v103, v111
    v_cvt_pk_bf16_f32 v24, v96, v97
    v_cvt_pk_bf16_f32 v25, v98, v99
    v_cvt_pk_bf16_f32 v26, v100, v101
    v_cvt_pk_bf16_f32 v27, v102, v103
    s_add_u32 s73, s72, 2048
    buffer_store_dwordx4 v[24:27], v1, s[60:63], s73 offen sc1
    v_mul_f32 v112, 0xbfb8aa3b, v112
    v_mul_f32 v113, 0xbfb8aa3b, v113
    v_mul_f32 v114, 0xbfb8aa3b, v114
    v_mul_f32 v115, 0xbfb8aa3b, v115
    v_mul_f32 v116, 0xbfb8aa3b, v116
    v_mul_f32 v117, 0xbfb8aa3b, v117
    v_mul_f32 v118, 0xbfb8aa3b, v118
    v_mul_f32 v119, 0xbfb8aa3b, v119
    v_exp_f32 v112, v112
    v_exp_f32 v113, v113
    v_exp_f32 v114, v114
    v_exp_f32 v115, v115
    v_exp_f32 v116, v116
    v_exp_f32 v117, v117
    v_exp_f32 v118, v118
    v_exp_f32 v119, v119
    v_add_f32 v112, 1.0, v112
    v_add_f32 v113, 1.0, v113
    v_add_f32 v114, 1.0, v114
    v_add_f32 v115, 1.0, v115
    v_add_f32 v116, 1.0, v116
    v_add_f32 v117, 1.0, v117
    v_add_f32 v118, 1.0, v118
    v_add_f32 v119, 1.0, v119
    v_rcp_f32 v112, v112
    v_rcp_f32 v113, v113
    v_rcp_f32 v114, v114
    v_rcp_f32 v115, v115
    v_rcp_f32 v116, v116
    v_rcp_f32 v117, v117
    v_rcp_f32 v118, v118
    v_rcp_f32 v119, v119
    v_mul_f32 v112, v112, v120
    v_mul_f32 v113, v113, v121
    v_mul_f32 v114, v114, v122
    v_mul_f32 v115, v115, v123
    v_mul_f32 v116, v116, v124
    v_mul_f32 v117, v117, v125
    v_mul_f32 v118, v118, v126
    v_mul_f32 v119, v119, v127
    v_cvt_pk_bf16_f32 v28, v112, v113
    v_cvt_pk_bf16_f32 v29, v114, v115
    v_cvt_pk_bf16_f32 v30, v116, v117
    v_cvt_pk_bf16_f32 v31, v118, v119
    s_add_u32 s73, s72, 3072
    buffer_store_dwordx4 v[28:31], v1, s[60:63], s73 offen sc1
    v_mul_f32 v128, 0xbfb8aa3b, v128
    v_mul_f32 v129, 0xbfb8aa3b, v129
    v_mul_f32 v130, 0xbfb8aa3b, v130
    v_mul_f32 v131, 0xbfb8aa3b, v131
    v_mul_f32 v132, 0xbfb8aa3b, v132
    v_mul_f32 v133, 0xbfb8aa3b, v133
    v_mul_f32 v134, 0xbfb8aa3b, v134
    v_mul_f32 v135, 0xbfb8aa3b, v135
    v_exp_f32 v128, v128
    v_exp_f32 v129, v129
    v_exp_f32 v130, v130
    v_exp_f32 v131, v131
    v_exp_f32 v132, v132
    v_exp_f32 v133, v133
    v_exp_f32 v134, v134
    v_exp_f32 v135, v135
    v_add_f32 v128, 1.0, v128
    v_add_f32 v129, 1.0, v129
    v_add_f32 v130, 1.0, v130
    v_add_f32 v131, 1.0, v131
    v_add_f32 v132, 1.0, v132
    v_add_f32 v133, 1.0, v133
    v_add_f32 v134, 1.0, v134
    v_add_f32 v135, 1.0, v135
    v_rcp_f32 v128, v128
    v_rcp_f32 v129, v129
    v_rcp_f32 v130, v130
    v_rcp_f32 v131, v131
    v_rcp_f32 v132, v132
    v_rcp_f32 v133, v133
    v_rcp_f32 v134, v134
    v_rcp_f32 v135, v135
    v_mul_f32 v128, v128, v136
    v_mul_f32 v129, v129, v137
    v_mul_f32 v130, v130, v138
    v_mul_f32 v131, v131, v139
    v_mul_f32 v132, v132, v140
    v_mul_f32 v133, v133, v141
    v_mul_f32 v134, v134, v142
    v_mul_f32 v135, v135, v143
    v_cvt_pk_bf16_f32 v16, v128, v129
    v_cvt_pk_bf16_f32 v17, v130, v131
    v_cvt_pk_bf16_f32 v18, v132, v133
    v_cvt_pk_bf16_f32 v19, v134, v135
    s_add_u32 s73, s72, 4096
    buffer_store_dwordx4 v[16:19], v1, s[60:63], s73 offen sc1
    v_mul_f32 v144, 0xbfb8aa3b, v144
    v_mul_f32 v145, 0xbfb8aa3b, v145
    v_mul_f32 v146, 0xbfb8aa3b, v146
    v_mul_f32 v147, 0xbfb8aa3b, v147
    v_mul_f32 v148, 0xbfb8aa3b, v148
    v_mul_f32 v149, 0xbfb8aa3b, v149
    v_mul_f32 v150, 0xbfb8aa3b, v150
    v_mul_f32 v151, 0xbfb8aa3b, v151
    v_exp_f32 v144, v144
    v_exp_f32 v145, v145
    v_exp_f32 v146, v146
    v_exp_f32 v147, v147
    v_exp_f32 v148, v148
    v_exp_f32 v149, v149
    v_exp_f32 v150, v150
    v_exp_f32 v151, v151
    v_add_f32 v144, 1.0, v144
    v_add_f32 v145, 1.0, v145
    v_add_f32 v146, 1.0, v146
    v_add_f32 v147, 1.0, v147
    v_add_f32 v148, 1.0, v148
    v_add_f32 v149, 1.0, v149
    v_add_f32 v150, 1.0, v150
    v_add_f32 v151, 1.0, v151
    v_rcp_f32 v144, v144
    v_rcp_f32 v145, v145
    v_rcp_f32 v146, v146
    v_rcp_f32 v147, v147
    v_rcp_f32 v148, v148
    v_rcp_f32 v149, v149
    v_rcp_f32 v150, v150
    v_rcp_f32 v151, v151
    v_mul_f32 v144, v144, v152
    v_mul_f32 v145, v145, v153
    v_mul_f32 v146, v146, v154
    v_mul_f32 v147, v147, v155
    v_mul_f32 v148, v148, v156
    v_mul_f32 v149, v149, v157
    v_mul_f32 v150, v150, v158
    v_mul_f32 v151, v151, v159
    v_cvt_pk_bf16_f32 v20, v144, v145
    v_cvt_pk_bf16_f32 v21, v146, v147
    v_cvt_pk_bf16_f32 v22, v148, v149
    v_cvt_pk_bf16_f32 v23, v150, v151
    s_add_u32 s73, s72, 5120
    buffer_store_dwordx4 v[20:23], v1, s[60:63], s73 offen sc1
P4_fin_92:
    s_waitcnt vmcnt(0)
    s_barrier
    s_lshl_b32 s71, s68, 4
    s_add_u32 s71, s71, s69
    s_cmp_lg_u32 s40, 0
    s_cbranch_scc1 sig_96
    s_lshl_b32 s94, s71, 6
    s_add_u32 s94, s94, 65600
    v_mov_b32 v250, s41
    v_mov_b32 v251, 0
    s_mov_b64 exec, 1
    buffer_store_dword v250, v251, s[96:99], s94 offen sc1
    s_mov_b64 exec, -1
sig_96:
    s_and_b32 s71, s2, 7
    s_lshr_b32 s72, s2, 3
    s_and_b32 s73, s71, 3
    s_lshl_b32 s73, s73, 3
    s_and_b32 s74, s72, 7
    s_add_u32 s68, s73, s74
    s_lshr_b32 s73, s71, 2
    s_lshl_b32 s73, s73, 2
    s_lshr_b32 s74, s72, 3
    s_add_u32 s69, s73, s74
    s_add_u32 s44, s38, 0x2c00000
    s_addc_u32 s45, s39, 0
    s_mov_b32 s46, 0x1e0000
    s_mov_b32 s47, 0x20000
    s_add_u32 s48, s38, 0x2500000
    s_addc_u32 s49, s39, 0
    s_mov_b32 s50, 0x600000
    s_mov_b32 s51, 0x20000
    s_add_u32 s52, s38, 0x80000
    s_addc_u32 s53, s39, 0
    s_mov_b32 s54, 0x20000
    s_mov_b32 s55, 0x20000
    s_add_u32 s60, s38, 0x1a00000
    s_addc_u32 s61, s39, 0
    s_mov_b32 s62, 0x280000
    s_mov_b32 s63, 0x20000
    v_lshlrev_b32 v1, 4, v0
    v_and_b32 v2, 31, v0
    v_lshrrev_b32 v3, 5, v0
    s_cmp_lt_u32 s40, 4
    s_cbranch_scc1 P5_comp_97
    s_sub_u32 s70, s40, 4
    s_lshl_b32 s72, s70, 10
    v_add_u32 v7, s72, v1
    s_mul_i32 s77, s70, 5120
    s_mul_i32 s73, s69, 245760
    s_add_u32 s73, s73, s77
    s_lshl_b32 s74, s68, 1
    s_mul_i32 s74, s74, 98304
    s_add_u32 m0, s77, 0
    s_add_u32 s75, s73, 0
    buffer_load_dwordx4 v1, s[44:47], s75 offen sc1 lds
    s_add_u32 m0, s77, 1024
    s_add_u32 s75, s73, 1024
    buffer_load_dwordx4 v1, s[44:47], s75 offen sc1 lds
    s_add_u32 m0, s77, 2048
    s_add_u32 s75, s73, 2048
    buffer_load_dwordx4 v1, s[44:47], s75 offen sc1 lds
    s_add_u32 m0, s77, 3072
    s_add_u32 s75, s73, 3072
    buffer_load_dwordx4 v1, s[44:47], s75 offen sc1 lds
    s_add_u32 m0, s77, 4096
    s_add_u32 s75, s73, 4096
    buffer_load_dwordx4 v1, s[44:47], s75 offen sc1 lds
    s_add_u32 m0, s77, 20480
    s_add_u32 s75, s73, 20480
    buffer_load_dwordx4 v1, s[44:47], s75 offen sc1 lds
    s_add_u32 m0, s77, 21504
    s_add_u32 s75, s73, 21504
    buffer_load_dwordx4 v1, s[44:47], s75 offen sc1 lds
    s_add_u32 m0, s77, 22528
    s_add_u32 s75, s73, 22528
    buffer_load_dwordx4 v1, s[44:47], s75 offen sc1 lds
    s_add_u32 m0, s77, 23552
    s_add_u32 s75, s73, 23552
    buffer_load_dwordx4 v1, s[44:47], s75 offen sc1 lds
    s_add_u32 m0, s77, 24576
    s_add_u32 s75, s73, 24576
    buffer_load_dwordx4 v1, s[44:47], s75 offen sc1 lds
    s_add_u32 m0, s77, 40960
    s_add_u32 s75, s73, 40960
    buffer_load_dwordx4 v1, s[44:47], s75 offen sc1 lds
    s_add_u32 m0, s77, 41984
    s_add_u32 s75, s73, 41984
    buffer_load_dwordx4 v1, s[44:47], s75 offen sc1 lds
    s_add_u32 m0, s77, 43008
    s_add_u32 s75, s73, 43008
    buffer_load_dwordx4 v1, s[44:47], s75 offen sc1 lds
    s_add_u32 m0, s77, 44032
    s_add_u32 s75, s73, 44032
    buffer_load_dwordx4 v1, s[44:47], s75 offen sc1 lds
    s_add_u32 m0, s77, 45056
    s_add_u32 s75, s73, 45056
    buffer_load_dwordx4 v1, s[44:47], s75 offen sc1 lds
    s_lshl_b32 s78, s68, 1
    s_mul_i32 s78, s78, 40960
    s_mul_i32 s79, s69, 5120
    s_add_u32 s78, s78, s79
    s_add_u32 s79, s70, 0
    s_cmp_ge_u32 s79, 5
    s_cselect_b32 s80, 35840, 0
    s_lshl_b32 s79, s79, 10
    s_add_u32 m0, s79, 131072
    s_add_u32 s79, s79, s80
    s_add_u32 s79, s79, s78
    buffer_load_dwordx4 v1, s[60:63], s79 offen sc1 lds
    s_add_u32 s79, s70, 4
    s_cmp_ge_u32 s79, 5
    s_cselect_b32 s80, 35840, 0
    s_lshl_b32 s79, s79, 10
    s_add_u32 m0, s79, 131072
    s_add_u32 s79, s79, s80
    s_add_u32 s79, s79, s78
    buffer_load_dwordx4 v1, s[60:63], s79 offen sc1 lds
    s_cmp_ge_u32 s70, 2
    s_cbranch_scc1 res_100
    s_add_u32 s79, s70, 8
    s_cmp_ge_u32 s79, 5
    s_cselect_b32 s80, 35840, 0
    s_lshl_b32 s79, s79, 10
    s_add_u32 m0, s79, 131072
    s_add_u32 s79, s79, s80
    s_add_u32 s79, s79, s78
    buffer_load_dwordx4 v1, s[60:63], s79 offen sc1 lds
res_100:
    s_barrier
    s_add_u32 m0, s72, 81920
    s_add_u32 s75, s74, 0
    buffer_load_dwordx4 v7, s[48:51], s75 offen sc1 lds
    s_add_u32 m0, s72, 86016
    s_add_u32 s75, s74, 4096
    buffer_load_dwordx4 v7, s[48:51], s75 offen sc1 lds
    s_add_u32 m0, s72, 90112
    s_add_u32 s75, s74, 98304
    buffer_load_dwordx4 v7, s[48:51], s75 offen sc1 lds
    s_add_u32 m0, s72, 94208
    s_add_u32 s75, s74, 102400
    buffer_load_dwordx4 v7, s[48:51], s75 offen sc1 lds
    s_add_u32 m0, s72, 98304
    s_add_u32 s75, s74, 8192
    buffer_load_dwordx4 v7, s[48:51], s75 offen sc1 lds
    s_add_u32 m0, s72, 102400
    s_add_u32 s75, s74, 12288
    buffer_load_dwordx4 v7, s[48:51], s75 offen sc1 lds
    s_add_u32 m0, s72, 106496
    s_add_u32 s75, s74, 106496
    buffer_load_dwordx4 v7, s[48:51], s75 offen sc1 lds
    s_add_u32 m0, s72, 110592
    s_add_u32 s75, s74, 110592
    buffer_load_dwordx4 v7, s[48:51], s75 offen sc1 lds
    s_waitcnt vmcnt(4)
    s_barrier
    s_add_u32 m0, s72, 114688
    s_add_u32 s75, s74, 16384
    buffer_load_dwordx4 v7, s[48:51], s75 offen sc1 lds
    s_add_u32 m0, s72, 118784
    s_add_u32 s75, s74, 20480
    buffer_load_dwordx4 v7, s[48:51], s75 offen sc1 lds
    s_add_u32 m0, s72, 122880
    s_add_u32 s75, s74, 114688
    buffer_load_dwordx4 v7, s[48:51], s75 offen sc1 lds
    s_add_u32 m0, s72, 126976
    s_add_u32 s75, s74, 118784
    buffer_load_dwordx4 v7, s[48:51], s75 offen sc1 lds
    s_add_u32 m0, s77, 61440
    s_add_u32 s75, s73, 61440
    buffer_load_dwordx4 v1, s[44:47], s75 offen sc1 lds
    s_add_u32 m0, s77, 62464
    s_add_u32 s75, s73, 62464
    buffer_load_dwordx4 v1, s[44:47], s75 offen sc1 lds
    s_add_u32 m0, s77, 63488
    s_add_u32 s75, s73, 63488
    buffer_load_dwordx4 v1, s[44:47], s75 offen sc1 lds
    s_add_u32 m0, s77, 64512
    s_add_u32 s75, s73, 64512
    buffer_load_dwordx4 v1, s[44:47], s75 offen sc1 lds
    s_add_u32 m0, s77, 65536
    s_add_u32 s75, s73, 65536
    buffer_load_dwordx4 v1, s[44:47], s75 offen sc1 lds
    s_waitcnt vmcnt(9)
    s_barrier
    s_add_u32 m0, s72, 81920
    s_add_u32 s75, s74, 24576
    buffer_load_dwordx4 v7, s[48:51], s75 offen sc1 lds
    s_add_u32 m0, s72, 86016
    s_add_u32 s75, s74, 28672
    buffer_load_dwordx4 v7, s[48:51], s75 offen sc1 lds
    s_add_u32 m0, s72, 90112
    s_add_u32 s75, s74, 122880
    buffer_load_dwordx4 v7, s[48:51], s75 offen sc1 lds
    s_add_u32 m0, s72, 94208
    s_add_u32 s75, s74, 126976
    buffer_load_dwordx4 v7, s[48:51], s75 offen sc1 lds
    s_add_u32 m0, s77, 0
    s_add_u32 s75, s73, 81920
    buffer_load_dwordx4 v1, s[44:47], s75 offen sc1 lds
    s_add_u32 m0, s77, 1024
    s_add_u32 s75, s73, 82944
    buffer_load_dwordx4 v1, s[44:47], s75 offen sc1 lds
    s_add_u32 m0, s77, 2048
    s_add_u32 s75, s73, 83968
    buffer_load_dwordx4 v1, s[44:47], s75 offen sc1 lds
    s_add_u32 m0, s77, 3072
    s_add_u32 s75, s73, 84992
    buffer_load_dwordx4 v1, s[44:47], s75 offen sc1 lds
    s_add_u32 m0, s77, 4096
    s_add_u32 s75, s73, 86016
    buffer_load_dwordx4 v1, s[44:47], s75 offen sc1 lds
    s_waitcnt vmcnt(14)
    s_barrier
    s_add_u32 m0, s72, 98304
    s_add_u32 s75, s74, 32768
    buffer_load_dwordx4 v7, s[48:51], s75 offen sc1 lds
    s_add_u32 m0, s72, 102400
    s_add_u32 s75, s74, 36864
    buffer_load_dwordx4 v7, s[48:51], s75 offen sc1 lds
    s_add_u32 m0, s72, 106496
    s_add_u32 s75, s74, 131072
    buffer_load_dwordx4 v7, s[48:51], s75 offen sc1 lds
    s_add_u32 m0, s72, 110592
    s_add_u32 s75, s74, 135168
    buffer_load_dwordx4 v7, s[48:51], s75 offen sc1 lds
    s_add_u32 m0, s77, 20480
    s_add_u32 s75, s73, 102400
    buffer_load_dwordx4 v1, s[44:47], s75 offen sc1 lds
    s_add_u32 m0, s77, 21504
    s_add_u32 s75, s73, 103424
    buffer_load_dwordx4 v1, s[44:47], s75 offen sc1 lds
    s_add_u32 m0, s77, 22528
    s_add_u32 s75, s73, 104448
    buffer_load_dwordx4 v1, s[44:47], s75 offen sc1 lds
    s_add_u32 m0, s77, 23552
    s_add_u32 s75, s73, 105472
    buffer_load_dwordx4 v1, s[44:47], s75 offen sc1 lds
    s_add_u32 m0, s77, 24576
    s_add_u32 s75, s73, 106496
    buffer_load_dwordx4 v1, s[44:47], s75 offen sc1 lds
    s_waitcnt vmcnt(14)
    s_barrier
    s_add_u32 m0, s72, 114688
    s_add_u32 s75, s74, 40960
    buffer_load_dwordx4 v7, s[48:51], s75 offen sc1 lds
    s_add_u32 m0, s72, 118784
    s_add_u32 s75, s74, 45056
    buffer_load_dwordx4 v7, s[48:51], s75 offen sc1 lds
    s_add_u32 m0, s72, 122880
    s_add_u32 s75, s74, 139264
    buffer_load_dwordx4 v7, s[48:51], s75 offen sc1 lds
    s_add_u32 m0, s72, 126976
    s_add_u32 s75, s74, 143360
    buffer_load_dwordx4 v7, s[48:51], s75 offen sc1 lds
    s_add_u32 m0, s77, 40960
    s_add_u32 s75, s73, 122880
    buffer_load_dwordx4 v1, s[44:47], s75 offen sc1 lds
    s_add_u32 m0, s77, 41984
    s_add_u32 s75, s73, 123904
    buffer_load_dwordx4 v1, s[44:47], s75 offen sc1 lds
    s_add_u32 m0, s77, 43008
    s_add_u32 s75, s73, 124928
    buffer_load_dwordx4 v1, s[44:47], s75 offen sc1 lds
    s_add_u32 m0, s77, 44032
    s_add_u32 s75, s73, 125952
    buffer_load_dwordx4 v1, s[44:47], s75 offen sc1 lds
    s_add_u32 m0, s77, 45056
    s_add_u32 s75, s73, 126976
    buffer_load_dwordx4 v1, s[44:47], s75 offen sc1 lds
    s_waitcnt vmcnt(14)
    s_barrier
    s_add_u32 m0, s72, 81920
    s_add_u32 s75, s74, 49152
    buffer_load_dwordx4 v7, s[48:51], s75 offen sc1 lds
    s_add_u32 m0, s72, 86016
    s_add_u32 s75, s74, 53248
    buffer_load_dwordx4 v7, s[48:51], s75 offen sc1 lds
    s_add_u32 m0, s72, 90112
    s_add_u32 s75, s74, 147456
    buffer_load_dwordx4 v7, s[48:51], s75 offen sc1 lds
    s_add_u32 m0, s72, 94208
    s_add_u32 s75, s74, 151552
    buffer_load_dwordx4 v7, s[48:51], s75 offen sc1 lds
    s_add_u32 m0, s77, 61440
    s_add_u32 s75, s73, 143360
    buffer_load_dwordx4 v1, s[44:47], s75 offen sc1 lds
    s_add_u32 m0, s77, 62464
    s_add_u32 s75, s73, 144384
    buffer_load_dwordx4 v1, s[44:47], s75 offen sc1 lds
    s_add_u32 m0, s77, 63488
    s_add_u32 s75, s73, 145408
    buffer_load_dwordx4 v1, s[44:47], s75 offen sc1 lds
    s_add_u32 m0, s77, 64512
    s_add_u32 s75, s73, 146432
    buffer_load_dwordx4 v1, s[44:47], s75 offen sc1 lds
    s_add_u32 m0, s77, 65536
    s_add_u32 s75, s73, 147456
    buffer_load_dwordx4 v1, s[44:47], s75 offen sc1 lds
    s_waitcnt vmcnt(14)
    s_barrier
    s_add_u32 m0, s72, 98304
    s_add_u32 s75, s74, 57344
    buffer_load_dwordx4 v7, s[48:51], s75 offen sc1 lds
    s_add_u32 m0, s72, 102400
    s_add_u32 s75, s74, 61440
    buffer_load_dwordx4 v7, s[48:51], s75 offen sc1 lds
    s_add_u32 m0, s72, 106496
    s_add_u32 s75, s74, 155648
    buffer_load_dwordx4 v7, s[48:51], s75 offen sc1 lds
    s_add_u32 m0, s72, 110592
    s_add_u32 s75, s74, 159744
    buffer_load_dwordx4 v7, s[48:51], s75 offen sc1 lds
    s_add_u32 m0, s77, 0
    s_add_u32 s75, s73, 163840
    buffer_load_dwordx4 v1, s[44:47], s75 offen sc1 lds
    s_add_u32 m0, s77, 1024
    s_add_u32 s75, s73, 164864
    buffer_load_dwordx4 v1, s[44:47], s75 offen sc1 lds
    s_add_u32 m0, s77, 2048
    s_add_u32 s75, s73, 165888
    buffer_load_dwordx4 v1, s[44:47], s75 offen sc1 lds
    s_add_u32 m0, s77, 3072
    s_add_u32 s75, s73, 166912
    buffer_load_dwordx4 v1, s[44:47], s75 offen sc1 lds
    s_add_u32 m0, s77, 4096
    s_add_u32 s75, s73, 167936
    buffer_load_dwordx4 v1, s[44:47], s75 offen sc1 lds
    s_waitcnt vmcnt(14)
    s_barrier
    s_add_u32 m0, s72, 114688
    s_add_u32 s75, s74, 65536
    buffer_load_dwordx4 v7, s[48:51], s75 offen sc1 lds
    s_add_u32 m0, s72, 118784
    s_add_u32 s75, s74, 69632
    buffer_load_dwordx4 v7, s[48:51], s75 offen sc1 lds
    s_add_u32 m0, s72, 122880
    s_add_u32 s75, s74, 163840
    buffer_load_dwordx4 v7, s[48:51], s75 offen sc1 lds
    s_add_u32 m0, s72, 126976
    s_add_u32 s75, s74, 167936
    buffer_load_dwordx4 v7, s[48:51], s75 offen sc1 lds
    s_add_u32 m0, s77, 20480
    s_add_u32 s75, s73, 184320
    buffer_load_dwordx4 v1, s[44:47], s75 offen sc1 lds
    s_add_u32 m0, s77, 21504
    s_add_u32 s75, s73, 185344
    buffer_load_dwordx4 v1, s[44:47], s75 offen sc1 lds
    s_add_u32 m0, s77, 22528
    s_add_u32 s75, s73, 186368
    buffer_load_dwordx4 v1, s[44:47], s75 offen sc1 lds
    s_add_u32 m0, s77, 23552
    s_add_u32 s75, s73, 187392
    buffer_load_dwordx4 v1, s[44:47], s75 offen sc1 lds
    s_add_u32 m0, s77, 24576
    s_add_u32 s75, s73, 188416
    buffer_load_dwordx4 v1, s[44:47], s75 offen sc1 lds
    s_waitcnt vmcnt(14)
    s_barrier
    s_add_u32 m0, s72, 81920
    s_add_u32 s75, s74, 73728
    buffer_load_dwordx4 v7, s[48:51], s75 offen sc1 lds
    s_add_u32 m0, s72, 86016
    s_add_u32 s75, s74, 77824
    buffer_load_dwordx4 v7, s[48:51], s75 offen sc1 lds
    s_add_u32 m0, s72, 90112
    s_add_u32 s75, s74, 172032
    buffer_load_dwordx4 v7, s[48:51], s75 offen sc1 lds
    s_add_u32 m0, s72, 94208
    s_add_u32 s75, s74, 176128
    buffer_load_dwordx4 v7, s[48:51], s75 offen sc1 lds
    s_add_u32 m0, s77, 40960
    s_add_u32 s75, s73, 204800
    buffer_load_dwordx4 v1, s[44:47], s75 offen sc1 lds
    s_add_u32 m0, s77, 41984
    s_add_u32 s75, s73, 205824
    buffer_load_dwordx4 v1, s[44:47], s75 offen sc1 lds
    s_add_u32 m0, s77, 43008
    s_add_u32 s75, s73, 206848
    buffer_load_dwordx4 v1, s[44:47], s75 offen sc1 lds
    s_add_u32 m0, s77, 44032
    s_add_u32 s75, s73, 207872
    buffer_load_dwordx4 v1, s[44:47], s75 offen sc1 lds
    s_add_u32 m0, s77, 45056
    s_add_u32 s75, s73, 208896
    buffer_load_dwordx4 v1, s[44:47], s75 offen sc1 lds
    s_waitcnt vmcnt(14)
    s_barrier
    s_add_u32 m0, s72, 98304
    s_add_u32 s75, s74, 81920
    buffer_load_dwordx4 v7, s[48:51], s75 offen sc1 lds
    s_add_u32 m0, s72, 102400
    s_add_u32 s75, s74, 86016
    buffer_load_dwordx4 v7, s[48:51], s75 offen sc1 lds
    s_add_u32 m0, s72, 106496
    s_add_u32 s75, s74, 180224
    buffer_load_dwordx4 v7, s[48:51], s75 offen sc1 lds
    s_add_u32 m0, s72, 110592
    s_add_u32 s75, s74, 184320
    buffer_load_dwordx4 v7, s[48:51], s75 offen sc1 lds
    s_add_u32 m0, s77, 61440
    s_add_u32 s75, s73, 225280
    buffer_load_dwordx4 v1, s[44:47], s75 offen sc1 lds
    s_add_u32 m0, s77, 62464
    s_add_u32 s75, s73, 226304
    buffer_load_dwordx4 v1, s[44:47], s75 offen sc1 lds
    s_add_u32 m0, s77, 63488
    s_add_u32 s75, s73, 227328
    buffer_load_dwordx4 v1, s[44:47], s75 offen sc1 lds
    s_add_u32 m0, s77, 64512
    s_add_u32 s75, s73, 228352
    buffer_load_dwordx4 v1, s[44:47], s75 offen sc1 lds
    s_add_u32 m0, s77, 65536
    s_add_u32 s75, s73, 229376
    buffer_load_dwordx4 v1, s[44:47], s75 offen sc1 lds
    s_waitcnt vmcnt(14)
    s_barrier
    s_add_u32 m0, s72, 114688
    s_add_u32 s75, s74, 90112
    buffer_load_dwordx4 v7, s[48:51], s75 offen sc1 lds
    s_add_u32 m0, s72, 118784
    s_add_u32 s75, s74, 94208
    buffer_load_dwordx4 v7, s[48:51], s75 offen sc1 lds
    s_add_u32 m0, s72, 122880
    s_add_u32 s75, s74, 188416
    buffer_load_dwordx4 v7, s[48:51], s75 offen sc1 lds
    s_add_u32 m0, s72, 126976
    s_add_u32 s75, s74, 192512
    buffer_load_dwordx4 v7, s[48:51], s75 offen sc1 lds
    s_waitcnt vmcnt(9)
    s_barrier
    s_waitcnt vmcnt(0)
    s_barrier
    s_barrier
    s_branch P5_fin_99
P5_comp_97:
    s_cmp_eq_u32 s40, 3
    s_cbranch_scc1 P5_w3_98
    s_mov_b32 s56, s34
    s_mov_b32 s57, s35
    s_mov_b32 s58, 0x280000
    s_mov_b32 s59, 0x20000
    v_bfe_u32 v11, v0, 2, 2
    v_bfe_u32 v12, v0, 4, 1
    v_and_b32 v13, 3, v0
    v_lshl_add_u32 v11, v3, 2, v11
    v_mul_u32_u24 v11, 160, v11
    s_cmp_eq_u32 s40, 2
    s_cselect_b32 s71, 0, 32
    v_mul_u32_u24 v12, s71, v12
    v_add_u32 v11, v11, v12
    v_lshl_add_u32 v11, v13, 3, v11
    s_lshl_b32 s71, s40, 6
    v_add_u32 v11, s71, v11
    v_mov_b32 v4, v11
    v_add_u32 v5, 65536, v11
    s_lshr_b32 s71, s68, 1
    s_lshl_b32 s71, s71, 4
    v_and_b32 v240, 15, v0
    v_add_u32 v240, s71, v240
    s_cmp_lg_u32 s40, 0
    s_cbranch_scc1 wf_101
    s_cmp_lg_u32 s42, 0
    s_cbranch_scc1 wf_101
    v_lshlrev_b32 v240, 6, v240
    v_add_u32 v240, 65600, v240
    s_mov_b32 s94, 30000
wf_poll_102:
    buffer_load_dword v250, v240, s[96:99], 0 offen sc1
    s_waitcnt vmcnt(0)
    v_cmp_ne_u32 vcc, s41, v250
    s_nop 1
    s_cbranch_vccz wf_101
    s_sleep 1
    s_sub_u32 s94, s94, 1
    s_cmp_lg_u32 s94, 0
    s_cbranch_scc1 wf_poll_102
wf_done_103:
    s_mov_b32 s42, 1
wf_101:
    s_barrier
    v_add_u32 v12, 81920, v1
    v_mov_b32 v8, v12
    v_add_u32 v9, 65536, v12
    s_barrier
    ds_read_b64_tr_b16 v[32:33], v4 offset:0
    ds_read_b64_tr_b16 v[34:35], v4 offset:1280
    ds_read_b128 v[16:19], v8 offset:0
    ds_read_b128 v[20:23], v8 offset:8192
    ds_read_b64_tr_b16 v[36:37], v4 offset:2560
    ds_read_b64_tr_b16 v[38:39], v4 offset:3840
    ds_read_b128 v[24:27], v8 offset:1024
    ds_read_b128 v[28:31], v8 offset:9216
    s_waitcnt lgkmcnt(5)
    v_mfma_f32_32x32x16_bf16 v[64:79], v[32:35], v[16:19], 0
    ds_read_b64_tr_b16 v[40:41], v4 offset:5120
    ds_read_b64_tr_b16 v[42:43], v4 offset:6400
    ds_read_b128 v[16:19], v8 offset:2048
    s_waitcnt lgkmcnt(7)
    v_mfma_f32_32x32x16_bf16 v[80:95], v[32:35], v[20:23], 0
    ds_read_b128 v[20:23], v8 offset:10240
    s_waitcnt lgkmcnt(5)
    v_mfma_f32_32x32x16_bf16 v[64:79], v[36:39], v[24:27], v[64:79]
    ds_read_b64_tr_b16 v[32:33], v4 offset:7680
    ds_read_b64_tr_b16 v[34:35], v4 offset:8960
    ds_read_b128 v[24:27], v8 offset:3072
    s_waitcnt lgkmcnt(7)
    v_mfma_f32_32x32x16_bf16 v[80:95], v[36:39], v[28:31], v[80:95]
    ds_read_b128 v[28:31], v8 offset:11264
    s_waitcnt lgkmcnt(5)
    v_mfma_f32_32x32x16_bf16 v[64:79], v[40:43], v[16:19], v[64:79]
    ds_read_b64_tr_b16 v[36:37], v4 offset:10240
    ds_read_b64_tr_b16 v[38:39], v4 offset:11520
    ds_read_b128 v[16:19], v8 offset:4096
    s_waitcnt lgkmcnt(7)
    v_mfma_f32_32x32x16_bf16 v[80:95], v[40:43], v[20:23], v[80:95]
    ds_read_b128 v[20:23], v8 offset:12288
    s_waitcnt lgkmcnt(5)
    v_mfma_f32_32x32x16_bf16 v[64:79], v[32:35], v[24:27], v[64:79]
    ds_read_b64_tr_b16 v[40:41], v4 offset:12800
    ds_read_b64_tr_b16 v[42:43], v4 offset:14080
    ds_read_b128 v[24:27], v8 offset:5120
    s_waitcnt lgkmcnt(7)
    v_mfma_f32_32x32x16_bf16 v[80:95], v[32:35], v[28:31], v[80:95]
    ds_read_b128 v[28:31], v8 offset:13312
    s_waitcnt lgkmcnt(5)
    v_mfma_f32_32x32x16_bf16 v[64:79], v[36:39], v[16:19], v[64:79]
    ds_read_b64_tr_b16 v[32:33], v4 offset:15360
    ds_read_b64_tr_b16 v[34:35], v4 offset:16640
    ds_read_b128 v[16:19], v8 offset:6144
    s_waitcnt lgkmcnt(7)
    v_mfma_f32_32x32x16_bf16 v[80:95], v[36:39], v[20:23], v[80:95]
    ds_read_b128 v[20:23], v8 offset:14336
    s_waitcnt lgkmcnt(5)
    v_mfma_f32_32x32x16_bf16 v[64:79], v[40:43], v[24:27], v[64:79]
    ds_read_b64_tr_b16 v[36:37], v4 offset:17920
    ds_read_b64_tr_b16 v[38:39], v4 offset:19200
    ds_read_b128 v[24:27], v8 offset:7168
    s_waitcnt lgkmcnt(7)
    v_mfma_f32_32x32x16_bf16 v[80:95], v[40:43], v[28:31], v[80:95]
    ds_read_b128 v[28:31], v8 offset:15360
    s_waitcnt lgkmcnt(5)
    v_mfma_f32_32x32x16_bf16 v[64:79], v[32:35], v[16:19], v[64:79]
    s_waitcnt lgkmcnt(4)
    v_mfma_f32_32x32x16_bf16 v[80:95], v[32:35], v[20:23], v[80:95]
    s_waitcnt lgkmcnt(0)
    s_barrier
    ds_read_b64_tr_b16 v[40:41], v4 offset:20480
    ds_read_b64_tr_b16 v[42:43], v4 offset:21760
    ds_read_b128 v[16:19], v8 offset:16384
    ds_read_b128 v[20:23], v8 offset:24576
    v_mfma_f32_32x32x16_bf16 v[64:79], v[36:39], v[24:27], v[64:79]
    ds_read_b64_tr_b16 v[32:33], v4 offset:23040
    ds_read_b64_tr_b16 v[34:35], v4 offset:24320
    ds_read_b128 v[24:27], v8 offset:17408
    v_mfma_f32_32x32x16_bf16 v[80:95], v[36:39], v[28:31], v[80:95]
    ds_read_b128 v[28:31], v8 offset:25600
    s_waitcnt lgkmcnt(5)
    v_mfma_f32_32x32x16_bf16 v[64:79], v[40:43], v[16:19], v[64:79]
    ds_read_b64_tr_b16 v[36:37], v4 offset:25600
    ds_read_b64_tr_b16 v[38:39], v4 offset:26880
    ds_read_b128 v[16:19], v8 offset:18432
    s_waitcnt lgkmcnt(7)
    v_mfma_f32_32x32x16_bf16 v[80:95], v[40:43], v[20:23], v[80:95]
    ds_read_b128 v[20:23], v8 offset:26624
    s_waitcnt lgkmcnt(5)
    v_mfma_f32_32x32x16_bf16 v[64:79], v[32:35], v[24:27], v[64:79]
    ds_read_b64_tr_b16 v[40:41], v4 offset:28160
    ds_read_b64_tr_b16 v[42:43], v4 offset:29440
    ds_read_b128 v[24:27], v8 offset:19456
    s_waitcnt lgkmcnt(7)
    v_mfma_f32_32x32x16_bf16 v[80:95], v[32:35], v[28:31], v[80:95]
    ds_read_b128 v[28:31], v8 offset:27648
    s_waitcnt lgkmcnt(5)
    v_mfma_f32_32x32x16_bf16 v[64:79], v[36:39], v[16:19], v[64:79]
    ds_read_b64_tr_b16 v[32:33], v4 offset:30720
    ds_read_b64_tr_b16 v[34:35], v4 offset:32000
    ds_read_b128 v[16:19], v8 offset:20480
    s_waitcnt lgkmcnt(7)
    v_mfma_f32_32x32x16_bf16 v[80:95], v[36:39], v[20:23], v[80:95]
    ds_read_b128 v[20:23], v8 offset:28672
    s_waitcnt lgkmcnt(5)
    v_mfma_f32_32x32x16_bf16 v[64:79], v[40:43], v[24:27], v[64:79]
    ds_read_b64_tr_b16 v[36:37], v4 offset:33280
    ds_read_b64_tr_b16 v[38:39], v4 offset:34560
    ds_read_b128 v[24:27], v8 offset:21504
    s_waitcnt lgkmcnt(7)
    v_mfma_f32_32x32x16_bf16 v[80:95], v[40:43], v[28:31], v[80:95]
    ds_read_b128 v[28:31], v8 offset:29696
    s_waitcnt lgkmcnt(5)
    v_mfma_f32_32x32x16_bf16 v[64:79], v[32:35], v[16:19], v[64:79]
    ds_read_b64_tr_b16 v[40:41], v4 offset:35840
    ds_read_b64_tr_b16 v[42:43], v4 offset:37120
    ds_read_b128 v[16:19], v8 offset:22528
    s_waitcnt lgkmcnt(7)
    v_mfma_f32_32x32x16_bf16 v[80:95], v[32:35], v[20:23], v[80:95]
    ds_read_b128 v[20:23], v8 offset:30720
    s_waitcnt lgkmcnt(5)
    v_mfma_f32_32x32x16_bf16 v[64:79], v[36:39], v[24:27], v[64:79]
    ds_read_b64_tr_b16 v[32:33], v4 offset:38400
    ds_read_b64_tr_b16 v[34:35], v4 offset:39680
    ds_read_b128 v[24:27], v8 offset:23552
    s_waitcnt lgkmcnt(7)
    v_mfma_f32_32x32x16_bf16 v[80:95], v[36:39], v[28:31], v[80:95]
    ds_read_b128 v[28:31], v8 offset:31744
    s_waitcnt lgkmcnt(5)
    v_mfma_f32_32x32x16_bf16 v[64:79], v[40:43], v[16:19], v[64:79]
    s_waitcnt lgkmcnt(4)
    v_mfma_f32_32x32x16_bf16 v[80:95], v[40:43], v[20:23], v[80:95]
    s_waitcnt lgkmcnt(0)
    s_barrier
    ds_read_b64_tr_b16 v[36:37], v4 offset:40960
    ds_read_b64_tr_b16 v[38:39], v4 offset:42240
    ds_read_b128 v[16:19], v8 offset:32768
    ds_read_b128 v[20:23], v8 offset:40960
    v_mfma_f32_32x32x16_bf16 v[64:79], v[32:35], v[24:27], v[64:79]
    ds_read_b64_tr_b16 v[40:41], v4 offset:43520
    ds_read_b64_tr_b16 v[42:43], v4 offset:44800
    ds_read_b128 v[24:27], v8 offset:33792
    v_mfma_f32_32x32x16_bf16 v[80:95], v[32:35], v[28:31], v[80:95]
    ds_read_b128 v[28:31], v8 offset:41984
    s_waitcnt lgkmcnt(5)
    v_mfma_f32_32x32x16_bf16 v[64:79], v[36:39], v[16:19], v[64:79]
    ds_read_b64_tr_b16 v[32:33], v4 offset:46080
    ds_read_b64_tr_b16 v[34:35], v4 offset:47360
    ds_read_b128 v[16:19], v8 offset:34816
    s_waitcnt lgkmcnt(7)
    v_mfma_f32_32x32x16_bf16 v[80:95], v[36:39], v[20:23], v[80:95]
    ds_read_b128 v[20:23], v8 offset:43008
    s_waitcnt lgkmcnt(5)
    v_mfma_f32_32x32x16_bf16 v[64:79], v[40:43], v[24:27], v[64:79]
    ds_read_b64_tr_b16 v[36:37], v4 offset:48640
    ds_read_b64_tr_b16 v[38:39], v4 offset:49920
    ds_read_b128 v[24:27], v8 offset:35840
    s_waitcnt lgkmcnt(7)
    v_mfma_f32_32x32x16_bf16 v[80:95], v[40:43], v[28:31], v[80:95]
    ds_read_b128 v[28:31], v8 offset:44032
    s_waitcnt lgkmcnt(5)
    v_mfma_f32_32x32x16_bf16 v[64:79], v[32:35], v[16:19], v[64:79]
    ds_read_b64_tr_b16 v[40:41], v4 offset:51200
    ds_read_b64_tr_b16 v[42:43], v4 offset:52480
    ds_read_b128 v[16:19], v8 offset:36864
    s_waitcnt lgkmcnt(7)
    v_mfma_f32_32x32x16_bf16 v[80:95], v[32:35], v[20:23], v[80:95]
    ds_read_b128 v[20:23], v8 offset:45056
    s_waitcnt lgkmcnt(5)
    v_mfma_f32_32x32x16_bf16 v[64:79], v[36:39], v[24:27], v[64:79]
    ds_read_b64_tr_b16 v[32:33], v4 offset:53760
    ds_read_b64_tr_b16 v[34:35], v4 offset:55040
    ds_read_b128 v[24:27], v8 offset:37888
    s_waitcnt lgkmcnt(7)
    v_mfma_f32_32x32x16_bf16 v[80:95], v[36:39], v[28:31], v[80:95]
    ds_read_b128 v[28:31], v8 offset:46080
    s_waitcnt lgkmcnt(5)
    v_mfma_f32_32x32x16_bf16 v[64:79], v[40:43], v[16:19], v[64:79]
    ds_read_b64_tr_b16 v[36:37], v4 offset:56320
    ds_read_b64_tr_b16 v[38:39], v4 offset:57600
    ds_read_b128 v[16:19], v8 offset:38912
    s_waitcnt lgkmcnt(7)
    v_mfma_f32_32x32x16_bf16 v[80:95], v[40:43], v[20:23], v[80:95]
    ds_read_b128 v[20:23], v8 offset:47104
    s_waitcnt lgkmcnt(5)
    v_mfma_f32_32x32x16_bf16 v[64:79], v[32:35], v[24:27], v[64:79]
    ds_read_b64_tr_b16 v[40:41], v4 offset:58880
    ds_read_b64_tr_b16 v[42:43], v4 offset:60160
    ds_read_b128 v[24:27], v8 offset:39936
    s_waitcnt lgkmcnt(7)
    v_mfma_f32_32x32x16_bf16 v[80:95], v[32:35], v[28:31], v[80:95]
    ds_read_b128 v[28:31], v8 offset:48128
    s_waitcnt lgkmcnt(5)
    v_mfma_f32_32x32x16_bf16 v[64:79], v[36:39], v[16:19], v[64:79]
    s_waitcnt lgkmcnt(4)
    v_mfma_f32_32x32x16_bf16 v[80:95], v[36:39], v[20:23], v[80:95]
    s_waitcnt lgkmcnt(0)
    s_barrier
    ds_read_b64_tr_b16 v[32:33], v4 offset:61440
    ds_read_b64_tr_b16 v[34:35], v4 offset:62720
    ds_read_b128 v[16:19], v8 offset:0
    ds_read_b128 v[20:23], v8 offset:8192
    v_mfma_f32_32x32x16_bf16 v[64:79], v[40:43], v[24:27], v[64:79]
    ds_read_b64_tr_b16 v[36:37], v4 offset:64000
    ds_read_b64_tr_b16 v[38:39], v4 offset:65280
    ds_read_b128 v[24:27], v8 offset:1024
    v_mfma_f32_32x32x16_bf16 v[80:95], v[40:43], v[28:31], v[80:95]
    ds_read_b128 v[28:31], v8 offset:9216
    s_waitcnt lgkmcnt(5)
    v_mfma_f32_32x32x16_bf16 v[64:79], v[32:35], v[16:19], v[64:79]
    ds_read_b64_tr_b16 v[40:41], v5 offset:1024
    ds_read_b64_tr_b16 v[42:43], v5 offset:2304
    ds_read_b128 v[16:19], v8 offset:2048
    s_waitcnt lgkmcnt(7)
    v_mfma_f32_32x32x16_bf16 v[80:95], v[32:35], v[20:23], v[80:95]
    ds_read_b128 v[20:23], v8 offset:10240
    s_waitcnt lgkmcnt(5)
    v_mfma_f32_32x32x16_bf16 v[64:79], v[36:39], v[24:27], v[64:79]
    ds_read_b64_tr_b16 v[32:33], v5 offset:3584
    ds_read_b64_tr_b16 v[34:35], v5 offset:4864
    ds_read_b128 v[24:27], v8 offset:3072
    s_waitcnt lgkmcnt(7)
    v_mfma_f32_32x32x16_bf16 v[80:95], v[36:39], v[28:31], v[80:95]
    ds_read_b128 v[28:31], v8 offset:11264
    s_waitcnt lgkmcnt(5)
    v_mfma_f32_32x32x16_bf16 v[64:79], v[40:43], v[16:19], v[64:79]
    ds_read_b64_tr_b16 v[36:37], v5 offset:6144
    ds_read_b64_tr_b16 v[38:39], v5 offset:7424
    ds_read_b128 v[16:19], v8 offset:4096
    s_waitcnt lgkmcnt(7)
    v_mfma_f32_32x32x16_bf16 v[80:95], v[40:43], v[20:23], v[80:95]
    ds_read_b128 v[20:23], v8 offset:12288
    s_waitcnt lgkmcnt(5)
    v_mfma_f32_32x32x16_bf16 v[64:79], v[32:35], v[24:27], v[64:79]
    ds_read_b64_tr_b16 v[40:41], v5 offset:8704
    ds_read_b64_tr_b16 v[42:43], v5 offset:9984
    ds_read_b128 v[24:27], v8 offset:5120
    s_waitcnt lgkmcnt(7)
    v_mfma_f32_32x32x16_bf16 v[80:95], v[32:35], v[28:31], v[80:95]
    ds_read_b128 v[28:31], v8 offset:13312
    s_waitcnt lgkmcnt(5)
    v_mfma_f32_32x32x16_bf16 v[64:79], v[36:39], v[16:19], v[64:79]
    ds_read_b64_tr_b16 v[32:33], v5 offset:11264
    ds_read_b64_tr_b16 v[34:35], v5 offset:12544
    ds_read_b128 v[16:19], v8 offset:6144
    s_waitcnt lgkmcnt(7)
    v_mfma_f32_32x32x16_bf16 v[80:95], v[36:39], v[20:23], v[80:95]
    ds_read_b128 v[20:23], v8 offset:14336
    s_waitcnt lgkmcnt(5)
    v_mfma_f32_32x32x16_bf16 v[64:79], v[40:43], v[24:27], v[64:79]
    ds_read_b64_tr_b16 v[36:37], v5 offset:13824
    ds_read_b64_tr_b16 v[38:39], v5 offset:15104
    ds_read_b128 v[24:27], v8 offset:7168
    s_waitcnt lgkmcnt(7)
    v_mfma_f32_32x32x16_bf16 v[80:95], v[40:43], v[28:31], v[80:95]
    ds_read_b128 v[28:31], v8 offset:15360
    s_waitcnt lgkmcnt(5)
    v_mfma_f32_32x32x16_bf16 v[64:79], v[32:35], v[16:19], v[64:79]
    s_waitcnt lgkmcnt(4)
    v_mfma_f32_32x32x16_bf16 v[80:95], v[32:35], v[20:23], v[80:95]
    s_waitcnt lgkmcnt(0)
    s_barrier
    ds_read_b64_tr_b16 v[40:41], v4 offset:0
    ds_read_b64_tr_b16 v[42:43], v4 offset:1280
    ds_read_b128 v[16:19], v8 offset:16384
    ds_read_b128 v[20:23], v8 offset:24576
    v_mfma_f32_32x32x16_bf16 v[64:79], v[36:39], v[24:27], v[64:79]
    ds_read_b64_tr_b16 v[32:33], v4 offset:2560
    ds_read_b64_tr_b16 v[34:35], v4 offset:3840
    ds_read_b128 v[24:27], v8 offset:17408
    v_mfma_f32_32x32x16_bf16 v[80:95], v[36:39], v[28:31], v[80:95]
    ds_read_b128 v[28:31], v8 offset:25600
    s_waitcnt lgkmcnt(5)
    v_mfma_f32_32x32x16_bf16 v[64:79], v[40:43], v[16:19], v[64:79]
    ds_read_b64_tr_b16 v[36:37], v4 offset:5120
    ds_read_b64_tr_b16 v[38:39], v4 offset:6400
    ds_read_b128 v[16:19], v8 offset:18432
    s_waitcnt lgkmcnt(7)
    v_mfma_f32_32x32x16_bf16 v[80:95], v[40:43], v[20:23], v[80:95]
    ds_read_b128 v[20:23], v8 offset:26624
    s_waitcnt lgkmcnt(5)
    v_mfma_f32_32x32x16_bf16 v[64:79], v[32:35], v[24:27], v[64:79]
    ds_read_b64_tr_b16 v[40:41], v4 offset:7680
    ds_read_b64_tr_b16 v[42:43], v4 offset:8960
    ds_read_b128 v[24:27], v8 offset:19456
    s_waitcnt lgkmcnt(7)
    v_mfma_f32_32x32x16_bf16 v[80:95], v[32:35], v[28:31], v[80:95]
    ds_read_b128 v[28:31], v8 offset:27648
    s_waitcnt lgkmcnt(5)
    v_mfma_f32_32x32x16_bf16 v[64:79], v[36:39], v[16:19], v[64:79]
    ds_read_b64_tr_b16 v[32:33], v4 offset:10240
    ds_read_b64_tr_b16 v[34:35], v4 offset:11520
    ds_read_b128 v[16:19], v8 offset:20480
    s_waitcnt lgkmcnt(7)
    v_mfma_f32_32x32x16_bf16 v[80:95], v[36:39], v[20:23], v[80:95]
    ds_read_b128 v[20:23], v8 offset:28672
    s_waitcnt lgkmcnt(5)
    v_mfma_f32_32x32x16_bf16 v[64:79], v[40:43], v[24:27], v[64:79]
    ds_read_b64_tr_b16 v[36:37], v4 offset:12800
    ds_read_b64_tr_b16 v[38:39], v4 offset:14080
    ds_read_b128 v[24:27], v8 offset:21504
    s_waitcnt lgkmcnt(7)
    v_mfma_f32_32x32x16_bf16 v[80:95], v[40:43], v[28:31], v[80:95]
    ds_read_b128 v[28:31], v8 offset:29696
    s_waitcnt lgkmcnt(5)
    v_mfma_f32_32x32x16_bf16 v[64:79], v[32:35], v[16:19], v[64:79]
    ds_read_b64_tr_b16 v[40:41], v4 offset:15360
    ds_read_b64_tr_b16 v[42:43], v4 offset:16640
    ds_read_b128 v[16:19], v8 offset:22528
    s_waitcnt lgkmcnt(7)
    v_mfma_f32_32x32x16_bf16 v[80:95], v[32:35], v[20:23], v[80:95]
    ds_read_b128 v[20:23], v8 offset:30720
    s_waitcnt lgkmcnt(5)
    v_mfma_f32_32x32x16_bf16 v[64:79], v[36:39], v[24:27], v[64:79]
    ds_read_b64_tr_b16 v[32:33], v4 offset:17920
    ds_read_b64_tr_b16 v[34:35], v4 offset:19200
    ds_read_b128 v[24:27], v8 offset:23552
    s_waitcnt lgkmcnt(7)
    v_mfma_f32_32x32x16_bf16 v[80:95], v[36:39], v[28:31], v[80:95]
    ds_read_b128 v[28:31], v8 offset:31744
    s_waitcnt lgkmcnt(5)
    v_mfma_f32_32x32x16_bf16 v[64:79], v[40:43], v[16:19], v[64:79]
    s_waitcnt lgkmcnt(4)
    v_mfma_f32_32x32x16_bf16 v[80:95], v[40:43], v[20:23], v[80:95]
    s_waitcnt lgkmcnt(0)
    s_barrier
    ds_read_b64_tr_b16 v[36:37], v4 offset:20480
    ds_read_b64_tr_b16 v[38:39], v4 offset:21760
    ds_read_b128 v[16:19], v8 offset:32768
    ds_read_b128 v[20:23], v8 offset:40960
    v_mfma_f32_32x32x16_bf16 v[64:79], v[32:35], v[24:27], v[64:79]
    ds_read_b64_tr_b16 v[40:41], v4 offset:23040
    ds_read_b64_tr_b16 v[42:43], v4 offset:24320
    ds_read_b128 v[24:27], v8 offset:33792
    v_mfma_f32_32x32x16_bf16 v[80:95], v[32:35], v[28:31], v[80:95]
    ds_read_b128 v[28:31], v8 offset:41984
    s_waitcnt lgkmcnt(5)
    v_mfma_f32_32x32x16_bf16 v[64:79], v[36:39], v[16:19], v[64:79]
    ds_read_b64_tr_b16 v[32:33], v4 offset:25600
    ds_read_b64_tr_b16 v[34:35], v4 offset:26880
    ds_read_b128 v[16:19], v8 offset:34816
    s_waitcnt lgkmcnt(7)
    v_mfma_f32_32x32x16_bf16 v[80:95], v[36:39], v[20:23], v[80:95]
    ds_read_b128 v[20:23], v8 offset:43008
    s_waitcnt lgkmcnt(5)
    v_mfma_f32_32x32x16_bf16 v[64:79], v[40:43], v[24:27], v[64:79]
    ds_read_b64_tr_b16 v[36:37], v4 offset:28160
    ds_read_b64_tr_b16 v[38:39], v4 offset:29440
    ds_read_b128 v[24:27], v8 offset:35840
    s_waitcnt lgkmcnt(7)
    v_mfma_f32_32x32x16_bf16 v[80:95], v[40:43], v[28:31], v[80:95]
    ds_read_b128 v[28:31], v8 offset:44032
    s_waitcnt lgkmcnt(5)
    v_mfma_f32_32x32x16_bf16 v[64:79], v[32:35], v[16:19], v[64:79]
    ds_read_b64_tr_b16 v[40:41], v4 offset:30720
    ds_read_b64_tr_b16 v[42:43], v4 offset:32000
    ds_read_b128 v[16:19], v8 offset:36864
    s_waitcnt lgkmcnt(7)
    v_mfma_f32_32x32x16_bf16 v[80:95], v[32:35], v[20:23], v[80:95]
    ds_read_b128 v[20:23], v8 offset:45056
    s_waitcnt lgkmcnt(5)
    v_mfma_f32_32x32x16_bf16 v[64:79], v[36:39], v[24:27], v[64:79]
    ds_read_b64_tr_b16 v[32:33], v4 offset:33280
    ds_read_b64_tr_b16 v[34:35], v4 offset:34560
    ds_read_b128 v[24:27], v8 offset:37888
    s_waitcnt lgkmcnt(7)
    v_mfma_f32_32x32x16_bf16 v[80:95], v[36:39], v[28:31], v[80:95]
    ds_read_b128 v[28:31], v8 offset:46080
    s_waitcnt lgkmcnt(5)
    v_mfma_f32_32x32x16_bf16 v[64:79], v[40:43], v[16:19], v[64:79]
    ds_read_b64_tr_b16 v[36:37], v4 offset:35840
    ds_read_b64_tr_b16 v[38:39], v4 offset:37120
    ds_read_b128 v[16:19], v8 offset:38912
    s_waitcnt lgkmcnt(7)
    v_mfma_f32_32x32x16_bf16 v[80:95], v[40:43], v[20:23], v[80:95]
    ds_read_b128 v[20:23], v8 offset:47104
    s_waitcnt lgkmcnt(5)
    v_mfma_f32_32x32x16_bf16 v[64:79], v[32:35], v[24:27], v[64:79]
    ds_read_b64_tr_b16 v[40:41], v4 offset:38400
    ds_read_b64_tr_b16 v[42:43], v4 offset:39680
    ds_read_b128 v[24:27], v8 offset:39936
    s_waitcnt lgkmcnt(7)
    v_mfma_f32_32x32x16_bf16 v[80:95], v[32:35], v[28:31], v[80:95]
    ds_read_b128 v[28:31], v8 offset:48128
    s_waitcnt lgkmcnt(5)
    v_mfma_f32_32x32x16_bf16 v[64:79], v[36:39], v[16:19], v[64:79]
    s_waitcnt lgkmcnt(4)
    v_mfma_f32_32x32x16_bf16 v[80:95], v[36:39], v[20:23], v[80:95]
    s_waitcnt lgkmcnt(0)
    s_barrier
    ds_read_b64_tr_b16 v[32:33], v4 offset:40960
    ds_read_b64_tr_b16 v[34:35], v4 offset:42240
    ds_read_b128 v[16:19], v8 offset:0
    ds_read_b128 v[20:23], v8 offset:8192
    v_mfma_f32_32x32x16_bf16 v[64:79], v[40:43], v[24:27], v[64:79]
    ds_read_b64_tr_b16 v[36:37], v4 offset:43520
    ds_read_b64_tr_b16 v[38:39], v4 offset:44800
    ds_read_b128 v[24:27], v8 offset:1024
    v_mfma_f32_32x32x16_bf16 v[80:95], v[40:43], v[28:31], v[80:95]
    ds_read_b128 v[28:31], v8 offset:9216
    s_waitcnt lgkmcnt(5)
    v_mfma_f32_32x32x16_bf16 v[64:79], v[32:35], v[16:19], v[64:79]
    ds_read_b64_tr_b16 v[40:41], v4 offset:46080
    ds_read_b64_tr_b16 v[42:43], v4 offset:47360
    ds_read_b128 v[16:19], v8 offset:2048
    s_waitcnt lgkmcnt(7)
    v_mfma_f32_32x32x16_bf16 v[80:95], v[32:35], v[20:23], v[80:95]
    ds_read_b128 v[20:23], v8 offset:10240
    s_waitcnt lgkmcnt(5)
    v_mfma_f32_32x32x16_bf16 v[64:79], v[36:39], v[24:27], v[64:79]
    ds_read_b64_tr_b16 v[32:33], v4 offset:48640
    ds_read_b64_tr_b16 v[34:35], v4 offset:49920
    ds_read_b128 v[24:27], v8 offset:3072
    s_waitcnt lgkmcnt(7)
    v_mfma_f32_32x32x16_bf16 v[80:95], v[36:39], v[28:31], v[80:95]
    ds_read_b128 v[28:31], v8 offset:11264
    s_waitcnt lgkmcnt(5)
    v_mfma_f32_32x32x16_bf16 v[64:79], v[40:43], v[16:19], v[64:79]
    ds_read_b64_tr_b16 v[36:37], v4 offset:51200
    ds_read_b64_tr_b16 v[38:39], v4 offset:52480
    ds_read_b128 v[16:19], v8 offset:4096
    s_waitcnt lgkmcnt(7)
    v_mfma_f32_32x32x16_bf16 v[80:95], v[40:43], v[20:23], v[80:95]
    ds_read_b128 v[20:23], v8 offset:12288
    s_waitcnt lgkmcnt(5)
    v_mfma_f32_32x32x16_bf16 v[64:79], v[32:35], v[24:27], v[64:79]
    ds_read_b64_tr_b16 v[40:41], v4 offset:53760
    ds_read_b64_tr_b16 v[42:43], v4 offset:55040
    ds_read_b128 v[24:27], v8 offset:5120
    s_waitcnt lgkmcnt(7)
    v_mfma_f32_32x32x16_bf16 v[80:95], v[32:35], v[28:31], v[80:95]
    ds_read_b128 v[28:31], v8 offset:13312
    s_waitcnt lgkmcnt(5)
    v_mfma_f32_32x32x16_bf16 v[64:79], v[36:39], v[16:19], v[64:79]
    ds_read_b64_tr_b16 v[32:33], v4 offset:56320
    ds_read_b64_tr_b16 v[34:35], v4 offset:57600
    ds_read_b128 v[16:19], v8 offset:6144
    s_waitcnt lgkmcnt(7)
    v_mfma_f32_32x32x16_bf16 v[80:95], v[36:39], v[20:23], v[80:95]
    ds_read_b128 v[20:23], v8 offset:14336
    s_waitcnt lgkmcnt(5)
    v_mfma_f32_32x32x16_bf16 v[64:79], v[40:43], v[24:27], v[64:79]
    ds_read_b64_tr_b16 v[36:37], v4 offset:58880
    ds_read_b64_tr_b16 v[38:39], v4 offset:60160
    ds_read_b128 v[24:27], v8 offset:7168
    s_waitcnt lgkmcnt(7)
    v_mfma_f32_32x32x16_bf16 v[80:95], v[40:43], v[28:31], v[80:95]
    ds_read_b128 v[28:31], v8 offset:15360
    s_waitcnt lgkmcnt(5)
    v_mfma_f32_32x32x16_bf16 v[64:79], v[32:35], v[16:19], v[64:79]
    s_waitcnt lgkmcnt(4)
    v_mfma_f32_32x32x16_bf16 v[80:95], v[32:35], v[20:23], v[80:95]
    s_waitcnt lgkmcnt(0)
    s_barrier
    ds_read_b64_tr_b16 v[40:41], v4 offset:61440
    ds_read_b64_tr_b16 v[42:43], v4 offset:62720
    ds_read_b128 v[16:19], v8 offset:16384
    ds_read_b128 v[20:23], v8 offset:24576
    v_mfma_f32_32x32x16_bf16 v[64:79], v[36:39], v[24:27], v[64:79]
    ds_read_b64_tr_b16 v[32:33], v4 offset:64000
    ds_read_b64_tr_b16 v[34:35], v4 offset:65280
    ds_read_b128 v[24:27], v8 offset:17408
    v_mfma_f32_32x32x16_bf16 v[80:95], v[36:39], v[28:31], v[80:95]
    ds_read_b128 v[28:31], v8 offset:25600
    s_waitcnt lgkmcnt(5)
    v_mfma_f32_32x32x16_bf16 v[64:79], v[40:43], v[16:19], v[64:79]
    ds_read_b64_tr_b16 v[36:37], v5 offset:1024
    ds_read_b64_tr_b16 v[38:39], v5 offset:2304
    ds_read_b128 v[16:19], v8 offset:18432
    s_waitcnt lgkmcnt(7)
    v_mfma_f32_32x32x16_bf16 v[80:95], v[40:43], v[20:23], v[80:95]
    ds_read_b128 v[20:23], v8 offset:26624
    s_waitcnt lgkmcnt(5)
    v_mfma_f32_32x32x16_bf16 v[64:79], v[32:35], v[24:27], v[64:79]
    ds_read_b64_tr_b16 v[40:41], v5 offset:3584
    ds_read_b64_tr_b16 v[42:43], v5 offset:4864
    ds_read_b128 v[24:27], v8 offset:19456
    s_waitcnt lgkmcnt(7)
    v_mfma_f32_32x32x16_bf16 v[80:95], v[32:35], v[28:31], v[80:95]
    ds_read_b128 v[28:31], v8 offset:27648
    s_waitcnt lgkmcnt(5)
    v_mfma_f32_32x32x16_bf16 v[64:79], v[36:39], v[16:19], v[64:79]
    ds_read_b64_tr_b16 v[32:33], v5 offset:6144
    ds_read_b64_tr_b16 v[34:35], v5 offset:7424
    ds_read_b128 v[16:19], v8 offset:20480
    s_waitcnt lgkmcnt(7)
    v_mfma_f32_32x32x16_bf16 v[80:95], v[36:39], v[20:23], v[80:95]
    ds_read_b128 v[20:23], v8 offset:28672
    s_waitcnt lgkmcnt(5)
    v_mfma_f32_32x32x16_bf16 v[64:79], v[40:43], v[24:27], v[64:79]
    ds_read_b64_tr_b16 v[36:37], v5 offset:8704
    ds_read_b64_tr_b16 v[38:39], v5 offset:9984
    ds_read_b128 v[24:27], v8 offset:21504
    s_waitcnt lgkmcnt(7)
    v_mfma_f32_32x32x16_bf16 v[80:95], v[40:43], v[28:31], v[80:95]
    ds_read_b128 v[28:31], v8 offset:29696
    s_waitcnt lgkmcnt(5)
    v_mfma_f32_32x32x16_bf16 v[64:79], v[32:35], v[16:19], v[64:79]
    ds_read_b64_tr_b16 v[40:41], v5 offset:11264
    ds_read_b64_tr_b16 v[42:43], v5 offset:12544
    ds_read_b128 v[16:19], v8 offset:22528
    s_waitcnt lgkmcnt(7)
    v_mfma_f32_32x32x16_bf16 v[80:95], v[32:35], v[20:23], v[80:95]
    ds_read_b128 v[20:23], v8 offset:30720
    s_waitcnt lgkmcnt(5)
    v_mfma_f32_32x32x16_bf16 v[64:79], v[36:39], v[24:27], v[64:79]
    ds_read_b64_tr_b16 v[32:33], v5 offset:13824
    ds_read_b64_tr_b16 v[34:35], v5 offset:15104
    ds_read_b128 v[24:27], v8 offset:23552
    s_waitcnt lgkmcnt(7)
    v_mfma_f32_32x32x16_bf16 v[80:95], v[36:39], v[28:31], v[80:95]
    ds_read_b128 v[28:31], v8 offset:31744
    s_waitcnt lgkmcnt(5)
    v_mfma_f32_32x32x16_bf16 v[64:79], v[40:43], v[16:19], v[64:79]
    s_waitcnt lgkmcnt(4)
    v_mfma_f32_32x32x16_bf16 v[80:95], v[40:43], v[20:23], v[80:95]
    s_waitcnt lgkmcnt(0)
    s_barrier
    ds_read_b64_tr_b16 v[36:37], v4 offset:0
    ds_read_b64_tr_b16 v[38:39], v4 offset:1280
    ds_read_b128 v[16:19], v8 offset:32768
    ds_read_b128 v[20:23], v8 offset:40960
    v_mfma_f32_32x32x16_bf16 v[64:79], v[32:35], v[24:27], v[64:79]
    ds_read_b64_tr_b16 v[40:41], v4 offset:2560
    ds_read_b64_tr_b16 v[42:43], v4 offset:3840
    ds_read_b128 v[24:27], v8 offset:33792
    v_mfma_f32_32x32x16_bf16 v[80:95], v[32:35], v[28:31], v[80:95]
    ds_read_b128 v[28:31], v8 offset:41984
    s_waitcnt lgkmcnt(5)
    v_mfma_f32_32x32x16_bf16 v[64:79], v[36:39], v[16:19], v[64:79]
    ds_read_b64_tr_b16 v[32:33], v4 offset:5120
    ds_read_b64_tr_b16 v[34:35], v4 offset:6400
    ds_read_b128 v[16:19], v8 offset:34816
    s_waitcnt lgkmcnt(7)
    v_mfma_f32_32x32x16_bf16 v[80:95], v[36:39], v[20:23], v[80:95]
    ds_read_b128 v[20:23], v8 offset:43008
    s_waitcnt lgkmcnt(5)
    v_mfma_f32_32x32x16_bf16 v[64:79], v[40:43], v[24:27], v[64:79]
    ds_read_b64_tr_b16 v[36:37], v4 offset:7680
    ds_read_b64_tr_b16 v[38:39], v4 offset:8960
    ds_read_b128 v[24:27], v8 offset:35840
    s_waitcnt lgkmcnt(7)
    v_mfma_f32_32x32x16_bf16 v[80:95], v[40:43], v[28:31], v[80:95]
    ds_read_b128 v[28:31], v8 offset:44032
    s_waitcnt lgkmcnt(5)
    v_mfma_f32_32x32x16_bf16 v[64:79], v[32:35], v[16:19], v[64:79]
    ds_read_b64_tr_b16 v[40:41], v4 offset:10240
    ds_read_b64_tr_b16 v[42:43], v4 offset:11520
    ds_read_b128 v[16:19], v8 offset:36864
    s_waitcnt lgkmcnt(7)
    v_mfma_f32_32x32x16_bf16 v[80:95], v[32:35], v[20:23], v[80:95]
    ds_read_b128 v[20:23], v8 offset:45056
    s_waitcnt lgkmcnt(5)
    v_mfma_f32_32x32x16_bf16 v[64:79], v[36:39], v[24:27], v[64:79]
    ds_read_b64_tr_b16 v[32:33], v4 offset:12800
    ds_read_b64_tr_b16 v[34:35], v4 offset:14080
    ds_read_b128 v[24:27], v8 offset:37888
    s_waitcnt lgkmcnt(7)
    v_mfma_f32_32x32x16_bf16 v[80:95], v[36:39], v[28:31], v[80:95]
    ds_read_b128 v[28:31], v8 offset:46080
    s_waitcnt lgkmcnt(5)
    v_mfma_f32_32x32x16_bf16 v[64:79], v[40:43], v[16:19], v[64:79]
    ds_read_b64_tr_b16 v[36:37], v4 offset:15360
    ds_read_b64_tr_b16 v[38:39], v4 offset:16640
    ds_read_b128 v[16:19], v8 offset:38912
    s_waitcnt lgkmcnt(7)
    v_mfma_f32_32x32x16_bf16 v[80:95], v[40:43], v[20:23], v[80:95]
    ds_read_b128 v[20:23], v8 offset:47104
    s_waitcnt lgkmcnt(5)
    v_mfma_f32_32x32x16_bf16 v[64:79], v[32:35], v[24:27], v[64:79]
    ds_read_b64_tr_b16 v[40:41], v4 offset:17920
    ds_read_b64_tr_b16 v[42:43], v4 offset:19200
    ds_read_b128 v[24:27], v8 offset:39936
    s_waitcnt lgkmcnt(7)
    v_mfma_f32_32x32x16_bf16 v[80:95], v[32:35], v[28:31], v[80:95]
    ds_read_b128 v[28:31], v8 offset:48128
    s_waitcnt lgkmcnt(5)
    v_mfma_f32_32x32x16_bf16 v[64:79], v[36:39], v[16:19], v[64:79]
    s_waitcnt lgkmcnt(4)
    v_mfma_f32_32x32x16_bf16 v[80:95], v[36:39], v[20:23], v[80:95]
    s_waitcnt lgkmcnt(0)
    s_barrier
    ds_read_b64_tr_b16 v[32:33], v4 offset:20480
    ds_read_b64_tr_b16 v[34:35], v4 offset:21760
    ds_read_b128 v[16:19], v8 offset:0
    ds_read_b128 v[20:23], v8 offset:8192
    v_mfma_f32_32x32x16_bf16 v[64:79], v[40:43], v[24:27], v[64:79]
    ds_read_b64_tr_b16 v[36:37], v4 offset:23040
    ds_read_b64_tr_b16 v[38:39], v4 offset:24320
    ds_read_b128 v[24:27], v8 offset:1024
    v_mfma_f32_32x32x16_bf16 v[80:95], v[40:43], v[28:31], v[80:95]
    ds_read_b128 v[28:31], v8 offset:9216
    s_waitcnt lgkmcnt(5)
    v_mfma_f32_32x32x16_bf16 v[64:79], v[32:35], v[16:19], v[64:79]
    ds_read_b64_tr_b16 v[40:41], v4 offset:25600
    ds_read_b64_tr_b16 v[42:43], v4 offset:26880
    ds_read_b128 v[16:19], v8 offset:2048
    s_waitcnt lgkmcnt(7)
    v_mfma_f32_32x32x16_bf16 v[80:95], v[32:35], v[20:23], v[80:95]
    ds_read_b128 v[20:23], v8 offset:10240
    s_waitcnt lgkmcnt(5)
    v_mfma_f32_32x32x16_bf16 v[64:79], v[36:39], v[24:27], v[64:79]
    ds_read_b64_tr_b16 v[32:33], v4 offset:28160
    ds_read_b64_tr_b16 v[34:35], v4 offset:29440
    ds_read_b128 v[24:27], v8 offset:3072
    s_waitcnt lgkmcnt(7)
    v_mfma_f32_32x32x16_bf16 v[80:95], v[36:39], v[28:31], v[80:95]
    ds_read_b128 v[28:31], v8 offset:11264
    s_waitcnt lgkmcnt(5)
    v_mfma_f32_32x32x16_bf16 v[64:79], v[40:43], v[16:19], v[64:79]
    ds_read_b64_tr_b16 v[36:37], v4 offset:30720
    ds_read_b64_tr_b16 v[38:39], v4 offset:32000
    ds_read_b128 v[16:19], v8 offset:4096
    s_waitcnt lgkmcnt(7)
    v_mfma_f32_32x32x16_bf16 v[80:95], v[40:43], v[20:23], v[80:95]
    ds_read_b128 v[20:23], v8 offset:12288
    s_waitcnt lgkmcnt(5)
    v_mfma_f32_32x32x16_bf16 v[64:79], v[32:35], v[24:27], v[64:79]
    ds_read_b64_tr_b16 v[40:41], v4 offset:33280
    ds_read_b64_tr_b16 v[42:43], v4 offset:34560
    ds_read_b128 v[24:27], v8 offset:5120
    s_waitcnt lgkmcnt(7)
    v_mfma_f32_32x32x16_bf16 v[80:95], v[32:35], v[28:31], v[80:95]
    ds_read_b128 v[28:31], v8 offset:13312
    s_waitcnt lgkmcnt(5)
    v_mfma_f32_32x32x16_bf16 v[64:79], v[36:39], v[16:19], v[64:79]
    ds_read_b64_tr_b16 v[32:33], v4 offset:35840
    ds_read_b64_tr_b16 v[34:35], v4 offset:37120
    ds_read_b128 v[16:19], v8 offset:6144
    s_waitcnt lgkmcnt(7)
    v_mfma_f32_32x32x16_bf16 v[80:95], v[36:39], v[20:23], v[80:95]
    ds_read_b128 v[20:23], v8 offset:14336
    s_waitcnt lgkmcnt(5)
    v_mfma_f32_32x32x16_bf16 v[64:79], v[40:43], v[24:27], v[64:79]
    ds_read_b64_tr_b16 v[36:37], v4 offset:38400
    ds_read_b64_tr_b16 v[38:39], v4 offset:39680
    ds_read_b128 v[24:27], v8 offset:7168
    s_waitcnt lgkmcnt(7)
    v_mfma_f32_32x32x16_bf16 v[80:95], v[40:43], v[28:31], v[80:95]
    ds_read_b128 v[28:31], v8 offset:15360
    s_waitcnt lgkmcnt(5)
    v_mfma_f32_32x32x16_bf16 v[64:79], v[32:35], v[16:19], v[64:79]
    s_waitcnt lgkmcnt(4)
    v_mfma_f32_32x32x16_bf16 v[80:95], v[32:35], v[20:23], v[80:95]
    s_waitcnt lgkmcnt(0)
    s_barrier
    ds_read_b64_tr_b16 v[40:41], v4 offset:40960
    ds_read_b64_tr_b16 v[42:43], v4 offset:42240
    ds_read_b128 v[16:19], v8 offset:16384
    ds_read_b128 v[20:23], v8 offset:24576
    v_mfma_f32_32x32x16_bf16 v[64:79], v[36:39], v[24:27], v[64:79]
    ds_read_b64_tr_b16 v[32:33], v4 offset:43520
    ds_read_b64_tr_b16 v[34:35], v4 offset:44800
    ds_read_b128 v[24:27], v8 offset:17408
    v_mfma_f32_32x32x16_bf16 v[80:95], v[36:39], v[28:31], v[80:95]
    ds_read_b128 v[28:31], v8 offset:25600
    s_waitcnt lgkmcnt(5)
    v_mfma_f32_32x32x16_bf16 v[64:79], v[40:43], v[16:19], v[64:79]
    ds_read_b64_tr_b16 v[36:37], v4 offset:46080
    ds_read_b64_tr_b16 v[38:39], v4 offset:47360
    ds_read_b128 v[16:19], v8 offset:18432
    s_waitcnt lgkmcnt(7)
    v_mfma_f32_32x32x16_bf16 v[80:95], v[40:43], v[20:23], v[80:95]
    ds_read_b128 v[20:23], v8 offset:26624
    s_waitcnt lgkmcnt(5)
    v_mfma_f32_32x32x16_bf16 v[64:79], v[32:35], v[24:27], v[64:79]
    ds_read_b64_tr_b16 v[40:41], v4 offset:48640
    ds_read_b64_tr_b16 v[42:43], v4 offset:49920
    ds_read_b128 v[24:27], v8 offset:19456
    s_waitcnt lgkmcnt(7)
    v_mfma_f32_32x32x16_bf16 v[80:95], v[32:35], v[28:31], v[80:95]
    ds_read_b128 v[28:31], v8 offset:27648
    s_waitcnt lgkmcnt(5)
    v_mfma_f32_32x32x16_bf16 v[64:79], v[36:39], v[16:19], v[64:79]
    ds_read_b64_tr_b16 v[32:33], v4 offset:51200
    ds_read_b64_tr_b16 v[34:35], v4 offset:52480
    ds_read_b128 v[16:19], v8 offset:20480
    s_waitcnt lgkmcnt(7)
    v_mfma_f32_32x32x16_bf16 v[80:95], v[36:39], v[20:23], v[80:95]
    ds_read_b128 v[20:23], v8 offset:28672
    s_waitcnt lgkmcnt(5)
    v_mfma_f32_32x32x16_bf16 v[64:79], v[40:43], v[24:27], v[64:79]
    ds_read_b64_tr_b16 v[36:37], v4 offset:53760
    ds_read_b64_tr_b16 v[38:39], v4 offset:55040
    ds_read_b128 v[24:27], v8 offset:21504
    s_waitcnt lgkmcnt(7)
    v_mfma_f32_32x32x16_bf16 v[80:95], v[40:43], v[28:31], v[80:95]
    ds_read_b128 v[28:31], v8 offset:29696
    s_waitcnt lgkmcnt(5)
    v_mfma_f32_32x32x16_bf16 v[64:79], v[32:35], v[16:19], v[64:79]
    ds_read_b64_tr_b16 v[40:41], v4 offset:56320
    ds_read_b64_tr_b16 v[42:43], v4 offset:57600
    ds_read_b128 v[16:19], v8 offset:22528
    s_waitcnt lgkmcnt(7)
    v_mfma_f32_32x32x16_bf16 v[80:95], v[32:35], v[20:23], v[80:95]
    ds_read_b128 v[20:23], v8 offset:30720
    s_waitcnt lgkmcnt(5)
    v_mfma_f32_32x32x16_bf16 v[64:79], v[36:39], v[24:27], v[64:79]
    ds_read_b64_tr_b16 v[32:33], v4 offset:58880
    ds_read_b64_tr_b16 v[34:35], v4 offset:60160
    ds_read_b128 v[24:27], v8 offset:23552
    s_waitcnt lgkmcnt(7)
    v_mfma_f32_32x32x16_bf16 v[80:95], v[36:39], v[28:31], v[80:95]
    ds_read_b128 v[28:31], v8 offset:31744
    s_waitcnt lgkmcnt(5)
    v_mfma_f32_32x32x16_bf16 v[64:79], v[40:43], v[16:19], v[64:79]
    s_waitcnt lgkmcnt(4)
    v_mfma_f32_32x32x16_bf16 v[80:95], v[40:43], v[20:23], v[80:95]
    s_waitcnt lgkmcnt(0)
    s_barrier
    ds_read_b64_tr_b16 v[36:37], v4 offset:61440
    ds_read_b64_tr_b16 v[38:39], v4 offset:62720
    ds_read_b128 v[16:19], v8 offset:32768
    ds_read_b128 v[20:23], v8 offset:40960
    v_mfma_f32_32x32x16_bf16 v[64:79], v[32:35], v[24:27], v[64:79]
    ds_read_b64_tr_b16 v[40:41], v4 offset:64000
    ds_read_b64_tr_b16 v[42:43], v4 offset:65280
    ds_read_b128 v[24:27], v8 offset:33792
    v_mfma_f32_32x32x16_bf16 v[80:95], v[32:35], v[28:31], v[80:95]
    ds_read_b128 v[28:31], v8 offset:41984
    s_waitcnt lgkmcnt(5)
    v_mfma_f32_32x32x16_bf16 v[64:79], v[36:39], v[16:19], v[64:79]
    ds_read_b64_tr_b16 v[32:33], v5 offset:1024
    ds_read_b64_tr_b16 v[34:35], v5 offset:2304
    ds_read_b128 v[16:19], v8 offset:34816
    s_waitcnt lgkmcnt(7)
    v_mfma_f32_32x32x16_bf16 v[80:95], v[36:39], v[20:23], v[80:95]
    ds_read_b128 v[20:23], v8 offset:43008
    s_waitcnt lgkmcnt(5)
    v_mfma_f32_32x32x16_bf16 v[64:79], v[40:43], v[24:27], v[64:79]
    ds_read_b64_tr_b16 v[36:37], v5 offset:3584
    ds_read_b64_tr_b16 v[38:39], v5 offset:4864
    ds_read_b128 v[24:27], v8 offset:35840
    s_waitcnt lgkmcnt(7)
    v_mfma_f32_32x32x16_bf16 v[80:95], v[40:43], v[28:31], v[80:95]
    ds_read_b128 v[28:31], v8 offset:44032
    s_waitcnt lgkmcnt(5)
    v_mfma_f32_32x32x16_bf16 v[64:79], v[32:35], v[16:19], v[64:79]
    ds_read_b64_tr_b16 v[40:41], v5 offset:6144
    ds_read_b64_tr_b16 v[42:43], v5 offset:7424
    ds_read_b128 v[16:19], v8 offset:36864
    s_waitcnt lgkmcnt(7)
    v_mfma_f32_32x32x16_bf16 v[80:95], v[32:35], v[20:23], v[80:95]
    ds_read_b128 v[20:23], v8 offset:45056
    s_waitcnt lgkmcnt(5)
    v_mfma_f32_32x32x16_bf16 v[64:79], v[36:39], v[24:27], v[64:79]
    ds_read_b64_tr_b16 v[32:33], v5 offset:8704
    ds_read_b64_tr_b16 v[34:35], v5 offset:9984
    ds_read_b128 v[24:27], v8 offset:37888
    s_waitcnt lgkmcnt(7)
    v_mfma_f32_32x32x16_bf16 v[80:95], v[36:39], v[28:31], v[80:95]
    ds_read_b128 v[28:31], v8 offset:46080
    s_waitcnt lgkmcnt(5)
    v_mfma_f32_32x32x16_bf16 v[64:79], v[40:43], v[16:19], v[64:79]
    ds_read_b64_tr_b16 v[36:37], v5 offset:11264
    ds_read_b64_tr_b16 v[38:39], v5 offset:12544
    ds_read_b128 v[16:19], v8 offset:38912
    s_waitcnt lgkmcnt(7)
    v_mfma_f32_32x32x16_bf16 v[80:95], v[40:43], v[20:23], v[80:95]
    ds_read_b128 v[20:23], v8 offset:47104
    s_waitcnt lgkmcnt(5)
    v_mfma_f32_32x32x16_bf16 v[64:79], v[32:35], v[24:27], v[64:79]
    ds_read_b64_tr_b16 v[40:41], v5 offset:13824
    ds_read_b64_tr_b16 v[42:43], v5 offset:15104
    ds_read_b128 v[24:27], v8 offset:39936
    s_waitcnt lgkmcnt(7)
    v_mfma_f32_32x32x16_bf16 v[80:95], v[32:35], v[28:31], v[80:95]
    ds_read_b128 v[28:31], v8 offset:48128
    s_waitcnt lgkmcnt(5)
    v_mfma_f32_32x32x16_bf16 v[64:79], v[36:39], v[16:19], v[64:79]
    s_waitcnt lgkmcnt(4)
    v_mfma_f32_32x32x16_bf16 v[80:95], v[36:39], v[20:23], v[80:95]
    s_waitcnt lgkmcnt(1)
    v_mfma_f32_32x32x16_bf16 v[64:79], v[40:43], v[24:27], v[64:79]
    s_waitcnt lgkmcnt(0)
    v_mfma_f32_32x32x16_bf16 v[80:95], v[40:43], v[28:31], v[80:95]
    s_lshl_b32 s71, s40, 7
    s_add_u32 s71, s71, 141312
    v_lshl_add_u32 v13, v3, 4, s71
    s_lshl_b32 s71, s40, 11
    s_add_u32 s71, s71, 131072
    v_add_u32 v14, s71, v1
    ds_read_b128 v[112:115], v13 offset:0
    ds_read_b128 v[116:119], v13 offset:32
    ds_read_b128 v[120:123], v13 offset:64
    ds_read_b128 v[124:127], v13 offset:96
    ds_read_b128 v[96:99], v14 offset:0
    ds_read_b128 v[100:103], v14 offset:1024
    ds_read_b128 v[104:107], v14 offset:5120
    ds_read_b128 v[108:111], v14 offset:6144
    v_mul_u32_u24 v15, 160, v2
    v_lshl_add_u32 v15, v3, 3, v15
    s_lshl_b32 s73, s40, 6
    s_add_u32 s73, s73, 142336
    v_add_u32 v15, s73, v15
    v_mul_u32_u24 v14, 1280, v2
    v_lshl_add_u32 v14, v3, 3, v14
    s_mul_i32 s72, s69, 160
    s_lshl_b32 s73, s40, 6
    s_add_u32 s72, s72, s73
    s_mul_i32 s73, s68, 81920
    s_add_u32 s72, s72, s73
    s_waitcnt lgkmcnt(0)
    s_nop 1
    s_add_u32 s74, s72, 0
    v_lshlrev_b32 v48, 16, v96
    v_and_b32 v49, 0xffff0000, v96
    v_fma_f32 v64, v112, v64, v48
    v_fma_f32 v65, v113, v65, v49
    v_lshlrev_b32 v48, 16, v97
    v_and_b32 v49, 0xffff0000, v97
    v_fma_f32 v66, v114, v66, v48
    v_fma_f32 v67, v115, v67, v49
    v_cvt_pk_bf16_f32 v16, v64, v65
    v_cvt_pk_bf16_f32 v17, v66, v67
    ds_write_b64 v15, v[16:17] offset:0
    v_lshlrev_b32 v48, 16, v98
    v_and_b32 v49, 0xffff0000, v98
    v_fma_f32 v68, v116, v68, v48
    v_fma_f32 v69, v117, v69, v49
    v_lshlrev_b32 v48, 16, v99
    v_and_b32 v49, 0xffff0000, v99
    v_fma_f32 v70, v118, v70, v48
    v_fma_f32 v71, v119, v71, v49
    v_cvt_pk_bf16_f32 v18, v68, v69
    v_cvt_pk_bf16_f32 v19, v70, v71
    ds_write_b64 v15, v[18:19] offset:16
    s_cmp_eq_u32 s40, 2
    s_cbranch_scc1 P5_e_104
    v_lshlrev_b32 v48, 16, v100
    v_and_b32 v49, 0xffff0000, v100
    v_fma_f32 v72, v120, v72, v48
    v_fma_f32 v73, v121, v73, v49
    v_lshlrev_b32 v48, 16, v101
    v_and_b32 v49, 0xffff0000, v101
    v_fma_f32 v74, v122, v74, v48
    v_fma_f32 v75, v123, v75, v49
    v_cvt_pk_bf16_f32 v20, v72, v73
    v_cvt_pk_bf16_f32 v21, v74, v75
    ds_write_b64 v15, v[20:21] offset:32
    v_lshlrev_b32 v48, 16, v102
    v_and_b32 v49, 0xffff0000, v102
    v_fma_f32 v76, v124, v76, v48
    v_fma_f32 v77, v125, v77, v49
    v_lshlrev_b32 v48, 16, v103
    v_and_b32 v49, 0xffff0000, v103
    v_fma_f32 v78, v126, v78, v48
    v_fma_f32 v79, v127, v79, v49
    v_cvt_pk_bf16_f32 v22, v76, v77
    v_cvt_pk_bf16_f32 v23, v78, v79
    ds_write_b64 v15, v[22:23] offset:48
P5_e_104:
    s_add_u32 s74, s72, 40960
    v_lshlrev_b32 v48, 16, v104
    v_and_b32 v49, 0xffff0000, v104
    v_fma_f32 v80, v112, v80, v48
    v_fma_f32 v81, v113, v81, v49
    v_lshlrev_b32 v48, 16, v105
    v_and_b32 v49, 0xffff0000, v105
    v_fma_f32 v82, v114, v82, v48
    v_fma_f32 v83, v115, v83, v49
    v_cvt_pk_bf16_f32 v24, v80, v81
    v_cvt_pk_bf16_f32 v25, v82, v83
    ds_write_b64 v15, v[24:25] offset:5120
    v_lshlrev_b32 v48, 16, v106
    v_and_b32 v49, 0xffff0000, v106
    v_fma_f32 v84, v116, v84, v48
    v_fma_f32 v85, v117, v85, v49
    v_lshlrev_b32 v48, 16, v107
    v_and_b32 v49, 0xffff0000, v107
    v_fma_f32 v86, v118, v86, v48
    v_fma_f32 v87, v119, v87, v49
    v_cvt_pk_bf16_f32 v26, v84, v85
    v_cvt_pk_bf16_f32 v27, v86, v87
    ds_write_b64 v15, v[26:27] offset:5136
    s_cmp_eq_u32 s40, 2
    s_cbranch_scc1 P5_e_105
    v_lshlrev_b32 v48, 16, v108
    v_and_b32 v49, 0xffff0000, v108
    v_fma_f32 v88, v120, v88, v48
    v_fma_f32 v89, v121, v89, v49
    v_lshlrev_b32 v48, 16, v109
    v_and_b32 v49, 0xffff0000, v109
    v_fma_f32 v90, v122, v90, v48
    v_fma_f32 v91, v123, v91, v49
    v_cvt_pk_bf16_f32 v28, v88, v89
    v_cvt_pk_bf16_f32 v29, v90, v91
    ds_write_b64 v15, v[28:29] offset:5152
    v_lshlrev_b32 v48, 16, v110
    v_and_b32 v49, 0xffff0000, v110
    v_fma_f32 v92, v124, v92, v48
    v_fma_f32 v93, v125, v93, v49
    v_lshlrev_b32 v48, 16, v111
    v_and_b32 v49, 0xffff0000, v111
    v_fma_f32 v94, v126, v94, v48
    v_fma_f32 v95, v127, v95, v49
    v_cvt_pk_bf16_f32 v30, v92, v93
    v_cvt_pk_bf16_f32 v31, v94, v95
    ds_write_b64 v15, v[30:31] offset:5168
P5_e_105:
    s_waitcnt lgkmcnt(0)
    s_barrier
    s_mul_i32 s72, s69, 160
    s_mul_i32 s73, s68, 81920
    s_add_u32 s72, s72, s73
    s_add_u32 s73, s40, 0
    s_lshl_b32 s73, s73, 6
    v_add_u32 v8, s73, v0
    v_lshlrev_b32 v9, 4, v8
    v_add_u32 v9, 142336, v9
    ds_read_b128 v[96:99], v9
    v_mul_u32_u24 v10, 104858, v8
    v_lshrrev_b32 v10, 20, v10
    v_mul_u32_u24 v11, 10, v10
    v_sub_u32 v11, v8, v11
    v_mul_u32_u24 v10, 1280, v10
    v_lshl_add_u32 v20, v11, 4, v10
    s_waitcnt lgkmcnt(0)
    buffer_store_dwordx4 v[96:99], v20, s[56:59], s72 offen
    s_add_u32 s73, s40, 3
    s_lshl_b32 s73, s73, 6
    v_add_u32 v8, s73, v0
    v_lshlrev_b32 v9, 4, v8
    v_add_u32 v9, 142336, v9
    ds_read_b128 v[100:103], v9
    v_mul_u32_u24 v10, 104858, v8
    v_lshrrev_b32 v10, 20, v10
    v_mul_u32_u24 v11, 10, v10
    v_sub_u32 v11, v8, v11
    v_mul_u32_u24 v10, 1280, v10
    v_lshl_add_u32 v21, v11, 4, v10
    s_waitcnt lgkmcnt(0)
    buffer_store_dwordx4 v[100:103], v21, s[56:59], s72 offen
    s_add_u32 s73, s40, 6
    s_lshl_b32 s73, s73, 6
    v_add_u32 v8, s73, v0
    v_lshlrev_b32 v9, 4, v8
    v_add_u32 v9, 142336, v9
    ds_read_b128 v[104:107], v9
    v_mul_u32_u24 v10, 104858, v8
    v_lshrrev_b32 v10, 20, v10
    v_mul_u32_u24 v11, 10, v10
    v_sub_u32 v11, v8, v11
    v_mul_u32_u24 v10, 1280, v10
    v_lshl_add_u32 v22, v11, 4, v10
    s_waitcnt lgkmcnt(0)
    buffer_store_dwordx4 v[104:107], v22, s[56:59], s72 offen
    s_cmp_lg_u32 s40, 0
    s_cbranch_scc1 P5_q_106
    s_add_u32 s73, s40, 9
    s_lshl_b32 s73, s73, 6
    v_add_u32 v8, s73, v0
    v_lshlrev_b32 v9, 4, v8
    v_add_u32 v9, 142336, v9
    ds_read_b128 v[108:111], v9
    v_mul_u32_u24 v10, 104858, v8
    v_lshrrev_b32 v10, 20, v10
    v_mul_u32_u24 v11, 10, v10
    v_sub_u32 v11, v8, v11
    v_mul_u32_u24 v10, 1280, v10
    v_lshl_add_u32 v23, v11, 4, v10
    s_waitcnt lgkmcnt(0)
    buffer_store_dwordx4 v[108:111], v23, s[56:59], s72 offen
P5_q_106:
    s_branch P5_fin_99
P5_w3_98:
    v_min_u32 v4, 19, v0
    v_mul_u32_u24 v5, 52429, v4
    v_lshrrev_b32 v5, 20, v5
    v_mul_u32_u24 v6, 20, v5
    v_sub_u32 v6, v4, v6
    v_add_u32 v7, 5, v5
    v_mul_u32_u24 v7, 160, v7
    v_add_u32 v7, v7, v6
    s_mul_i32 s71, s69, 20
    v_add_u32 v7, s71, v7
    v_lshlrev_b32 v7, 4, v7
    v_mov_b32 v15, v7
    v_mul_u32_u24 v7, 320, v5
    v_lshl_add_u32 v7, v6, 4, v7
    v_add_u32 v7, 141312, v7
    s_barrier
    s_barrier
    s_mov_b32 s94, 30000
    s_cmp_lg_u32 s42, 0
    s_cselect_b32 s94, 1, s94
tab_poll_107:
    buffer_load_dwordx4 v[8:11], v15, s[52:55], 0 offen sc1
    s_waitcnt vmcnt(0)
    v_cmp_ne_u32 vcc, s41, v10
    s_nop 1
    s_cbranch_vccz tab_ok_109
    s_sleep 2
    s_sub_u32 s94, s94, 1
    s_cmp_lg_u32 s94, 0
    s_cbranch_scc1 tab_poll_107
    s_mov_b32 s42, 1
tab_ok_109:
    v_lshlrev_b32 v12, 16, v8
    v_and_b32 v13, 0xffff0000, v8
    v_lshlrev_b32 v14, 16, v9
    v_and_b32 v15, 0xffff0000, v9
    ds_write_b128 v7, v[12:15]
    s_waitcnt lgkmcnt(0)
    s_barrier
    s_barrier
    s_barrier
    s_barrier
    s_barrier
    s_barrier
    s_barrier
    s_barrier
    s_barrier
    s_barrier
    s_barrier
    s_barrier
P5_fin_99:
    s_cmp_lg_u32 s2, 0
    s_cbranch_scc1 pubn_110
    s_cmp_lg_u32 s40, 0
    s_cbranch_scc1 pubn_110
    v_mov_b32 v250, s41
    v_mov_b32 v251, 0
    s_mov_b64 exec, 1
    buffer_store_dword v250, v251, s[96:99], 0 offen sc1
    s_mov_b64 exec, -1
pubn_110:
L_fin:
    s_endpgm
.section .rodata,"a"
.p2align 6
.amdhsa_kernel adaLN_cond__mha_block__glu_gated_glu__prompt_kernel
  .amdhsa_next_free_vgpr 256
  .amdhsa_next_free_sgpr 102
  .amdhsa_accum_offset 256
  .amdhsa_group_segment_fixed_size 0
  .amdhsa_kernarg_size 96
  .amdhsa_user_sgpr_count 2
  .amdhsa_user_sgpr_kernarg_segment_ptr 1
  .amdhsa_system_sgpr_workgroup_id_x 1
  .amdhsa_float_denorm_mode_32 3
.end_amdhsa_kernel
```
